```python
import torch

def _softmax(x, axis=-1):
    return torch.softmax(x, dim=axis)
def _gelu(x):
    return torch.nn.functional.gelu(x, approximate="tanh")
def _silu(x):
    return torch.nn.functional.silu(x)
def _sigmoid(x):
    return torch.sigmoid(x)
def _layernorm(x, axis=-1, eps=1e-5):
    m = x.mean(dim=axis, keepdim=True)
    v = x.var(dim=axis, keepdim=True, unbiased=False)
    return (x - m) / torch.sqrt(v + eps)
def _scatter_add(tgt, idx, src, axis=0):
    return tgt.clone().index_add_(axis, idx, src)
def _segment_sum(src, seg, n):
    out = torch.zeros((n,) + src.shape[1:], dtype=src.dtype)
    return out.index_add_(0, seg, src)
def _pad(x, pw):
    flat = tuple(v for pair in reversed(pw) for v in pair)
    return torch.nn.functional.pad(x, flat)

kernel_name = 'gated_mix__linear_attn_block__glu_gated_glu__prompt'

def setup_inputs():

    _w = (lambda a: (lambda t: t.to(torch.bfloat16) if t.is_floating_point() else t)(torch.as_tensor(a)))
    def _A_setup():
        B, S, D = 1, 2048, 640
        return {
            "x": _w((lambda *s: torch.randn(*s, dtype=torch.bfloat16) * 0.05)(B, S, D)),
            "wqkv": _w((lambda *s: torch.randn(*s, dtype=torch.bfloat16) * 0.8)(D, 3 * D)),
            "wo": _w((lambda *s: torch.randn(*s, dtype=torch.bfloat16) * 0.2)(D, D)),
        }
    _A_in = _A_setup()

    def _B_setup():
        B, S, D, F = 1, 2048, 640, 1728
        return {
            "x": _w((lambda *s: torch.randn(*s, dtype=torch.bfloat16) * 0.05)(B, S, D)),
            "w_gate": _w((lambda *s: torch.randn(*s, dtype=torch.bfloat16) * 0.4)(D, F)),
            "w_up": _w((lambda *s: torch.randn(*s, dtype=torch.bfloat16) * 0.05)(D, F)),
            "w_down": _w((lambda *s: torch.randn(*s, dtype=torch.bfloat16) * 0.05)(F, D)),
        }
    _B_in = _B_setup()

    return {
        "A_x": _A_in["x"],
        "A_wqkv": _A_in["wqkv"],
        "A_wo": _A_in["wo"],
        "B_x": _B_in["x"],
        "B_w_gate": _B_in["w_gate"],
        "B_w_up": _B_in["w_up"],
        "B_w_down": _B_in["w_down"],
        "gate_w": _w((lambda *s: torch.randn(*s, dtype=torch.bfloat16) * 0.05)(640) * 16.0),
    }

def reference(A_x, A_wqkv, A_wo, B_x, B_w_gate, B_w_up, B_w_down, gate_w):
    def _A_ref(x, wqkv, wo):
        B, S, D = x.shape
        H = 32; Dh = D // H
        qkv = (lambda x, *d: x.permute(*d))((x @ wqkv).reshape(B, S, 3, H, Dh), 2, 0, 3, 1, 4)
        q, k, v = qkv[0], qkv[1], qkv[2]
        phi = lambda t: torch.where(t > 0, t + 1, torch.exp(t)) + 1e-6
        pq, pk = phi(q), phi(k)
        kv = torch.einsum("bhsd,bhse->bhde", pk, v)
        z = torch.einsum("bhsd->bhd", pk)
        num = torch.einsum("bhqd,bhde->bhqe", pq, kv)
        den = torch.einsum("bhqd,bhd->bhq", pq, z)[..., None] + 1e-6
        o = num / den
        return (lambda x, *d: x.permute(*d))(o, 0, 2, 1, 3).reshape(B, S, D) @ wo

    def _B_ref(x, w_gate, w_up, w_down):
        g = torch.einsum("bsd,df->bsf", x, w_gate)
        u = torch.einsum("bsd,df->bsf", x, w_up)
        h = _sigmoid(g) * u
        return torch.einsum("bsf,fd->bsd", h, w_down)

    x = A_x
    g = _sigmoid((x * gate_w).sum(-1, keepdims=True))
    a = _A_ref(x, A_wqkv, A_wo)
    b = _B_ref(x, B_w_gate, B_w_up, B_w_down)
    return g * a + (1 - g) * b
```

```asm
; @launch grid=(256,1,1) block=(512,1,1) lds=163840
.amdgcn_target "amdgcn-amd-amdhsa--gfx950"
.text
.globl gated_mix__linear_attn_block__glu_gated_glu__prompt_kernel
.p2align 8
.type gated_mix__linear_attn_block__glu_gated_glu__prompt_kernel,@function
gated_mix__linear_attn_block__glu_gated_glu__prompt_kernel:

    s_load_dwordx16 s[16:31], s[0:1], 0
    s_load_dwordx4 s[32:35], s[0:1], 64
    s_load_dwordx2 s[36:37], s[0:1], 80
    s_cmp_ge_u32 s2, 256
    s_cbranch_scc1 L_end
    v_lshrrev_b32 v1, 6, v0
    v_and_b32 v0, 63, v0
    v_readfirstlane_b32 s3, v1
    s_and_b32 s90, s2, 7
    s_lshr_b32 s91, s2, 3
    s_lshr_b32 s6, s90, 2
    s_and_b32 s7, s90, 3
    s_lshr_b32 s11, s91, 2
    s_and_b32 s10, s91, 3
    s_lshl_b32 s88, s90, 2
    s_add_u32 s88, s88, s10
    s_mov_b32 s89, s11
    s_cmp_lt_u32 s91, 28
    s_cbranch_scc1 L_dec_full
    s_and_b32 s8, s7, 1
    s_lshl_b32 s8, s8, 1
    s_sub_u32 s9, s91, 28
    s_add_u32 s10, s8, s9
L_dec_full:
    s_lshl_b32 s52, s6, 2
    s_add_u32 s52, s52, s10
    s_mov_b32 s54, 0
    s_lshl_b32 s53, s7, 1
    s_add_u32 s53, s53, s11
    s_cmp_lt_u32 s11, 2
    s_cbranch_scc1 L_role_done
    s_mov_b32 s54, 1
    s_mov_b32 s53, s7
    s_cmp_eq_u32 s11, 2
    s_cbranch_scc1 L_role_done
    s_mov_b32 s54, 2
    s_lshl_b32 s53, s7, 2
    s_add_u32 s53, s53, s11
    s_sub_u32 s53, s53, 3
    s_cmp_lt_u32 s11, 7
    s_cbranch_scc1 L_role_done
    s_lshr_b32 s53, s7, 1
    s_add_u32 s53, s53, 16
L_role_done:
    s_mul_i32 s8, s10, 5
    s_add_u32 s8, s8, 1
    s_lshr_b32 s8, s8, 1
    s_add_u32 s8, s8, s11
    s_cmp_ge_u32 s8, 10
    s_cselect_b32 s9, 10, 0
    s_sub_u32 s39, s8, s9
    s_waitcnt lgkmcnt(0)
    s_or_b32 s4, s2, s3
    s_cmp_lg_u32 s4, 0
    s_cbranch_scc1 L_noT
    s_memrealtime s[4:5]
    s_mov_b32 s40, s34
    s_mov_b32 s41, s35
    s_mov_b32 s42, 0x100
    s_mov_b32 s43, 0x20000
    s_waitcnt lgkmcnt(0)
    s_or_b32 s4, s4, 1
    v_mov_b32 v1, 0
    v_mov_b32 v2, s4
    s_mov_b64 exec, 1
    buffer_store_dword v2, v1, s[40:43], 0 offen sc1
    s_mov_b64 exec, -1
L_noT:
    s_add_u32 s84, s36, 0xfa0000
    s_addc_u32 s85, s37, 0
    s_mov_b32 s86, 0x8000
    s_mov_b32 s87, 0x20000
    s_cmp_ge_u32 s91, 30
    s_cbranch_scc1 L_spare
    s_cmp_ge_u32 s3, 4
    s_cbranch_scc1 L_loader
    s_cmp_eq_u32 s54, 0
    s_cbranch_scc1 L_cons_kv
    s_cmp_eq_u32 s54, 1
    s_cbranch_scc1 L_cons_q
    s_branch L_cons_ffn
L_loader:
    s_sub_u32 s4, s3, 4
    s_and_b32 s5, s4, 1
    s_lshr_b32 s6, s4, 1
    s_mov_b32 s40, s16
    s_mov_b32 s41, s17
    s_mov_b32 s42, 0x280000
    s_mov_b32 s43, 0x20000
    s_mov_b32 s48, s30
    s_mov_b32 s49, s31
    s_mov_b32 s50, 0x500
    s_mov_b32 s51, 0x20000
    s_mov_b32 s47, 0x20000
    s_mov_b32 s67, 32
    s_cmp_eq_u32 s54, 2
    s_cbranch_scc0 L_ld_qkv
    s_cmp_eq_u32 s6, 0
    s_cselect_b32 s44, s24, s26
    s_cselect_b32 s45, s25, s27
    s_mov_b32 s46, 2211840
    s_mov_b32 s68, 3456
    s_mul_i32 s64, s53, 192
    s_add_u32 s65, s64, 64
    s_add_u32 s66, s64, 128
    s_branch L_ld_common
L_ld_qkv:
    s_mov_b32 s44, s18
    s_mov_b32 s45, s19
    s_mov_b32 s46, 2457600
    s_mov_b32 s68, 3840
    s_cmp_eq_u32 s54, 1
    s_cbranch_scc0 L_ld_kv
    s_mul_i32 s64, s53, 320
    s_mul_i32 s7, s6, 192
    s_add_u32 s64, s64, s7
    s_add_u32 s65, s64, 64
    s_add_u32 s66, s64, 128
    s_cmp_eq_u32 s6, 1
    s_cselect_b32 s66, 0x40000000, s66
    s_branch L_ld_common
L_ld_kv:
    s_mul_i32 s64, s53, 160
    s_mul_i32 s7, s6, 1280
    s_add_u32 s64, s64, s7
    s_add_u32 s64, s64, 1280
    s_add_u32 s65, s64, 64
    s_add_u32 s66, s64, 128
    s_cmp_eq_u32 s6, 1
    s_cselect_b32 s66, 0x40000000, s66
    s_cselect_b32 s67, 32, 1280
L_ld_common:
    v_lshrrev_b32 v1, 2, v0
    s_lshl_b32 s7, s5, 4
    v_add_u32 v2, s7, v1
    v_mul_lo_u32 v2, v2, s68
    v_and_b32 v3, 1, v0
    v_lshl_add_u32 v2, v3, 4, v2
    v_lshrrev_b32 v3, 1, v0
    v_lshrrev_b32 v4, 5, v0
    v_xor_b32 v3, v3, v4
    v_and_b32 v3, 1, v3
    v_lshl_add_u32 v5, v3, 5, v2
    v_add_u32 v10, s64, v5
    v_add_u32 v11, s65, v5
    v_mad_u32_u24 v12, v3, s67, v2
    v_add_u32 v12, s66, v12
    s_lshl_b32 s60, s68, 5
    s_mul_i32 s71, s60, 20
    s_mul_i32 s56, s60, s39
    s_lshl_b32 s56, s56, 1
    s_mov_b32 s61, 0
    s_mul_i32 s7, s5, 6
    s_mul_i32 s8, s6, 3
    s_add_u32 s7, s7, s8
    s_lshl_b32 s7, s7, 10
    s_add_u32 s57, s7, 98304
    s_add_u32 m0, s57, 0
    s_nop 0
    buffer_load_dwordx4 v10, s[44:47], s56 offen lds
    s_add_u32 m0, s57, 1024
    s_nop 0
    buffer_load_dwordx4 v11, s[44:47], s56 offen lds
    s_add_u32 m0, s57, 2048
    s_nop 0
    buffer_load_dwordx4 v12, s[44:47], s56 offen lds
    s_add_u32 s56, s56, s60
    s_cmp_eq_u32 s56, s71
    s_cselect_b32 s56, 0, s56
    s_add_u32 s61, s61, 1
    s_add_u32 s57, s57, 12288
    s_cmp_eq_u32 s61, 5
    s_cselect_b32 s61, 0, s61
    s_cselect_b32 s69, 61440, 0
    s_sub_u32 s57, s57, s69
    v_lshrrev_b32 v1, 3, v0
    v_mul_u32_u24 v1, 0x500, v1
    v_and_b32 v2, 7, v0
    v_lshrrev_b32 v3, 4, v0
    v_xor_b32 v4, v2, v3
    v_lshl_add_u32 v13, v4, 4, v1
    v_xor_b32 v4, 4, v4
    v_lshl_add_u32 v14, v4, 4, v1
    s_lshl_b32 s7, s52, 8
    s_lshl_b32 s8, s4, 5
    s_add_u32 s7, s7, s8
    s_mul_i32 s73, s7, 1280
    s_add_u32 s72, s73, 1280
    s_lshl_b32 s58, s39, 7
    s_add_u32 s58, s58, s73
    s_lshl_b32 s59, s4, 12
    s_mov_b32 s62, 0
    s_add_u32 m0, s59, 0
    s_add_u32 s69, s58, 0
    buffer_load_dwordx4 v13, s[40:43], s69 offen lds
    s_add_u32 m0, s59, 1024
    s_add_u32 s69, s58, 10240
    buffer_load_dwordx4 v14, s[40:43], s69 offen lds
    s_add_u32 m0, s59, 2048
    s_add_u32 s69, s58, 20480
    buffer_load_dwordx4 v13, s[40:43], s69 offen lds
    s_add_u32 m0, s59, 3072
    s_add_u32 s69, s58, 30720
    buffer_load_dwordx4 v14, s[40:43], s69 offen lds
    s_add_u32 m0, s59, 16384
    s_add_u32 s69, s58, 163840
    buffer_load_dwordx4 v13, s[40:43], s69 offen lds
    s_add_u32 m0, s59, 17408
    s_add_u32 s69, s58, 174080
    buffer_load_dwordx4 v14, s[40:43], s69 offen lds
    s_add_u32 m0, s59, 18432
    s_add_u32 s69, s58, 184320
    buffer_load_dwordx4 v13, s[40:43], s69 offen lds
    s_add_u32 m0, s59, 19456
    s_add_u32 s69, s58, 194560
    buffer_load_dwordx4 v14, s[40:43], s69 offen lds
    s_add_u32 s58, s58, 128
    s_cmp_eq_u32 s58, s72
    s_cselect_b32 s58, s73, s58
    s_add_u32 s62, s62, 1
    s_add_u32 s59, s59, 32768
    s_cmp_eq_u32 s62, 3
    s_cselect_b32 s62, 0, s62
    s_cselect_b32 s69, 98304, 0
    s_sub_u32 s59, s59, s69
    v_lshlrev_b32 v8, 4, v0
    v_add_u32 v9, 0x400, v8
    s_mov_b32 m0, 159744
    s_nop 0
    buffer_load_dwordx4 v8, s[48:51], 0 offen lds
    s_mov_b32 m0, 160768
    s_nop 0
    buffer_load_dwordx4 v9, s[48:51], 0 offen lds
    s_add_u32 m0, s57, 0
    s_nop 0
    buffer_load_dwordx4 v10, s[44:47], s56 offen lds
    s_add_u32 m0, s57, 1024
    s_nop 0
    buffer_load_dwordx4 v11, s[44:47], s56 offen lds
    s_add_u32 m0, s57, 2048
    s_nop 0
    buffer_load_dwordx4 v12, s[44:47], s56 offen lds
    s_add_u32 s56, s56, s60
    s_cmp_eq_u32 s56, s71
    s_cselect_b32 s56, 0, s56
    s_add_u32 s61, s61, 1
    s_add_u32 s57, s57, 12288
    s_cmp_eq_u32 s61, 5
    s_cselect_b32 s61, 0, s61
    s_cselect_b32 s69, 61440, 0
    s_sub_u32 s57, s57, s69
    s_add_u32 m0, s59, 0
    s_add_u32 s69, s58, 0
    buffer_load_dwordx4 v13, s[40:43], s69 offen lds
    s_add_u32 m0, s59, 1024
    s_add_u32 s69, s58, 10240
    buffer_load_dwordx4 v14, s[40:43], s69 offen lds
    s_add_u32 m0, s59, 2048
    s_add_u32 s69, s58, 20480
    buffer_load_dwordx4 v13, s[40:43], s69 offen lds
    s_add_u32 m0, s59, 3072
    s_add_u32 s69, s58, 30720
    buffer_load_dwordx4 v14, s[40:43], s69 offen lds
    s_add_u32 m0, s59, 16384
    s_add_u32 s69, s58, 163840
    buffer_load_dwordx4 v13, s[40:43], s69 offen lds
    s_add_u32 m0, s59, 17408
    s_add_u32 s69, s58, 174080
    buffer_load_dwordx4 v14, s[40:43], s69 offen lds
    s_add_u32 m0, s59, 18432
    s_add_u32 s69, s58, 184320
    buffer_load_dwordx4 v13, s[40:43], s69 offen lds
    s_add_u32 m0, s59, 19456
    s_add_u32 s69, s58, 194560
    buffer_load_dwordx4 v14, s[40:43], s69 offen lds
    s_add_u32 s58, s58, 128
    s_cmp_eq_u32 s58, s72
    s_cselect_b32 s58, s73, s58
    s_add_u32 s62, s62, 1
    s_add_u32 s59, s59, 32768
    s_cmp_eq_u32 s62, 3
    s_cselect_b32 s62, 0, s62
    s_cselect_b32 s69, 98304, 0
    s_sub_u32 s59, s59, s69
    s_add_u32 m0, s57, 0
    s_nop 0
    buffer_load_dwordx4 v10, s[44:47], s56 offen lds
    s_add_u32 m0, s57, 1024
    s_nop 0
    buffer_load_dwordx4 v11, s[44:47], s56 offen lds
    s_add_u32 m0, s57, 2048
    s_nop 0
    buffer_load_dwordx4 v12, s[44:47], s56 offen lds
    s_add_u32 s56, s56, s60
    s_cmp_eq_u32 s56, s71
    s_cselect_b32 s56, 0, s56
    s_add_u32 s61, s61, 1
    s_add_u32 s57, s57, 12288
    s_cmp_eq_u32 s61, 5
    s_cselect_b32 s61, 0, s61
    s_cselect_b32 s69, 61440, 0
    s_sub_u32 s57, s57, s69
    s_mov_b32 s80, s34
    s_mov_b32 s81, s35
    s_mov_b32 s82, 0x100
    s_mov_b32 s83, 0x20000
    v_mov_b32 v6, 0
    buffer_load_dword v5, v6, s[80:83], 0 offen sc1
    s_waitcnt vmcnt(15)
    s_barrier
    s_add_u32 m0, s57, 0
    s_nop 0
    buffer_load_dwordx4 v10, s[44:47], s56 offen lds
    s_add_u32 m0, s57, 1024
    s_nop 0
    buffer_load_dwordx4 v11, s[44:47], s56 offen lds
    s_add_u32 m0, s57, 2048
    s_nop 0
    buffer_load_dwordx4 v12, s[44:47], s56 offen lds
    s_add_u32 s56, s56, s60
    s_cmp_eq_u32 s56, s71
    s_cselect_b32 s56, 0, s56
    s_add_u32 s61, s61, 1
    s_add_u32 s57, s57, 12288
    s_cmp_eq_u32 s61, 5
    s_cselect_b32 s61, 0, s61
    s_cselect_b32 s69, 61440, 0
    s_sub_u32 s57, s57, s69
    s_add_u32 m0, s59, 0
    s_add_u32 s69, s58, 0
    buffer_load_dwordx4 v13, s[40:43], s69 offen lds
    s_add_u32 m0, s59, 1024
    s_add_u32 s69, s58, 10240
    buffer_load_dwordx4 v14, s[40:43], s69 offen lds
    s_add_u32 m0, s59, 2048
    s_add_u32 s69, s58, 20480
    buffer_load_dwordx4 v13, s[40:43], s69 offen lds
    s_add_u32 m0, s59, 3072
    s_add_u32 s69, s58, 30720
    buffer_load_dwordx4 v14, s[40:43], s69 offen lds
    s_waitcnt vmcnt(19)
    s_barrier
    s_add_u32 m0, s57, 0
    s_nop 0
    buffer_load_dwordx4 v10, s[44:47], s56 offen lds
    s_add_u32 m0, s57, 1024
    s_nop 0
    buffer_load_dwordx4 v11, s[44:47], s56 offen lds
    s_add_u32 m0, s57, 2048
    s_nop 0
    buffer_load_dwordx4 v12, s[44:47], s56 offen lds
    s_add_u32 s56, s56, s60
    s_cmp_eq_u32 s56, s71
    s_cselect_b32 s56, 0, s56
    s_add_u32 s61, s61, 1
    s_add_u32 s57, s57, 12288
    s_cmp_eq_u32 s61, 5
    s_cselect_b32 s61, 0, s61
    s_cselect_b32 s69, 61440, 0
    s_sub_u32 s57, s57, s69
    s_add_u32 m0, s59, 16384
    s_add_u32 s69, s58, 163840
    buffer_load_dwordx4 v13, s[40:43], s69 offen lds
    s_add_u32 m0, s59, 17408
    s_add_u32 s69, s58, 174080
    buffer_load_dwordx4 v14, s[40:43], s69 offen lds
    s_add_u32 m0, s59, 18432
    s_add_u32 s69, s58, 184320
    buffer_load_dwordx4 v13, s[40:43], s69 offen lds
    s_add_u32 m0, s59, 19456
    s_add_u32 s69, s58, 194560
    buffer_load_dwordx4 v14, s[40:43], s69 offen lds
    s_add_u32 s58, s58, 128
    s_cmp_eq_u32 s58, s72
    s_cselect_b32 s58, s73, s58
    s_add_u32 s62, s62, 1
    s_add_u32 s59, s59, 32768
    s_cmp_eq_u32 s62, 3
    s_cselect_b32 s62, 0, s62
    s_cselect_b32 s69, 98304, 0
    s_sub_u32 s59, s59, s69
    s_waitcnt vmcnt(15)
    s_barrier
    s_add_u32 m0, s57, 0
    s_nop 0
    buffer_load_dwordx4 v10, s[44:47], s56 offen lds
    s_add_u32 m0, s57, 1024
    s_nop 0
    buffer_load_dwordx4 v11, s[44:47], s56 offen lds
    s_add_u32 m0, s57, 2048
    s_nop 0
    buffer_load_dwordx4 v12, s[44:47], s56 offen lds
    s_add_u32 s56, s56, s60
    s_cmp_eq_u32 s56, s71
    s_cselect_b32 s56, 0, s56
    s_add_u32 s61, s61, 1
    s_add_u32 s57, s57, 12288
    s_cmp_eq_u32 s61, 5
    s_cselect_b32 s61, 0, s61
    s_cselect_b32 s69, 61440, 0
    s_sub_u32 s57, s57, s69
    s_add_u32 m0, s59, 0
    s_add_u32 s69, s58, 0
    buffer_load_dwordx4 v13, s[40:43], s69 offen lds
    s_add_u32 m0, s59, 1024
    s_add_u32 s69, s58, 10240
    buffer_load_dwordx4 v14, s[40:43], s69 offen lds
    s_add_u32 m0, s59, 2048
    s_add_u32 s69, s58, 20480
    buffer_load_dwordx4 v13, s[40:43], s69 offen lds
    s_add_u32 m0, s59, 3072
    s_add_u32 s69, s58, 30720
    buffer_load_dwordx4 v14, s[40:43], s69 offen lds
    s_waitcnt vmcnt(14)
    s_barrier
    s_add_u32 m0, s57, 0
    s_nop 0
    buffer_load_dwordx4 v10, s[44:47], s56 offen lds
    s_add_u32 m0, s57, 1024
    s_nop 0
    buffer_load_dwordx4 v11, s[44:47], s56 offen lds
    s_add_u32 m0, s57, 2048
    s_nop 0
    buffer_load_dwordx4 v12, s[44:47], s56 offen lds
    s_add_u32 s56, s56, s60
    s_cmp_eq_u32 s56, s71
    s_cselect_b32 s56, 0, s56
    s_add_u32 s61, s61, 1
    s_add_u32 s57, s57, 12288
    s_cmp_eq_u32 s61, 5
    s_cselect_b32 s61, 0, s61
    s_cselect_b32 s69, 61440, 0
    s_sub_u32 s57, s57, s69
    s_add_u32 m0, s59, 16384
    s_add_u32 s69, s58, 163840
    buffer_load_dwordx4 v13, s[40:43], s69 offen lds
    s_add_u32 m0, s59, 17408
    s_add_u32 s69, s58, 174080
    buffer_load_dwordx4 v14, s[40:43], s69 offen lds
    s_add_u32 m0, s59, 18432
    s_add_u32 s69, s58, 184320
    buffer_load_dwordx4 v13, s[40:43], s69 offen lds
    s_add_u32 m0, s59, 19456
    s_add_u32 s69, s58, 194560
    buffer_load_dwordx4 v14, s[40:43], s69 offen lds
    s_add_u32 s58, s58, 128
    s_cmp_eq_u32 s58, s72
    s_cselect_b32 s58, s73, s58
    s_add_u32 s62, s62, 1
    s_add_u32 s59, s59, 32768
    s_cmp_eq_u32 s62, 3
    s_cselect_b32 s62, 0, s62
    s_cselect_b32 s69, 98304, 0
    s_sub_u32 s59, s59, s69
    s_waitcnt vmcnt(14)
    s_barrier
    s_add_u32 m0, s57, 0
    s_nop 0
    buffer_load_dwordx4 v10, s[44:47], s56 offen lds
    s_add_u32 m0, s57, 1024
    s_nop 0
    buffer_load_dwordx4 v11, s[44:47], s56 offen lds
    s_add_u32 m0, s57, 2048
    s_nop 0
    buffer_load_dwordx4 v12, s[44:47], s56 offen lds
    s_add_u32 s56, s56, s60
    s_cmp_eq_u32 s56, s71
    s_cselect_b32 s56, 0, s56
    s_add_u32 s61, s61, 1
    s_add_u32 s57, s57, 12288
    s_cmp_eq_u32 s61, 5
    s_cselect_b32 s61, 0, s61
    s_cselect_b32 s69, 61440, 0
    s_sub_u32 s57, s57, s69
    s_add_u32 m0, s59, 0
    s_add_u32 s69, s58, 0
    buffer_load_dwordx4 v13, s[40:43], s69 offen lds
    s_add_u32 m0, s59, 1024
    s_add_u32 s69, s58, 10240
    buffer_load_dwordx4 v14, s[40:43], s69 offen lds
    s_add_u32 m0, s59, 2048
    s_add_u32 s69, s58, 20480
    buffer_load_dwordx4 v13, s[40:43], s69 offen lds
    s_add_u32 m0, s59, 3072
    s_add_u32 s69, s58, 30720
    buffer_load_dwordx4 v14, s[40:43], s69 offen lds
    s_waitcnt vmcnt(14)
    s_barrier
    s_add_u32 m0, s57, 0
    s_nop 0
    buffer_load_dwordx4 v10, s[44:47], s56 offen lds
    s_add_u32 m0, s57, 1024
    s_nop 0
    buffer_load_dwordx4 v11, s[44:47], s56 offen lds
    s_add_u32 m0, s57, 2048
    s_nop 0
    buffer_load_dwordx4 v12, s[44:47], s56 offen lds
    s_add_u32 s56, s56, s60
    s_cmp_eq_u32 s56, s71
    s_cselect_b32 s56, 0, s56
    s_add_u32 s61, s61, 1
    s_add_u32 s57, s57, 12288
    s_cmp_eq_u32 s61, 5
    s_cselect_b32 s61, 0, s61
    s_cselect_b32 s69, 61440, 0
    s_sub_u32 s57, s57, s69
    s_add_u32 m0, s59, 16384
    s_add_u32 s69, s58, 163840
    buffer_load_dwordx4 v13, s[40:43], s69 offen lds
    s_add_u32 m0, s59, 17408
    s_add_u32 s69, s58, 174080
    buffer_load_dwordx4 v14, s[40:43], s69 offen lds
    s_add_u32 m0, s59, 18432
    s_add_u32 s69, s58, 184320
    buffer_load_dwordx4 v13, s[40:43], s69 offen lds
    s_add_u32 m0, s59, 19456
    s_add_u32 s69, s58, 194560
    buffer_load_dwordx4 v14, s[40:43], s69 offen lds
    s_add_u32 s58, s58, 128
    s_cmp_eq_u32 s58, s72
    s_cselect_b32 s58, s73, s58
    s_add_u32 s62, s62, 1
    s_add_u32 s59, s59, 32768
    s_cmp_eq_u32 s62, 3
    s_cselect_b32 s62, 0, s62
    s_cselect_b32 s69, 98304, 0
    s_sub_u32 s59, s59, s69
    s_waitcnt vmcnt(14)
    s_barrier
    s_add_u32 m0, s57, 0
    s_nop 0
    buffer_load_dwordx4 v10, s[44:47], s56 offen lds
    s_add_u32 m0, s57, 1024
    s_nop 0
    buffer_load_dwordx4 v11, s[44:47], s56 offen lds
    s_add_u32 m0, s57, 2048
    s_nop 0
    buffer_load_dwordx4 v12, s[44:47], s56 offen lds
    s_add_u32 s56, s56, s60
    s_cmp_eq_u32 s56, s71
    s_cselect_b32 s56, 0, s56
    s_add_u32 s61, s61, 1
    s_add_u32 s57, s57, 12288
    s_cmp_eq_u32 s61, 5
    s_cselect_b32 s61, 0, s61
    s_cselect_b32 s69, 61440, 0
    s_sub_u32 s57, s57, s69
    s_add_u32 m0, s59, 0
    s_add_u32 s69, s58, 0
    buffer_load_dwordx4 v13, s[40:43], s69 offen lds
    s_add_u32 m0, s59, 1024
    s_add_u32 s69, s58, 10240
    buffer_load_dwordx4 v14, s[40:43], s69 offen lds
    s_add_u32 m0, s59, 2048
    s_add_u32 s69, s58, 20480
    buffer_load_dwordx4 v13, s[40:43], s69 offen lds
    s_add_u32 m0, s59, 3072
    s_add_u32 s69, s58, 30720
    buffer_load_dwordx4 v14, s[40:43], s69 offen lds
    s_waitcnt vmcnt(14)
    s_barrier
    s_add_u32 m0, s57, 0
    s_nop 0
    buffer_load_dwordx4 v10, s[44:47], s56 offen lds
    s_add_u32 m0, s57, 1024
    s_nop 0
    buffer_load_dwordx4 v11, s[44:47], s56 offen lds
    s_add_u32 m0, s57, 2048
    s_nop 0
    buffer_load_dwordx4 v12, s[44:47], s56 offen lds
    s_add_u32 s56, s56, s60
    s_cmp_eq_u32 s56, s71
    s_cselect_b32 s56, 0, s56
    s_add_u32 s61, s61, 1
    s_add_u32 s57, s57, 12288
    s_cmp_eq_u32 s61, 5
    s_cselect_b32 s61, 0, s61
    s_cselect_b32 s69, 61440, 0
    s_sub_u32 s57, s57, s69
    s_add_u32 m0, s59, 16384
    s_add_u32 s69, s58, 163840
    buffer_load_dwordx4 v13, s[40:43], s69 offen lds
    s_add_u32 m0, s59, 17408
    s_add_u32 s69, s58, 174080
    buffer_load_dwordx4 v14, s[40:43], s69 offen lds
    s_add_u32 m0, s59, 18432
    s_add_u32 s69, s58, 184320
    buffer_load_dwordx4 v13, s[40:43], s69 offen lds
    s_add_u32 m0, s59, 19456
    s_add_u32 s69, s58, 194560
    buffer_load_dwordx4 v14, s[40:43], s69 offen lds
    s_add_u32 s58, s58, 128
    s_cmp_eq_u32 s58, s72
    s_cselect_b32 s58, s73, s58
    s_add_u32 s62, s62, 1
    s_add_u32 s59, s59, 32768
    s_cmp_eq_u32 s62, 3
    s_cselect_b32 s62, 0, s62
    s_cselect_b32 s69, 98304, 0
    s_sub_u32 s59, s59, s69
    s_waitcnt vmcnt(14)
    s_barrier
    s_add_u32 m0, s57, 0
    s_nop 0
    buffer_load_dwordx4 v10, s[44:47], s56 offen lds
    s_add_u32 m0, s57, 1024
    s_nop 0
    buffer_load_dwordx4 v11, s[44:47], s56 offen lds
    s_add_u32 m0, s57, 2048
    s_nop 0
    buffer_load_dwordx4 v12, s[44:47], s56 offen lds
    s_add_u32 s56, s56, s60
    s_cmp_eq_u32 s56, s71
    s_cselect_b32 s56, 0, s56
    s_add_u32 s61, s61, 1
    s_add_u32 s57, s57, 12288
    s_cmp_eq_u32 s61, 5
    s_cselect_b32 s61, 0, s61
    s_cselect_b32 s69, 61440, 0
    s_sub_u32 s57, s57, s69
    s_add_u32 m0, s59, 0
    s_add_u32 s69, s58, 0
    buffer_load_dwordx4 v13, s[40:43], s69 offen lds
    s_add_u32 m0, s59, 1024
    s_add_u32 s69, s58, 10240
    buffer_load_dwordx4 v14, s[40:43], s69 offen lds
    s_add_u32 m0, s59, 2048
    s_add_u32 s69, s58, 20480
    buffer_load_dwordx4 v13, s[40:43], s69 offen lds
    s_add_u32 m0, s59, 3072
    s_add_u32 s69, s58, 30720
    buffer_load_dwordx4 v14, s[40:43], s69 offen lds
    s_waitcnt vmcnt(14)
    s_barrier
    s_add_u32 m0, s57, 0
    s_nop 0
    buffer_load_dwordx4 v10, s[44:47], s56 offen lds
    s_add_u32 m0, s57, 1024
    s_nop 0
    buffer_load_dwordx4 v11, s[44:47], s56 offen lds
    s_add_u32 m0, s57, 2048
    s_nop 0
    buffer_load_dwordx4 v12, s[44:47], s56 offen lds
    s_add_u32 s56, s56, s60
    s_cmp_eq_u32 s56, s71
    s_cselect_b32 s56, 0, s56
    s_add_u32 s61, s61, 1
    s_add_u32 s57, s57, 12288
    s_cmp_eq_u32 s61, 5
    s_cselect_b32 s61, 0, s61
    s_cselect_b32 s69, 61440, 0
    s_sub_u32 s57, s57, s69
    s_add_u32 m0, s59, 16384
    s_add_u32 s69, s58, 163840
    buffer_load_dwordx4 v13, s[40:43], s69 offen lds
    s_add_u32 m0, s59, 17408
    s_add_u32 s69, s58, 174080
    buffer_load_dwordx4 v14, s[40:43], s69 offen lds
    s_add_u32 m0, s59, 18432
    s_add_u32 s69, s58, 184320
    buffer_load_dwordx4 v13, s[40:43], s69 offen lds
    s_add_u32 m0, s59, 19456
    s_add_u32 s69, s58, 194560
    buffer_load_dwordx4 v14, s[40:43], s69 offen lds
    s_add_u32 s58, s58, 128
    s_cmp_eq_u32 s58, s72
    s_cselect_b32 s58, s73, s58
    s_add_u32 s62, s62, 1
    s_add_u32 s59, s59, 32768
    s_cmp_eq_u32 s62, 3
    s_cselect_b32 s62, 0, s62
    s_cselect_b32 s69, 98304, 0
    s_sub_u32 s59, s59, s69
    s_waitcnt vmcnt(14)
    s_barrier
    s_add_u32 m0, s57, 0
    s_nop 0
    buffer_load_dwordx4 v10, s[44:47], s56 offen lds
    s_add_u32 m0, s57, 1024
    s_nop 0
    buffer_load_dwordx4 v11, s[44:47], s56 offen lds
    s_add_u32 m0, s57, 2048
    s_nop 0
    buffer_load_dwordx4 v12, s[44:47], s56 offen lds
    s_add_u32 s56, s56, s60
    s_cmp_eq_u32 s56, s71
    s_cselect_b32 s56, 0, s56
    s_add_u32 s61, s61, 1
    s_add_u32 s57, s57, 12288
    s_cmp_eq_u32 s61, 5
    s_cselect_b32 s61, 0, s61
    s_cselect_b32 s69, 61440, 0
    s_sub_u32 s57, s57, s69
    s_add_u32 m0, s59, 0
    s_add_u32 s69, s58, 0
    buffer_load_dwordx4 v13, s[40:43], s69 offen lds
    s_add_u32 m0, s59, 1024
    s_add_u32 s69, s58, 10240
    buffer_load_dwordx4 v14, s[40:43], s69 offen lds
    s_add_u32 m0, s59, 2048
    s_add_u32 s69, s58, 20480
    buffer_load_dwordx4 v13, s[40:43], s69 offen lds
    s_add_u32 m0, s59, 3072
    s_add_u32 s69, s58, 30720
    buffer_load_dwordx4 v14, s[40:43], s69 offen lds
    s_waitcnt vmcnt(14)
    s_barrier
    s_add_u32 m0, s57, 0
    s_nop 0
    buffer_load_dwordx4 v10, s[44:47], s56 offen lds
    s_add_u32 m0, s57, 1024
    s_nop 0
    buffer_load_dwordx4 v11, s[44:47], s56 offen lds
    s_add_u32 m0, s57, 2048
    s_nop 0
    buffer_load_dwordx4 v12, s[44:47], s56 offen lds
    s_add_u32 s56, s56, s60
    s_cmp_eq_u32 s56, s71
    s_cselect_b32 s56, 0, s56
    s_add_u32 s61, s61, 1
    s_add_u32 s57, s57, 12288
    s_cmp_eq_u32 s61, 5
    s_cselect_b32 s61, 0, s61
    s_cselect_b32 s69, 61440, 0
    s_sub_u32 s57, s57, s69
    s_add_u32 m0, s59, 16384
    s_add_u32 s69, s58, 163840
    buffer_load_dwordx4 v13, s[40:43], s69 offen lds
    s_add_u32 m0, s59, 17408
    s_add_u32 s69, s58, 174080
    buffer_load_dwordx4 v14, s[40:43], s69 offen lds
    s_add_u32 m0, s59, 18432
    s_add_u32 s69, s58, 184320
    buffer_load_dwordx4 v13, s[40:43], s69 offen lds
    s_add_u32 m0, s59, 19456
    s_add_u32 s69, s58, 194560
    buffer_load_dwordx4 v14, s[40:43], s69 offen lds
    s_add_u32 s58, s58, 128
    s_cmp_eq_u32 s58, s72
    s_cselect_b32 s58, s73, s58
    s_add_u32 s62, s62, 1
    s_add_u32 s59, s59, 32768
    s_cmp_eq_u32 s62, 3
    s_cselect_b32 s62, 0, s62
    s_cselect_b32 s69, 98304, 0
    s_sub_u32 s59, s59, s69
    s_waitcnt vmcnt(14)
    s_barrier
    s_add_u32 m0, s57, 0
    s_nop 0
    buffer_load_dwordx4 v10, s[44:47], s56 offen lds
    s_add_u32 m0, s57, 1024
    s_nop 0
    buffer_load_dwordx4 v11, s[44:47], s56 offen lds
    s_add_u32 m0, s57, 2048
    s_nop 0
    buffer_load_dwordx4 v12, s[44:47], s56 offen lds
    s_add_u32 s56, s56, s60
    s_cmp_eq_u32 s56, s71
    s_cselect_b32 s56, 0, s56
    s_add_u32 s61, s61, 1
    s_add_u32 s57, s57, 12288
    s_cmp_eq_u32 s61, 5
    s_cselect_b32 s61, 0, s61
    s_cselect_b32 s69, 61440, 0
    s_sub_u32 s57, s57, s69
    s_add_u32 m0, s59, 0
    s_add_u32 s69, s58, 0
    buffer_load_dwordx4 v13, s[40:43], s69 offen lds
    s_add_u32 m0, s59, 1024
    s_add_u32 s69, s58, 10240
    buffer_load_dwordx4 v14, s[40:43], s69 offen lds
    s_add_u32 m0, s59, 2048
    s_add_u32 s69, s58, 20480
    buffer_load_dwordx4 v13, s[40:43], s69 offen lds
    s_add_u32 m0, s59, 3072
    s_add_u32 s69, s58, 30720
    buffer_load_dwordx4 v14, s[40:43], s69 offen lds
    s_waitcnt vmcnt(14)
    s_barrier
    s_add_u32 m0, s57, 0
    s_nop 0
    buffer_load_dwordx4 v10, s[44:47], s56 offen lds
    s_add_u32 m0, s57, 1024
    s_nop 0
    buffer_load_dwordx4 v11, s[44:47], s56 offen lds
    s_add_u32 m0, s57, 2048
    s_nop 0
    buffer_load_dwordx4 v12, s[44:47], s56 offen lds
    s_add_u32 s56, s56, s60
    s_cmp_eq_u32 s56, s71
    s_cselect_b32 s56, 0, s56
    s_add_u32 s61, s61, 1
    s_add_u32 s57, s57, 12288
    s_cmp_eq_u32 s61, 5
    s_cselect_b32 s61, 0, s61
    s_cselect_b32 s69, 61440, 0
    s_sub_u32 s57, s57, s69
    s_add_u32 m0, s59, 16384
    s_add_u32 s69, s58, 163840
    buffer_load_dwordx4 v13, s[40:43], s69 offen lds
    s_add_u32 m0, s59, 17408
    s_add_u32 s69, s58, 174080
    buffer_load_dwordx4 v14, s[40:43], s69 offen lds
    s_add_u32 m0, s59, 18432
    s_add_u32 s69, s58, 184320
    buffer_load_dwordx4 v13, s[40:43], s69 offen lds
    s_add_u32 m0, s59, 19456
    s_add_u32 s69, s58, 194560
    buffer_load_dwordx4 v14, s[40:43], s69 offen lds
    s_add_u32 s58, s58, 128
    s_cmp_eq_u32 s58, s72
    s_cselect_b32 s58, s73, s58
    s_add_u32 s62, s62, 1
    s_add_u32 s59, s59, 32768
    s_cmp_eq_u32 s62, 3
    s_cselect_b32 s62, 0, s62
    s_cselect_b32 s69, 98304, 0
    s_sub_u32 s59, s59, s69
    s_waitcnt vmcnt(14)
    s_barrier
    s_add_u32 m0, s57, 0
    s_nop 0
    buffer_load_dwordx4 v10, s[44:47], s56 offen lds
    s_add_u32 m0, s57, 1024
    s_nop 0
    buffer_load_dwordx4 v11, s[44:47], s56 offen lds
    s_add_u32 m0, s57, 2048
    s_nop 0
    buffer_load_dwordx4 v12, s[44:47], s56 offen lds
    s_add_u32 s56, s56, s60
    s_cmp_eq_u32 s56, s71
    s_cselect_b32 s56, 0, s56
    s_add_u32 s61, s61, 1
    s_add_u32 s57, s57, 12288
    s_cmp_eq_u32 s61, 5
    s_cselect_b32 s61, 0, s61
    s_cselect_b32 s69, 61440, 0
    s_sub_u32 s57, s57, s69
    s_add_u32 m0, s59, 0
    s_add_u32 s69, s58, 0
    buffer_load_dwordx4 v13, s[40:43], s69 offen lds
    s_add_u32 m0, s59, 1024
    s_add_u32 s69, s58, 10240
    buffer_load_dwordx4 v14, s[40:43], s69 offen lds
    s_add_u32 m0, s59, 2048
    s_add_u32 s69, s58, 20480
    buffer_load_dwordx4 v13, s[40:43], s69 offen lds
    s_add_u32 m0, s59, 3072
    s_add_u32 s69, s58, 30720
    buffer_load_dwordx4 v14, s[40:43], s69 offen lds
    s_waitcnt vmcnt(14)
    s_barrier
    s_add_u32 m0, s57, 0
    s_nop 0
    buffer_load_dwordx4 v10, s[44:47], s56 offen lds
    s_add_u32 m0, s57, 1024
    s_nop 0
    buffer_load_dwordx4 v11, s[44:47], s56 offen lds
    s_add_u32 m0, s57, 2048
    s_nop 0
    buffer_load_dwordx4 v12, s[44:47], s56 offen lds
    s_add_u32 s56, s56, s60
    s_cmp_eq_u32 s56, s71
    s_cselect_b32 s56, 0, s56
    s_add_u32 s61, s61, 1
    s_add_u32 s57, s57, 12288
    s_cmp_eq_u32 s61, 5
    s_cselect_b32 s61, 0, s61
    s_cselect_b32 s69, 61440, 0
    s_sub_u32 s57, s57, s69
    s_add_u32 m0, s59, 16384
    s_add_u32 s69, s58, 163840
    buffer_load_dwordx4 v13, s[40:43], s69 offen lds
    s_add_u32 m0, s59, 17408
    s_add_u32 s69, s58, 174080
    buffer_load_dwordx4 v14, s[40:43], s69 offen lds
    s_add_u32 m0, s59, 18432
    s_add_u32 s69, s58, 184320
    buffer_load_dwordx4 v13, s[40:43], s69 offen lds
    s_add_u32 m0, s59, 19456
    s_add_u32 s69, s58, 194560
    buffer_load_dwordx4 v14, s[40:43], s69 offen lds
    s_add_u32 s58, s58, 128
    s_cmp_eq_u32 s58, s72
    s_cselect_b32 s58, s73, s58
    s_add_u32 s62, s62, 1
    s_add_u32 s59, s59, 32768
    s_cmp_eq_u32 s62, 3
    s_cselect_b32 s62, 0, s62
    s_cselect_b32 s69, 98304, 0
    s_sub_u32 s59, s59, s69
    v_readfirstlane_b32 s92, v5
    s_lshl_b32 s7, s90, 7
    s_add_u32 s7, s7, 8192
    v_lshlrev_b32 v7, 2, v0
    buffer_load_dword v8, v7, s[84:87], s7 offen sc1
    s_mul_i32 s8, s4, 14
    s_cmp_eq_u32 s4, 3
    s_cselect_b32 s9, 1, 0
    s_sub_u32 s8, s8, s9
    s_cmp_ge_u32 s4, 2
    s_cselect_b32 s76, 13, 14
    s_lshl_b32 s74, s88, 2
    s_mul_i32 s74, s74, 75
    s_add_u32 s74, s74, s8
    s_lshl_b32 s74, s74, 10
    s_mul_i32 s75, s89, 74
    s_add_u32 s75, s75, s8
    s_mul_i32 s75, s75, 5120
    s_mul_i32 s77, s89, 7
    s_lshr_b32 s77, s77, 2
    s_and_b32 s9, s88, 3
    s_mul_i32 s9, s9, 7
    s_lshr_b32 s9, s9, 1
    s_add_u32 s77, s77, s9
    s_cmp_ge_u32 s77, 14
    s_cselect_b32 s9, 14, 0
    s_sub_u32 s77, s77, s9
    s_add_u32 s48, s36, 0xa00400
    s_addc_u32 s49, s37, 0
    s_mov_b32 s50, 0x2e4000
    s_mov_b32 s51, 0x20000
    v_lshlrev_b32 v1, 4, v0
    v_add_u32 v2, 0x1000, v1
    s_waitcnt vmcnt(15)
    s_barrier
    s_add_u32 m0, s57, 0
    s_nop 0
    buffer_load_dwordx4 v10, s[44:47], s56 offen lds
    s_add_u32 m0, s57, 1024
    s_nop 0
    buffer_load_dwordx4 v11, s[44:47], s56 offen lds
    s_add_u32 m0, s57, 2048
    s_nop 0
    buffer_load_dwordx4 v12, s[44:47], s56 offen lds
    s_add_u32 s56, s56, s60
    s_cmp_eq_u32 s56, s71
    s_cselect_b32 s56, 0, s56
    s_add_u32 s61, s61, 1
    s_add_u32 s57, s57, 12288
    s_cmp_eq_u32 s61, 5
    s_cselect_b32 s61, 0, s61
    s_cselect_b32 s69, 61440, 0
    s_sub_u32 s57, s57, s69
    s_waitcnt vmcnt(3)
    s_cmp_lg_u32 s92, 0
    s_cbranch_scc1 L_ldT_have
    s_mov_b32 s80, s34
    s_mov_b32 s81, s35
    s_mov_b32 s82, 0x100
    s_mov_b32 s83, 0x20000
    v_mov_b32 v5, 0
L_ldT_T:
    buffer_load_dword v6, v5, s[80:83], 0 offen sc1
    s_waitcnt vmcnt(0)
    v_readfirstlane_b32 s92, v6
    s_nop 3
    s_cmp_lg_u32 s92, 0
    s_cbranch_scc1 L_ldT_Tok
    s_sleep 8
    s_branch L_ldT_T
L_ldT_Tok:
L_ldT_have:
    v_cmp_ne_u32 vcc, s92, v8
    s_nop 1
    s_and_b32 vcc_lo, vcc_lo, 0xffff
    s_cbranch_scc0 L_f4_fast
    v_lshlrev_b32 v7, 2, v0
    s_mov_b64 s[94:95], 0xffff
L_f4_poll:
    buffer_load_dword v8, v7, s[84:87], s7 offen sc1
    s_waitcnt vmcnt(0)
    v_cmp_ne_u32 vcc, s92, v8
    s_nop 1
    s_and_b64 vcc, vcc, s[94:95]
    s_cbranch_scc0 L_f4_ok
    s_sleep 8
    s_branch L_f4_poll
L_f4_ok:
L_f4_fast:
    s_waitcnt vmcnt(11)
    s_barrier
    s_add_u32 s79, s77, 0
    s_cmp_ge_u32 s79, 14
    s_cselect_b32 s78, 14, 0
    s_sub_u32 s79, s79, s78
    s_mul_i32 s78, s79, 5120
    s_add_u32 s78, s78, s75
    s_cmp_eq_u32 s79, s76
    s_cselect_b32 s78, 0x40000000, s78
    buffer_load_dwordx4 v[16:19], v1, s[48:51], s78 offen offset:0 sc1
    buffer_load_dwordx4 v[20:23], v1, s[48:51], s78 offen offset:1024 sc1
    buffer_load_dwordx4 v[24:27], v1, s[48:51], s78 offen offset:2048 sc1
    buffer_load_dwordx4 v[28:31], v1, s[48:51], s78 offen offset:3072 sc1
    buffer_load_dwordx4 v[32:35], v2, s[48:51], s78 offen sc1
    s_add_u32 s79, s77, 1
    s_cmp_ge_u32 s79, 14
    s_cselect_b32 s78, 14, 0
    s_sub_u32 s79, s79, s78
    s_mul_i32 s78, s79, 5120
    s_add_u32 s78, s78, s75
    s_cmp_eq_u32 s79, s76
    s_cselect_b32 s78, 0x40000000, s78
    buffer_load_dwordx4 v[36:39], v1, s[48:51], s78 offen offset:0 sc1
    buffer_load_dwordx4 v[40:43], v1, s[48:51], s78 offen offset:1024 sc1
    buffer_load_dwordx4 v[44:47], v1, s[48:51], s78 offen offset:2048 sc1
    buffer_load_dwordx4 v[48:51], v1, s[48:51], s78 offen offset:3072 sc1
    buffer_load_dwordx4 v[52:55], v2, s[48:51], s78 offen sc1
    s_waitcnt vmcnt(14)
    s_barrier
    s_add_u32 s79, s77, 2
    s_cmp_ge_u32 s79, 14
    s_cselect_b32 s78, 14, 0
    s_sub_u32 s79, s79, s78
    s_mul_i32 s78, s79, 5120
    s_add_u32 s78, s78, s75
    s_cmp_eq_u32 s79, s76
    s_cselect_b32 s78, 0x40000000, s78
    buffer_load_dwordx4 v[56:59], v1, s[48:51], s78 offen offset:0 sc1
    buffer_load_dwordx4 v[60:63], v1, s[48:51], s78 offen offset:1024 sc1
    buffer_load_dwordx4 v[64:67], v1, s[48:51], s78 offen offset:2048 sc1
    buffer_load_dwordx4 v[68:71], v1, s[48:51], s78 offen offset:3072 sc1
    buffer_load_dwordx4 v[72:75], v2, s[48:51], s78 offen sc1
    s_add_u32 s79, s77, 3
    s_cmp_ge_u32 s79, 14
    s_cselect_b32 s78, 14, 0
    s_sub_u32 s79, s79, s78
    s_mul_i32 s78, s79, 5120
    s_add_u32 s78, s78, s75
    s_cmp_eq_u32 s79, s76
    s_cselect_b32 s78, 0x40000000, s78
    buffer_load_dwordx4 v[76:79], v1, s[48:51], s78 offen offset:0 sc1
    buffer_load_dwordx4 v[80:83], v1, s[48:51], s78 offen offset:1024 sc1
    buffer_load_dwordx4 v[84:87], v1, s[48:51], s78 offen offset:2048 sc1
    buffer_load_dwordx4 v[88:91], v1, s[48:51], s78 offen offset:3072 sc1
    buffer_load_dwordx4 v[92:95], v2, s[48:51], s78 offen sc1
    s_waitcnt vmcnt(20)
    s_barrier
    s_add_u32 s79, s77, 4
    s_cmp_ge_u32 s79, 14
    s_cselect_b32 s78, 14, 0
    s_sub_u32 s79, s79, s78
    s_mul_i32 s78, s79, 5120
    s_add_u32 s78, s78, s75
    s_cmp_eq_u32 s79, s76
    s_cselect_b32 s78, 0x40000000, s78
    buffer_load_dwordx4 v[96:99], v1, s[48:51], s78 offen offset:0 sc1
    buffer_load_dwordx4 v[100:103], v1, s[48:51], s78 offen offset:1024 sc1
    buffer_load_dwordx4 v[104:107], v1, s[48:51], s78 offen offset:2048 sc1
    buffer_load_dwordx4 v[108:111], v1, s[48:51], s78 offen offset:3072 sc1
    buffer_load_dwordx4 v[112:115], v2, s[48:51], s78 offen sc1
    s_add_u32 s79, s77, 5
    s_cmp_ge_u32 s79, 14
    s_cselect_b32 s78, 14, 0
    s_sub_u32 s79, s79, s78
    s_mul_i32 s78, s79, 5120
    s_add_u32 s78, s78, s75
    s_cmp_eq_u32 s79, s76
    s_cselect_b32 s78, 0x40000000, s78
    buffer_load_dwordx4 v[116:119], v1, s[48:51], s78 offen offset:0 sc1
    buffer_load_dwordx4 v[120:123], v1, s[48:51], s78 offen offset:1024 sc1
    buffer_load_dwordx4 v[124:127], v1, s[48:51], s78 offen offset:2048 sc1
    buffer_load_dwordx4 v[128:131], v1, s[48:51], s78 offen offset:3072 sc1
    buffer_load_dwordx4 v[132:135], v2, s[48:51], s78 offen sc1
    s_barrier
    s_add_u32 s79, s77, 6
    s_cmp_ge_u32 s79, 14
    s_cselect_b32 s78, 14, 0
    s_sub_u32 s79, s79, s78
    s_mul_i32 s78, s79, 5120
    s_add_u32 s78, s78, s75
    s_cmp_eq_u32 s79, s76
    s_cselect_b32 s78, 0x40000000, s78
    buffer_load_dwordx4 v[136:139], v1, s[48:51], s78 offen offset:0 sc1
    buffer_load_dwordx4 v[140:143], v1, s[48:51], s78 offen offset:1024 sc1
    buffer_load_dwordx4 v[144:147], v1, s[48:51], s78 offen offset:2048 sc1
    buffer_load_dwordx4 v[148:151], v1, s[48:51], s78 offen offset:3072 sc1
    buffer_load_dwordx4 v[152:155], v2, s[48:51], s78 offen sc1
    s_add_u32 s79, s77, 7
    s_cmp_ge_u32 s79, 14
    s_cselect_b32 s78, 14, 0
    s_sub_u32 s79, s79, s78
    s_mul_i32 s78, s79, 5120
    s_add_u32 s78, s78, s75
    s_cmp_eq_u32 s79, s76
    s_cselect_b32 s78, 0x40000000, s78
    buffer_load_dwordx4 v[156:159], v1, s[48:51], s78 offen offset:0 sc1
    buffer_load_dwordx4 v[160:163], v1, s[48:51], s78 offen offset:1024 sc1
    buffer_load_dwordx4 v[164:167], v1, s[48:51], s78 offen offset:2048 sc1
    buffer_load_dwordx4 v[168:171], v1, s[48:51], s78 offen offset:3072 sc1
    buffer_load_dwordx4 v[172:175], v2, s[48:51], s78 offen sc1
    s_barrier
    s_add_u32 s79, s77, 8
    s_cmp_ge_u32 s79, 14
    s_cselect_b32 s78, 14, 0
    s_sub_u32 s79, s79, s78
    s_mul_i32 s78, s79, 5120
    s_add_u32 s78, s78, s75
    s_cmp_eq_u32 s79, s76
    s_cselect_b32 s78, 0x40000000, s78
    buffer_load_dwordx4 v[176:179], v1, s[48:51], s78 offen offset:0 sc1
    buffer_load_dwordx4 v[180:183], v1, s[48:51], s78 offen offset:1024 sc1
    buffer_load_dwordx4 v[184:187], v1, s[48:51], s78 offen offset:2048 sc1
    buffer_load_dwordx4 v[188:191], v1, s[48:51], s78 offen offset:3072 sc1
    buffer_load_dwordx4 v[192:195], v2, s[48:51], s78 offen sc1
    s_add_u32 s79, s77, 9
    s_cmp_ge_u32 s79, 14
    s_cselect_b32 s78, 14, 0
    s_sub_u32 s79, s79, s78
    s_mul_i32 s78, s79, 5120
    s_add_u32 s78, s78, s75
    s_cmp_eq_u32 s79, s76
    s_cselect_b32 s78, 0x40000000, s78
    buffer_load_dwordx4 v[196:199], v1, s[48:51], s78 offen offset:0 sc1
    buffer_load_dwordx4 v[200:203], v1, s[48:51], s78 offen offset:1024 sc1
    buffer_load_dwordx4 v[204:207], v1, s[48:51], s78 offen offset:2048 sc1
    buffer_load_dwordx4 v[208:211], v1, s[48:51], s78 offen offset:3072 sc1
    buffer_load_dwordx4 v[212:215], v2, s[48:51], s78 offen sc1
    s_add_u32 s79, s77, 10
    s_cmp_ge_u32 s79, 14
    s_cselect_b32 s78, 14, 0
    s_sub_u32 s79, s79, s78
    s_mul_i32 s78, s79, 5120
    s_add_u32 s78, s78, s75
    s_cmp_eq_u32 s79, s76
    s_cselect_b32 s78, 0x40000000, s78
    buffer_load_dwordx4 v[216:219], v1, s[48:51], s78 offen offset:0 sc1
    buffer_load_dwordx4 v[220:223], v1, s[48:51], s78 offen offset:1024 sc1
    buffer_load_dwordx4 v[224:227], v1, s[48:51], s78 offen offset:2048 sc1
    buffer_load_dwordx4 v[228:231], v1, s[48:51], s78 offen offset:3072 sc1
    buffer_load_dwordx4 v[232:235], v2, s[48:51], s78 offen sc1
    s_add_u32 s79, s77, 11
    s_cmp_ge_u32 s79, 14
    s_cselect_b32 s78, 14, 0
    s_sub_u32 s79, s79, s78
    s_mul_i32 s78, s79, 5120
    s_add_u32 s78, s78, s75
    s_cmp_eq_u32 s79, s76
    s_cselect_b32 s78, 0x40000000, s78
    buffer_load_dwordx4 v[236:239], v1, s[48:51], s78 offen offset:0 sc1
    buffer_load_dwordx4 v[240:243], v1, s[48:51], s78 offen offset:1024 sc1
    buffer_load_dwordx4 v[244:247], v1, s[48:51], s78 offen offset:2048 sc1
    buffer_load_dwordx4 v[248:251], v1, s[48:51], s78 offen offset:3072 sc1
    buffer_load_dwordx4 v[252:255], v2, s[48:51], s78 offen sc1
    s_branch L_p2_loader_entry
L_cons_ffn:
    v_and_b32 v7, 15, v0
    v_lshrrev_b32 v8, 4, v0
    v_lshrrev_b32 v9, 1, v7
    v_xor_b32 v9, v9, v8
    v_lshlrev_b32 v9, 4, v9
    v_lshl_add_u32 v9, v7, 7, v9
    s_lshl_b32 s4, s3, 13
    v_add_u32 v2, s4, v9
    v_xor_b32 v3, 64, v2
    v_lshrrev_b32 v9, 1, v8
    v_mul_u32_u24 v9, 0x1800, v9
    v_and_b32 v10, 1, v8
    v_mul_u32_u24 v10, 0x220, v10
    v_add_u32 v9, v9, v10
    v_bfe_u32 v10, v0, 2, 2
    v_lshl_add_u32 v9, v10, 6, v9
    v_and_b32 v10, 3, v0
    v_lshl_add_u32 v9, v10, 3, v9
    v_add_u32 v4, 0x18000, v9
    v_xor_b32 v5, 32, v4
    v_mov_b32 v64, 0
    v_mov_b32 v65, 0
    v_mov_b32 v66, 0
    v_mov_b32 v67, 0
    v_mov_b32 v68, 0
    v_mov_b32 v69, 0
    v_mov_b32 v70, 0
    v_mov_b32 v71, 0
    v_mov_b32 v72, 0
    v_mov_b32 v73, 0
    v_mov_b32 v74, 0
    v_mov_b32 v75, 0
    v_mov_b32 v76, 0
    v_mov_b32 v77, 0
    v_mov_b32 v78, 0
    v_mov_b32 v79, 0
    v_mov_b32 v80, 0
    v_mov_b32 v81, 0
    v_mov_b32 v82, 0
    v_mov_b32 v83, 0
    v_mov_b32 v84, 0
    v_mov_b32 v85, 0
    v_mov_b32 v86, 0
    v_mov_b32 v87, 0
    v_mov_b32 v88, 0
    v_mov_b32 v89, 0
    v_mov_b32 v90, 0
    v_mov_b32 v91, 0
    v_mov_b32 v92, 0
    v_mov_b32 v93, 0
    v_mov_b32 v94, 0
    v_mov_b32 v95, 0
    v_mov_b32 v96, 0
    v_mov_b32 v97, 0
    v_mov_b32 v98, 0
    v_mov_b32 v99, 0
    v_mov_b32 v100, 0
    v_mov_b32 v101, 0
    v_mov_b32 v102, 0
    v_mov_b32 v103, 0
    v_mov_b32 v104, 0
    v_mov_b32 v105, 0
    v_mov_b32 v106, 0
    v_mov_b32 v107, 0
    v_mov_b32 v108, 0
    v_mov_b32 v109, 0
    v_mov_b32 v110, 0
    v_mov_b32 v111, 0
    v_mov_b32 v112, 0
    v_mov_b32 v113, 0
    v_mov_b32 v114, 0
    v_mov_b32 v115, 0
    v_mov_b32 v116, 0
    v_mov_b32 v117, 0
    v_mov_b32 v118, 0
    v_mov_b32 v119, 0
    v_mov_b32 v120, 0
    v_mov_b32 v121, 0
    v_mov_b32 v122, 0
    v_mov_b32 v123, 0
    v_mov_b32 v124, 0
    v_mov_b32 v125, 0
    v_mov_b32 v126, 0
    v_mov_b32 v127, 0
    v_mov_b32 v128, 0
    v_mov_b32 v129, 0
    v_mov_b32 v130, 0
    v_mov_b32 v131, 0
    v_mov_b32 v132, 0
    v_mov_b32 v133, 0
    v_mov_b32 v134, 0
    v_mov_b32 v135, 0
    v_mov_b32 v136, 0
    v_mov_b32 v137, 0
    v_mov_b32 v138, 0
    v_mov_b32 v139, 0
    v_mov_b32 v140, 0
    v_mov_b32 v141, 0
    v_mov_b32 v142, 0
    v_mov_b32 v143, 0
    v_mov_b32 v144, 0
    v_mov_b32 v145, 0
    v_mov_b32 v146, 0
    v_mov_b32 v147, 0
    v_mov_b32 v148, 0
    v_mov_b32 v149, 0
    v_mov_b32 v150, 0
    v_mov_b32 v151, 0
    v_mov_b32 v152, 0
    v_mov_b32 v153, 0
    v_mov_b32 v154, 0
    v_mov_b32 v155, 0
    v_mov_b32 v156, 0
    v_mov_b32 v157, 0
    v_mov_b32 v158, 0
    v_mov_b32 v159, 0
    v_mov_b32 v160, 0
    v_mov_b32 v161, 0
    v_mov_b32 v162, 0
    v_mov_b32 v163, 0
    v_mov_b32 v164, 0
    v_mov_b32 v165, 0
    v_mov_b32 v166, 0
    v_mov_b32 v167, 0
    v_mov_b32 v168, 0
    v_mov_b32 v169, 0
    v_mov_b32 v170, 0
    v_mov_b32 v171, 0
    v_mov_b32 v172, 0
    v_mov_b32 v173, 0
    v_mov_b32 v174, 0
    v_mov_b32 v175, 0
    v_mov_b32 v176, 0
    v_mov_b32 v177, 0
    v_mov_b32 v178, 0
    v_mov_b32 v179, 0
    v_mov_b32 v180, 0
    v_mov_b32 v181, 0
    v_mov_b32 v182, 0
    v_mov_b32 v183, 0
    v_mov_b32 v184, 0
    v_mov_b32 v185, 0
    v_mov_b32 v186, 0
    v_mov_b32 v187, 0
    v_mov_b32 v188, 0
    v_mov_b32 v189, 0
    v_mov_b32 v190, 0
    v_mov_b32 v191, 0
    v_mov_b32 v192, 0
    v_mov_b32 v193, 0
    v_mov_b32 v194, 0
    v_mov_b32 v195, 0
    v_mov_b32 v196, 0
    v_mov_b32 v197, 0
    v_mov_b32 v198, 0
    v_mov_b32 v199, 0
    v_mov_b32 v200, 0
    v_mov_b32 v201, 0
    v_mov_b32 v202, 0
    v_mov_b32 v203, 0
    v_mov_b32 v204, 0
    v_mov_b32 v205, 0
    v_mov_b32 v206, 0
    v_mov_b32 v207, 0
    v_mov_b32 v208, 0
    v_mov_b32 v209, 0
    v_mov_b32 v210, 0
    v_mov_b32 v211, 0
    v_mov_b32 v212, 0
    v_mov_b32 v213, 0
    v_mov_b32 v214, 0
    v_mov_b32 v215, 0
    v_mov_b32 v216, 0
    v_mov_b32 v217, 0
    v_mov_b32 v218, 0
    v_mov_b32 v219, 0
    v_mov_b32 v220, 0
    v_mov_b32 v221, 0
    v_mov_b32 v222, 0
    v_mov_b32 v223, 0
    v_mov_b32 v224, 0
    v_mov_b32 v225, 0
    v_mov_b32 v226, 0
    v_mov_b32 v227, 0
    v_mov_b32 v228, 0
    v_mov_b32 v229, 0
    v_mov_b32 v230, 0
    v_mov_b32 v231, 0
    v_mov_b32 v232, 0
    v_mov_b32 v233, 0
    v_mov_b32 v234, 0
    v_mov_b32 v235, 0
    v_mov_b32 v236, 0
    v_mov_b32 v237, 0
    v_mov_b32 v238, 0
    v_mov_b32 v239, 0
    v_mov_b32 v240, 0
    v_mov_b32 v241, 0
    v_mov_b32 v242, 0
    v_mov_b32 v243, 0
    v_mov_b32 v244, 0
    v_mov_b32 v245, 0
    v_mov_b32 v246, 0
    v_mov_b32 v247, 0
    v_mov_b32 v248, 0
    v_mov_b32 v249, 0
    v_mov_b32 v250, 0
    v_mov_b32 v251, 0
    v_mov_b32 v252, 0
    v_mov_b32 v253, 0
    v_mov_b32 v254, 0
    v_mov_b32 v255, 0
    s_mov_b32 s61, 0
    s_mov_b32 s62, 0
    s_mov_b32 s63, 10
    s_mov_b32 s66, 0xffff4000
    s_mov_b32 s67, 12288
    s_mov_b32 s68, 0xffff0000
    s_mov_b32 s69, 32768
    s_mov_b32 s70, 0xbfb8aa3b
    s_mov_b32 s71, 0xbfb8aa3b
    s_mov_b32 s72, 1.0
    s_mov_b32 s73, 1.0
    s_mov_b32 s74, 0x3fb8aa3b
    s_mov_b32 s75, 0x3fb8aa3b
    s_mov_b32 s76, 0x358637bd
    s_mov_b32 s77, 0x358637bd
    s_cmp_lg_u32 s3, 0
    s_cbranch_scc1 L_cT_skip1
    s_mov_b32 s40, s34
    s_mov_b32 s41, s35
    s_mov_b32 s42, 0x100
    s_mov_b32 s43, 0x20000
    v_mov_b32 v7, 0
L_cT1_T:
    buffer_load_dword v8, v7, s[40:43], 0 offen sc1
    s_waitcnt vmcnt(0)
    v_readfirstlane_b32 s92, v8
    s_nop 3
    s_cmp_lg_u32 s92, 0
    s_cbranch_scc1 L_cT1_Tok
    s_sleep 8
    s_branch L_cT1_T
L_cT1_Tok:
L_cT_skip1:
    s_barrier
    ds_read_b128 v[16:19], v2 offset:0
    ds_read_b128 v[20:23], v2 offset:2048
    ds_read_b128 v[24:27], v2 offset:4096
    ds_read_b128 v[28:31], v2 offset:6144
    ds_read_b64_tr_b16 v[48:49], v4 offset:0
    ds_read_b64_tr_b16 v[50:51], v4 offset:256
    ds_read_b64_tr_b16 v[52:53], v5 offset:0
    ds_read_b64_tr_b16 v[54:55], v5 offset:256
    ds_read_b64_tr_b16 v[56:57], v4 offset:1024
    ds_read_b64_tr_b16 v[58:59], v4 offset:1280
    s_waitcnt lgkmcnt(0)
L_ffn_loop:
    s_waitcnt lgkmcnt(4)
    v_mfma_f32_16x16x32_bf16 v[64:67], v[48:51], v[16:19], v[64:67]
    s_add_u32 s61, s61, 1
    s_cmp_eq_u32 s61, 5
    v_mfma_f32_16x16x32_bf16 v[68:71], v[48:51], v[20:23], v[68:71]
    s_cselect_b32 s61, 0, s61
    s_cselect_b32 s64, s66, s67
    v_mfma_f32_16x16x32_bf16 v[72:75], v[48:51], v[24:27], v[72:75]
    ds_read_b64_tr_b16 v[60:61], v5 offset:1024
    v_mfma_f32_16x16x32_bf16 v[76:79], v[48:51], v[28:31], v[76:79]
    ds_read_b64_tr_b16 v[62:63], v5 offset:1280
    s_waitcnt lgkmcnt(4)
    v_mfma_f32_16x16x32_bf16 v[80:83], v[52:55], v[16:19], v[80:83]
    s_barrier
    s_add_u32 s62, s62, 1
    v_mfma_f32_16x16x32_bf16 v[84:87], v[52:55], v[20:23], v[84:87]
    s_cmp_eq_u32 s62, 3
    s_cselect_b32 s62, 0, s62
    v_mfma_f32_16x16x32_bf16 v[88:91], v[52:55], v[24:27], v[88:91]
    s_cselect_b32 s65, s68, s69
    ds_read_b64_tr_b16 v[48:49], v4 offset:2048
    v_mfma_f32_16x16x32_bf16 v[92:95], v[52:55], v[28:31], v[92:95]
    ds_read_b64_tr_b16 v[50:51], v4 offset:2304
    s_waitcnt lgkmcnt(4)
    v_mfma_f32_16x16x32_bf16 v[96:99], v[56:59], v[16:19], v[96:99]
    ds_read_b64_tr_b16 v[52:53], v5 offset:2048
    v_mfma_f32_16x16x32_bf16 v[100:103], v[56:59], v[20:23], v[100:103]
    ds_read_b64_tr_b16 v[54:55], v5 offset:2304
    v_mfma_f32_16x16x32_bf16 v[104:107], v[56:59], v[24:27], v[104:107]
    ds_read_b128 v[32:35], v3 offset:0
    v_mfma_f32_16x16x32_bf16 v[108:111], v[56:59], v[28:31], v[108:111]
    s_waitcnt lgkmcnt(5)
    v_mfma_f32_16x16x32_bf16 v[112:115], v[60:63], v[16:19], v[112:115]
    ds_read_b64_tr_b16 v[56:57], v4 offset:3072
    v_mfma_f32_16x16x32_bf16 v[116:119], v[60:63], v[20:23], v[116:119]
    ds_read_b64_tr_b16 v[58:59], v4 offset:3328
    v_mfma_f32_16x16x32_bf16 v[120:123], v[60:63], v[24:27], v[120:123]
    ds_read_b128 v[36:39], v3 offset:2048
    v_mfma_f32_16x16x32_bf16 v[124:127], v[60:63], v[28:31], v[124:127]
    s_waitcnt lgkmcnt(6)
    v_mfma_f32_16x16x32_bf16 v[128:131], v[48:51], v[16:19], v[128:131]
    ds_read_b64_tr_b16 v[60:61], v5 offset:3072
    v_mfma_f32_16x16x32_bf16 v[132:135], v[48:51], v[20:23], v[132:135]
    ds_read_b64_tr_b16 v[62:63], v5 offset:3328
    v_mfma_f32_16x16x32_bf16 v[136:139], v[48:51], v[24:27], v[136:139]
    ds_read_b128 v[40:43], v3 offset:4096
    v_mfma_f32_16x16x32_bf16 v[140:143], v[48:51], v[28:31], v[140:143]
    s_waitcnt lgkmcnt(7)
    v_mfma_f32_16x16x32_bf16 v[144:147], v[52:55], v[16:19], v[144:147]
    ds_read_b64_tr_b16 v[48:49], v4 offset:4096
    v_mfma_f32_16x16x32_bf16 v[148:151], v[52:55], v[20:23], v[148:151]
    ds_read_b64_tr_b16 v[50:51], v4 offset:4352
    v_mfma_f32_16x16x32_bf16 v[152:155], v[52:55], v[24:27], v[152:155]
    ds_read_b128 v[44:47], v3 offset:6144
    v_mfma_f32_16x16x32_bf16 v[156:159], v[52:55], v[28:31], v[156:159]
    s_waitcnt lgkmcnt(7)
    v_mfma_f32_16x16x32_bf16 v[160:163], v[56:59], v[16:19], v[160:163]
    ds_read_b64_tr_b16 v[52:53], v5 offset:4096
    v_mfma_f32_16x16x32_bf16 v[164:167], v[56:59], v[20:23], v[164:167]
    ds_read_b64_tr_b16 v[54:55], v5 offset:4352
    v_mfma_f32_16x16x32_bf16 v[168:171], v[56:59], v[24:27], v[168:171]
    v_add_u32 v3, s65, v3
    v_mfma_f32_16x16x32_bf16 v[172:175], v[56:59], v[28:31], v[172:175]
    s_waitcnt lgkmcnt(6)
    v_mfma_f32_16x16x32_bf16 v[176:179], v[60:63], v[16:19], v[176:179]
    ds_read_b64_tr_b16 v[56:57], v4 offset:5120
    v_mfma_f32_16x16x32_bf16 v[180:183], v[60:63], v[20:23], v[180:183]
    ds_read_b64_tr_b16 v[58:59], v4 offset:5376
    v_mfma_f32_16x16x32_bf16 v[184:187], v[60:63], v[24:27], v[184:187]
    v_mfma_f32_16x16x32_bf16 v[188:191], v[60:63], v[28:31], v[188:191]
    s_waitcnt lgkmcnt(5)
    v_mfma_f32_16x16x32_bf16 v[192:195], v[48:51], v[16:19], v[192:195]
    ds_read_b64_tr_b16 v[60:61], v5 offset:5120
    v_mfma_f32_16x16x32_bf16 v[196:199], v[48:51], v[20:23], v[196:199]
    ds_read_b64_tr_b16 v[62:63], v5 offset:5376
    v_mfma_f32_16x16x32_bf16 v[200:203], v[48:51], v[24:27], v[200:203]
    v_mfma_f32_16x16x32_bf16 v[204:207], v[48:51], v[28:31], v[204:207]
    s_waitcnt lgkmcnt(4)
    v_mfma_f32_16x16x32_bf16 v[208:211], v[52:55], v[16:19], v[208:211]
    v_add_u32 v4, s64, v4
    v_mfma_f32_16x16x32_bf16 v[212:215], v[52:55], v[20:23], v[212:215]
    v_add_u32 v5, s64, v5
    v_mfma_f32_16x16x32_bf16 v[216:219], v[52:55], v[24:27], v[216:219]
    ds_read_b64_tr_b16 v[48:49], v4 offset:0
    v_mfma_f32_16x16x32_bf16 v[220:223], v[52:55], v[28:31], v[220:223]
    ds_read_b64_tr_b16 v[50:51], v4 offset:256
    s_waitcnt lgkmcnt(4)
    v_mfma_f32_16x16x32_bf16 v[224:227], v[56:59], v[16:19], v[224:227]
    ds_read_b64_tr_b16 v[52:53], v5 offset:0
    v_mfma_f32_16x16x32_bf16 v[228:231], v[56:59], v[20:23], v[228:231]
    ds_read_b64_tr_b16 v[54:55], v5 offset:256
    v_mfma_f32_16x16x32_bf16 v[232:235], v[56:59], v[24:27], v[232:235]
    v_mfma_f32_16x16x32_bf16 v[236:239], v[56:59], v[28:31], v[236:239]
    s_waitcnt lgkmcnt(4)
    v_mfma_f32_16x16x32_bf16 v[240:243], v[60:63], v[16:19], v[240:243]
    ds_read_b64_tr_b16 v[56:57], v4 offset:1024
    v_mfma_f32_16x16x32_bf16 v[244:247], v[60:63], v[20:23], v[244:247]
    ds_read_b64_tr_b16 v[58:59], v4 offset:1280
    v_mfma_f32_16x16x32_bf16 v[248:251], v[60:63], v[24:27], v[248:251]
    v_mfma_f32_16x16x32_bf16 v[252:255], v[60:63], v[28:31], v[252:255]
    s_waitcnt lgkmcnt(4)
    v_mfma_f32_16x16x32_bf16 v[64:67], v[48:51], v[32:35], v[64:67]
    s_add_u32 s61, s61, 1
    s_cmp_eq_u32 s61, 5
    v_mfma_f32_16x16x32_bf16 v[68:71], v[48:51], v[36:39], v[68:71]
    s_cselect_b32 s61, 0, s61
    s_cselect_b32 s64, s66, s67
    v_mfma_f32_16x16x32_bf16 v[72:75], v[48:51], v[40:43], v[72:75]
    ds_read_b64_tr_b16 v[60:61], v5 offset:1024
    v_mfma_f32_16x16x32_bf16 v[76:79], v[48:51], v[44:47], v[76:79]
    ds_read_b64_tr_b16 v[62:63], v5 offset:1280
    s_waitcnt lgkmcnt(4)
    v_mfma_f32_16x16x32_bf16 v[80:83], v[52:55], v[32:35], v[80:83]
    s_barrier
    v_mfma_f32_16x16x32_bf16 v[84:87], v[52:55], v[36:39], v[84:87]
    v_add_u32 v2, s65, v2
    v_mfma_f32_16x16x32_bf16 v[88:91], v[52:55], v[40:43], v[88:91]
    ds_read_b64_tr_b16 v[48:49], v4 offset:2048
    v_mfma_f32_16x16x32_bf16 v[92:95], v[52:55], v[44:47], v[92:95]
    ds_read_b64_tr_b16 v[50:51], v4 offset:2304
    s_waitcnt lgkmcnt(4)
    v_mfma_f32_16x16x32_bf16 v[96:99], v[56:59], v[32:35], v[96:99]
    ds_read_b64_tr_b16 v[52:53], v5 offset:2048
    v_mfma_f32_16x16x32_bf16 v[100:103], v[56:59], v[36:39], v[100:103]
    ds_read_b64_tr_b16 v[54:55], v5 offset:2304
    v_mfma_f32_16x16x32_bf16 v[104:107], v[56:59], v[40:43], v[104:107]
    ds_read_b128 v[16:19], v2 offset:0
    v_mfma_f32_16x16x32_bf16 v[108:111], v[56:59], v[44:47], v[108:111]
    s_waitcnt lgkmcnt(5)
    v_mfma_f32_16x16x32_bf16 v[112:115], v[60:63], v[32:35], v[112:115]
    ds_read_b64_tr_b16 v[56:57], v4 offset:3072
    v_mfma_f32_16x16x32_bf16 v[116:119], v[60:63], v[36:39], v[116:119]
    ds_read_b64_tr_b16 v[58:59], v4 offset:3328
    v_mfma_f32_16x16x32_bf16 v[120:123], v[60:63], v[40:43], v[120:123]
    ds_read_b128 v[20:23], v2 offset:2048
    v_mfma_f32_16x16x32_bf16 v[124:127], v[60:63], v[44:47], v[124:127]
    s_waitcnt lgkmcnt(6)
    v_mfma_f32_16x16x32_bf16 v[128:131], v[48:51], v[32:35], v[128:131]
    ds_read_b64_tr_b16 v[60:61], v5 offset:3072
    v_mfma_f32_16x16x32_bf16 v[132:135], v[48:51], v[36:39], v[132:135]
    ds_read_b64_tr_b16 v[62:63], v5 offset:3328
    v_mfma_f32_16x16x32_bf16 v[136:139], v[48:51], v[40:43], v[136:139]
    ds_read_b128 v[24:27], v2 offset:4096
    v_mfma_f32_16x16x32_bf16 v[140:143], v[48:51], v[44:47], v[140:143]
    s_waitcnt lgkmcnt(7)
    v_mfma_f32_16x16x32_bf16 v[144:147], v[52:55], v[32:35], v[144:147]
    ds_read_b64_tr_b16 v[48:49], v4 offset:4096
    v_mfma_f32_16x16x32_bf16 v[148:151], v[52:55], v[36:39], v[148:151]
    ds_read_b64_tr_b16 v[50:51], v4 offset:4352
    v_mfma_f32_16x16x32_bf16 v[152:155], v[52:55], v[40:43], v[152:155]
    ds_read_b128 v[28:31], v2 offset:6144
    v_mfma_f32_16x16x32_bf16 v[156:159], v[52:55], v[44:47], v[156:159]
    s_waitcnt lgkmcnt(7)
    v_mfma_f32_16x16x32_bf16 v[160:163], v[56:59], v[32:35], v[160:163]
    ds_read_b64_tr_b16 v[52:53], v5 offset:4096
    v_mfma_f32_16x16x32_bf16 v[164:167], v[56:59], v[36:39], v[164:167]
    ds_read_b64_tr_b16 v[54:55], v5 offset:4352
    v_mfma_f32_16x16x32_bf16 v[168:171], v[56:59], v[40:43], v[168:171]
    v_mfma_f32_16x16x32_bf16 v[172:175], v[56:59], v[44:47], v[172:175]
    s_waitcnt lgkmcnt(6)
    v_mfma_f32_16x16x32_bf16 v[176:179], v[60:63], v[32:35], v[176:179]
    ds_read_b64_tr_b16 v[56:57], v4 offset:5120
    v_mfma_f32_16x16x32_bf16 v[180:183], v[60:63], v[36:39], v[180:183]
    ds_read_b64_tr_b16 v[58:59], v4 offset:5376
    v_mfma_f32_16x16x32_bf16 v[184:187], v[60:63], v[40:43], v[184:187]
    v_mfma_f32_16x16x32_bf16 v[188:191], v[60:63], v[44:47], v[188:191]
    s_waitcnt lgkmcnt(5)
    v_mfma_f32_16x16x32_bf16 v[192:195], v[48:51], v[32:35], v[192:195]
    ds_read_b64_tr_b16 v[60:61], v5 offset:5120
    v_mfma_f32_16x16x32_bf16 v[196:199], v[48:51], v[36:39], v[196:199]
    ds_read_b64_tr_b16 v[62:63], v5 offset:5376
    v_mfma_f32_16x16x32_bf16 v[200:203], v[48:51], v[40:43], v[200:203]
    v_mfma_f32_16x16x32_bf16 v[204:207], v[48:51], v[44:47], v[204:207]
    s_waitcnt lgkmcnt(4)
    v_mfma_f32_16x16x32_bf16 v[208:211], v[52:55], v[32:35], v[208:211]
    v_add_u32 v4, s64, v4
    v_mfma_f32_16x16x32_bf16 v[212:215], v[52:55], v[36:39], v[212:215]
    v_add_u32 v5, s64, v5
    v_mfma_f32_16x16x32_bf16 v[216:219], v[52:55], v[40:43], v[216:219]
    ds_read_b64_tr_b16 v[48:49], v4 offset:0
    v_mfma_f32_16x16x32_bf16 v[220:223], v[52:55], v[44:47], v[220:223]
    ds_read_b64_tr_b16 v[50:51], v4 offset:256
    s_waitcnt lgkmcnt(4)
    v_mfma_f32_16x16x32_bf16 v[224:227], v[56:59], v[32:35], v[224:227]
    ds_read_b64_tr_b16 v[52:53], v5 offset:0
    v_mfma_f32_16x16x32_bf16 v[228:231], v[56:59], v[36:39], v[228:231]
    ds_read_b64_tr_b16 v[54:55], v5 offset:256
    v_mfma_f32_16x16x32_bf16 v[232:235], v[56:59], v[40:43], v[232:235]
    v_mfma_f32_16x16x32_bf16 v[236:239], v[56:59], v[44:47], v[236:239]
    s_waitcnt lgkmcnt(4)
    v_mfma_f32_16x16x32_bf16 v[240:243], v[60:63], v[32:35], v[240:243]
    ds_read_b64_tr_b16 v[56:57], v4 offset:1024
    v_mfma_f32_16x16x32_bf16 v[244:247], v[60:63], v[36:39], v[244:247]
    ds_read_b64_tr_b16 v[58:59], v4 offset:1280
    v_mfma_f32_16x16x32_bf16 v[248:251], v[60:63], v[40:43], v[248:251]
    v_mfma_f32_16x16x32_bf16 v[252:255], v[60:63], v[44:47], v[252:255]
    s_sub_u32 s63, s63, 1
    s_cmp_lg_u32 s63, 0
    s_cbranch_scc1 L_ffn_loop
    s_waitcnt lgkmcnt(0)
    s_barrier
    s_nop 7
    s_mov_b32 s44, s36
    s_mov_b32 s45, s37
    s_mov_b32 s46, 0x960000
    s_mov_b32 s47, 0x20000
    s_lshl_b32 s4, s52, 4
    s_lshl_b32 s5, s3, 2
    s_add_u32 s4, s4, s5
    s_mul_i32 s4, s4, 75
    s_mul_i32 s5, s53, 3
    s_add_u32 s4, s4, s5
    s_add_u32 s4, s4, 0
    s_lshl_b32 s80, s4, 10
    s_add_u32 s81, s80, 76800
    s_add_u32 s82, s80, 153600
    s_add_u32 s83, s80, 230400
    v_lshlrev_b32 v7, 4, v0
    v_pk_mul_f32 v[64:65], v[64:65], s[70:71]
    v_pk_mul_f32 v[66:67], v[66:67], s[70:71]
    v_pk_mul_f32 v[80:81], v[80:81], s[70:71]
    v_pk_mul_f32 v[82:83], v[82:83], s[70:71]
    v_exp_f32 v64, v64
    v_exp_f32 v65, v65
    v_exp_f32 v66, v66
    v_exp_f32 v67, v67
    v_exp_f32 v80, v80
    v_exp_f32 v81, v81
    v_exp_f32 v82, v82
    v_exp_f32 v83, v83
    v_pk_add_f32 v[64:65], v[64:65], s[72:73]
    v_pk_add_f32 v[66:67], v[66:67], s[72:73]
    v_pk_add_f32 v[80:81], v[80:81], s[72:73]
    v_pk_add_f32 v[82:83], v[82:83], s[72:73]
    v_rcp_f32 v64, v64
    v_rcp_f32 v65, v65
    v_rcp_f32 v66, v66
    v_rcp_f32 v67, v67
    v_rcp_f32 v80, v80
    v_rcp_f32 v81, v81
    v_rcp_f32 v82, v82
    v_rcp_f32 v83, v83
    v_pk_mul_f32 v[160:161], v[160:161], v[64:65]
    v_pk_mul_f32 v[162:163], v[162:163], v[66:67]
    v_pk_mul_f32 v[176:177], v[176:177], v[80:81]
    v_pk_mul_f32 v[178:179], v[178:179], v[82:83]
    v_cvt_pk_bf16_f32 v64, v160, v161
    v_cvt_pk_bf16_f32 v65, v162, v163
    v_cvt_pk_bf16_f32 v66, v176, v177
    v_cvt_pk_bf16_f32 v67, v178, v179
    buffer_store_dwordx4 v[64:67], v7, s[44:47], s80 offen offset:0 sc1
    v_pk_mul_f32 v[96:97], v[96:97], s[70:71]
    v_pk_mul_f32 v[98:99], v[98:99], s[70:71]
    v_pk_mul_f32 v[112:113], v[112:113], s[70:71]
    v_pk_mul_f32 v[114:115], v[114:115], s[70:71]
    v_exp_f32 v96, v96
    v_exp_f32 v97, v97
    v_exp_f32 v98, v98
    v_exp_f32 v99, v99
    v_exp_f32 v112, v112
    v_exp_f32 v113, v113
    v_exp_f32 v114, v114
    v_exp_f32 v115, v115
    v_pk_add_f32 v[96:97], v[96:97], s[72:73]
    v_pk_add_f32 v[98:99], v[98:99], s[72:73]
    v_pk_add_f32 v[112:113], v[112:113], s[72:73]
    v_pk_add_f32 v[114:115], v[114:115], s[72:73]
    v_rcp_f32 v96, v96
    v_rcp_f32 v97, v97
    v_rcp_f32 v98, v98
    v_rcp_f32 v99, v99
    v_rcp_f32 v112, v112
    v_rcp_f32 v113, v113
    v_rcp_f32 v114, v114
    v_rcp_f32 v115, v115
    v_pk_mul_f32 v[192:193], v[192:193], v[96:97]
    v_pk_mul_f32 v[194:195], v[194:195], v[98:99]
    v_pk_mul_f32 v[208:209], v[208:209], v[112:113]
    v_pk_mul_f32 v[210:211], v[210:211], v[114:115]
    v_cvt_pk_bf16_f32 v96, v192, v193
    v_cvt_pk_bf16_f32 v97, v194, v195
    v_cvt_pk_bf16_f32 v98, v208, v209
    v_cvt_pk_bf16_f32 v99, v210, v211
    buffer_store_dwordx4 v[96:99], v7, s[44:47], s80 offen offset:1024 sc1
    v_pk_mul_f32 v[128:129], v[128:129], s[70:71]
    v_pk_mul_f32 v[130:131], v[130:131], s[70:71]
    v_pk_mul_f32 v[144:145], v[144:145], s[70:71]
    v_pk_mul_f32 v[146:147], v[146:147], s[70:71]
    v_exp_f32 v128, v128
    v_exp_f32 v129, v129
    v_exp_f32 v130, v130
    v_exp_f32 v131, v131
    v_exp_f32 v144, v144
    v_exp_f32 v145, v145
    v_exp_f32 v146, v146
    v_exp_f32 v147, v147
    v_pk_add_f32 v[128:129], v[128:129], s[72:73]
    v_pk_add_f32 v[130:131], v[130:131], s[72:73]
    v_pk_add_f32 v[144:145], v[144:145], s[72:73]
    v_pk_add_f32 v[146:147], v[146:147], s[72:73]
    v_rcp_f32 v128, v128
    v_rcp_f32 v129, v129
    v_rcp_f32 v130, v130
    v_rcp_f32 v131, v131
    v_rcp_f32 v144, v144
    v_rcp_f32 v145, v145
    v_rcp_f32 v146, v146
    v_rcp_f32 v147, v147
    v_pk_mul_f32 v[224:225], v[224:225], v[128:129]
    v_pk_mul_f32 v[226:227], v[226:227], v[130:131]
    v_pk_mul_f32 v[240:241], v[240:241], v[144:145]
    v_pk_mul_f32 v[242:243], v[242:243], v[146:147]
    v_cvt_pk_bf16_f32 v128, v224, v225
    v_cvt_pk_bf16_f32 v129, v226, v227
    v_cvt_pk_bf16_f32 v130, v240, v241
    v_cvt_pk_bf16_f32 v131, v242, v243
    buffer_store_dwordx4 v[128:131], v7, s[44:47], s80 offen offset:2048 sc1
    v_pk_mul_f32 v[68:69], v[68:69], s[70:71]
    v_pk_mul_f32 v[70:71], v[70:71], s[70:71]
    v_pk_mul_f32 v[84:85], v[84:85], s[70:71]
    v_pk_mul_f32 v[86:87], v[86:87], s[70:71]
    v_exp_f32 v68, v68
    v_exp_f32 v69, v69
    v_exp_f32 v70, v70
    v_exp_f32 v71, v71
    v_exp_f32 v84, v84
    v_exp_f32 v85, v85
    v_exp_f32 v86, v86
    v_exp_f32 v87, v87
    v_pk_add_f32 v[68:69], v[68:69], s[72:73]
    v_pk_add_f32 v[70:71], v[70:71], s[72:73]
    v_pk_add_f32 v[84:85], v[84:85], s[72:73]
    v_pk_add_f32 v[86:87], v[86:87], s[72:73]
    v_rcp_f32 v68, v68
    v_rcp_f32 v69, v69
    v_rcp_f32 v70, v70
    v_rcp_f32 v71, v71
    v_rcp_f32 v84, v84
    v_rcp_f32 v85, v85
    v_rcp_f32 v86, v86
    v_rcp_f32 v87, v87
    v_pk_mul_f32 v[164:165], v[164:165], v[68:69]
    v_pk_mul_f32 v[166:167], v[166:167], v[70:71]
    v_pk_mul_f32 v[180:181], v[180:181], v[84:85]
    v_pk_mul_f32 v[182:183], v[182:183], v[86:87]
    v_cvt_pk_bf16_f32 v68, v164, v165
    v_cvt_pk_bf16_f32 v69, v166, v167
    v_cvt_pk_bf16_f32 v70, v180, v181
    v_cvt_pk_bf16_f32 v71, v182, v183
    buffer_store_dwordx4 v[68:71], v7, s[44:47], s81 offen offset:0 sc1
    v_pk_mul_f32 v[100:101], v[100:101], s[70:71]
    v_pk_mul_f32 v[102:103], v[102:103], s[70:71]
    v_pk_mul_f32 v[116:117], v[116:117], s[70:71]
    v_pk_mul_f32 v[118:119], v[118:119], s[70:71]
    v_exp_f32 v100, v100
    v_exp_f32 v101, v101
    v_exp_f32 v102, v102
    v_exp_f32 v103, v103
    v_exp_f32 v116, v116
    v_exp_f32 v117, v117
    v_exp_f32 v118, v118
    v_exp_f32 v119, v119
    v_pk_add_f32 v[100:101], v[100:101], s[72:73]
    v_pk_add_f32 v[102:103], v[102:103], s[72:73]
    v_pk_add_f32 v[116:117], v[116:117], s[72:73]
    v_pk_add_f32 v[118:119], v[118:119], s[72:73]
    v_rcp_f32 v100, v100
    v_rcp_f32 v101, v101
    v_rcp_f32 v102, v102
    v_rcp_f32 v103, v103
    v_rcp_f32 v116, v116
    v_rcp_f32 v117, v117
    v_rcp_f32 v118, v118
    v_rcp_f32 v119, v119
    v_pk_mul_f32 v[196:197], v[196:197], v[100:101]
    v_pk_mul_f32 v[198:199], v[198:199], v[102:103]
    v_pk_mul_f32 v[212:213], v[212:213], v[116:117]
    v_pk_mul_f32 v[214:215], v[214:215], v[118:119]
    v_cvt_pk_bf16_f32 v100, v196, v197
    v_cvt_pk_bf16_f32 v101, v198, v199
    v_cvt_pk_bf16_f32 v102, v212, v213
    v_cvt_pk_bf16_f32 v103, v214, v215
    buffer_store_dwordx4 v[100:103], v7, s[44:47], s81 offen offset:1024 sc1
    v_pk_mul_f32 v[132:133], v[132:133], s[70:71]
    v_pk_mul_f32 v[134:135], v[134:135], s[70:71]
    v_pk_mul_f32 v[148:149], v[148:149], s[70:71]
    v_pk_mul_f32 v[150:151], v[150:151], s[70:71]
    v_exp_f32 v132, v132
    v_exp_f32 v133, v133
    v_exp_f32 v134, v134
    v_exp_f32 v135, v135
    v_exp_f32 v148, v148
    v_exp_f32 v149, v149
    v_exp_f32 v150, v150
    v_exp_f32 v151, v151
    v_pk_add_f32 v[132:133], v[132:133], s[72:73]
    v_pk_add_f32 v[134:135], v[134:135], s[72:73]
    v_pk_add_f32 v[148:149], v[148:149], s[72:73]
    v_pk_add_f32 v[150:151], v[150:151], s[72:73]
    v_rcp_f32 v132, v132
    v_rcp_f32 v133, v133
    v_rcp_f32 v134, v134
    v_rcp_f32 v135, v135
    v_rcp_f32 v148, v148
    v_rcp_f32 v149, v149
    v_rcp_f32 v150, v150
    v_rcp_f32 v151, v151
    v_pk_mul_f32 v[228:229], v[228:229], v[132:133]
    v_pk_mul_f32 v[230:231], v[230:231], v[134:135]
    v_pk_mul_f32 v[244:245], v[244:245], v[148:149]
    v_pk_mul_f32 v[246:247], v[246:247], v[150:151]
    v_cvt_pk_bf16_f32 v132, v228, v229
    v_cvt_pk_bf16_f32 v133, v230, v231
    v_cvt_pk_bf16_f32 v134, v244, v245
    v_cvt_pk_bf16_f32 v135, v246, v247
    buffer_store_dwordx4 v[132:135], v7, s[44:47], s81 offen offset:2048 sc1
    v_pk_mul_f32 v[72:73], v[72:73], s[70:71]
    v_pk_mul_f32 v[74:75], v[74:75], s[70:71]
    v_pk_mul_f32 v[88:89], v[88:89], s[70:71]
    v_pk_mul_f32 v[90:91], v[90:91], s[70:71]
    v_exp_f32 v72, v72
    v_exp_f32 v73, v73
    v_exp_f32 v74, v74
    v_exp_f32 v75, v75
    v_exp_f32 v88, v88
    v_exp_f32 v89, v89
    v_exp_f32 v90, v90
    v_exp_f32 v91, v91
    v_pk_add_f32 v[72:73], v[72:73], s[72:73]
    v_pk_add_f32 v[74:75], v[74:75], s[72:73]
    v_pk_add_f32 v[88:89], v[88:89], s[72:73]
    v_pk_add_f32 v[90:91], v[90:91], s[72:73]
    v_rcp_f32 v72, v72
    v_rcp_f32 v73, v73
    v_rcp_f32 v74, v74
    v_rcp_f32 v75, v75
    v_rcp_f32 v88, v88
    v_rcp_f32 v89, v89
    v_rcp_f32 v90, v90
    v_rcp_f32 v91, v91
    v_pk_mul_f32 v[168:169], v[168:169], v[72:73]
    v_pk_mul_f32 v[170:171], v[170:171], v[74:75]
    v_pk_mul_f32 v[184:185], v[184:185], v[88:89]
    v_pk_mul_f32 v[186:187], v[186:187], v[90:91]
    v_cvt_pk_bf16_f32 v72, v168, v169
    v_cvt_pk_bf16_f32 v73, v170, v171
    v_cvt_pk_bf16_f32 v74, v184, v185
    v_cvt_pk_bf16_f32 v75, v186, v187
    buffer_store_dwordx4 v[72:75], v7, s[44:47], s82 offen offset:0 sc1
    v_pk_mul_f32 v[104:105], v[104:105], s[70:71]
    v_pk_mul_f32 v[106:107], v[106:107], s[70:71]
    v_pk_mul_f32 v[120:121], v[120:121], s[70:71]
    v_pk_mul_f32 v[122:123], v[122:123], s[70:71]
    v_exp_f32 v104, v104
    v_exp_f32 v105, v105
    v_exp_f32 v106, v106
    v_exp_f32 v107, v107
    v_exp_f32 v120, v120
    v_exp_f32 v121, v121
    v_exp_f32 v122, v122
    v_exp_f32 v123, v123
    v_pk_add_f32 v[104:105], v[104:105], s[72:73]
    v_pk_add_f32 v[106:107], v[106:107], s[72:73]
    v_pk_add_f32 v[120:121], v[120:121], s[72:73]
    v_pk_add_f32 v[122:123], v[122:123], s[72:73]
    v_rcp_f32 v104, v104
    v_rcp_f32 v105, v105
    v_rcp_f32 v106, v106
    v_rcp_f32 v107, v107
    v_rcp_f32 v120, v120
    v_rcp_f32 v121, v121
    v_rcp_f32 v122, v122
    v_rcp_f32 v123, v123
    v_pk_mul_f32 v[200:201], v[200:201], v[104:105]
    v_pk_mul_f32 v[202:203], v[202:203], v[106:107]
    v_pk_mul_f32 v[216:217], v[216:217], v[120:121]
    v_pk_mul_f32 v[218:219], v[218:219], v[122:123]
    v_cvt_pk_bf16_f32 v104, v200, v201
    v_cvt_pk_bf16_f32 v105, v202, v203
    v_cvt_pk_bf16_f32 v106, v216, v217
    v_cvt_pk_bf16_f32 v107, v218, v219
    buffer_store_dwordx4 v[104:107], v7, s[44:47], s82 offen offset:1024 sc1
    v_pk_mul_f32 v[136:137], v[136:137], s[70:71]
    v_pk_mul_f32 v[138:139], v[138:139], s[70:71]
    v_pk_mul_f32 v[152:153], v[152:153], s[70:71]
    v_pk_mul_f32 v[154:155], v[154:155], s[70:71]
    v_exp_f32 v136, v136
    v_exp_f32 v137, v137
    v_exp_f32 v138, v138
    v_exp_f32 v139, v139
    v_exp_f32 v152, v152
    v_exp_f32 v153, v153
    v_exp_f32 v154, v154
    v_exp_f32 v155, v155
    v_pk_add_f32 v[136:137], v[136:137], s[72:73]
    v_pk_add_f32 v[138:139], v[138:139], s[72:73]
    v_pk_add_f32 v[152:153], v[152:153], s[72:73]
    v_pk_add_f32 v[154:155], v[154:155], s[72:73]
    v_rcp_f32 v136, v136
    v_rcp_f32 v137, v137
    v_rcp_f32 v138, v138
    v_rcp_f32 v139, v139
    v_rcp_f32 v152, v152
    v_rcp_f32 v153, v153
    v_rcp_f32 v154, v154
    v_rcp_f32 v155, v155
    v_pk_mul_f32 v[232:233], v[232:233], v[136:137]
    v_pk_mul_f32 v[234:235], v[234:235], v[138:139]
    v_pk_mul_f32 v[248:249], v[248:249], v[152:153]
    v_pk_mul_f32 v[250:251], v[250:251], v[154:155]
    v_cvt_pk_bf16_f32 v136, v232, v233
    v_cvt_pk_bf16_f32 v137, v234, v235
    v_cvt_pk_bf16_f32 v138, v248, v249
    v_cvt_pk_bf16_f32 v139, v250, v251
    buffer_store_dwordx4 v[136:139], v7, s[44:47], s82 offen offset:2048 sc1
    v_pk_mul_f32 v[76:77], v[76:77], s[70:71]
    v_pk_mul_f32 v[78:79], v[78:79], s[70:71]
    v_pk_mul_f32 v[92:93], v[92:93], s[70:71]
    v_pk_mul_f32 v[94:95], v[94:95], s[70:71]
    v_exp_f32 v76, v76
    v_exp_f32 v77, v77
    v_exp_f32 v78, v78
    v_exp_f32 v79, v79
    v_exp_f32 v92, v92
    v_exp_f32 v93, v93
    v_exp_f32 v94, v94
    v_exp_f32 v95, v95
    v_pk_add_f32 v[76:77], v[76:77], s[72:73]
    v_pk_add_f32 v[78:79], v[78:79], s[72:73]
    v_pk_add_f32 v[92:93], v[92:93], s[72:73]
    v_pk_add_f32 v[94:95], v[94:95], s[72:73]
    v_rcp_f32 v76, v76
    v_rcp_f32 v77, v77
    v_rcp_f32 v78, v78
    v_rcp_f32 v79, v79
    v_rcp_f32 v92, v92
    v_rcp_f32 v93, v93
    v_rcp_f32 v94, v94
    v_rcp_f32 v95, v95
    v_pk_mul_f32 v[172:173], v[172:173], v[76:77]
    v_pk_mul_f32 v[174:175], v[174:175], v[78:79]
    v_pk_mul_f32 v[188:189], v[188:189], v[92:93]
    v_pk_mul_f32 v[190:191], v[190:191], v[94:95]
    v_cvt_pk_bf16_f32 v76, v172, v173
    v_cvt_pk_bf16_f32 v77, v174, v175
    v_cvt_pk_bf16_f32 v78, v188, v189
    v_cvt_pk_bf16_f32 v79, v190, v191
    buffer_store_dwordx4 v[76:79], v7, s[44:47], s83 offen offset:0 sc1
    v_pk_mul_f32 v[108:109], v[108:109], s[70:71]
    v_pk_mul_f32 v[110:111], v[110:111], s[70:71]
    v_pk_mul_f32 v[124:125], v[124:125], s[70:71]
    v_pk_mul_f32 v[126:127], v[126:127], s[70:71]
    v_exp_f32 v108, v108
    v_exp_f32 v109, v109
    v_exp_f32 v110, v110
    v_exp_f32 v111, v111
    v_exp_f32 v124, v124
    v_exp_f32 v125, v125
    v_exp_f32 v126, v126
    v_exp_f32 v127, v127
    v_pk_add_f32 v[108:109], v[108:109], s[72:73]
    v_pk_add_f32 v[110:111], v[110:111], s[72:73]
    v_pk_add_f32 v[124:125], v[124:125], s[72:73]
    v_pk_add_f32 v[126:127], v[126:127], s[72:73]
    v_rcp_f32 v108, v108
    v_rcp_f32 v109, v109
    v_rcp_f32 v110, v110
    v_rcp_f32 v111, v111
    v_rcp_f32 v124, v124
    v_rcp_f32 v125, v125
    v_rcp_f32 v126, v126
    v_rcp_f32 v127, v127
    v_pk_mul_f32 v[204:205], v[204:205], v[108:109]
    v_pk_mul_f32 v[206:207], v[206:207], v[110:111]
    v_pk_mul_f32 v[220:221], v[220:221], v[124:125]
    v_pk_mul_f32 v[222:223], v[222:223], v[126:127]
    v_cvt_pk_bf16_f32 v108, v204, v205
    v_cvt_pk_bf16_f32 v109, v206, v207
    v_cvt_pk_bf16_f32 v110, v220, v221
    v_cvt_pk_bf16_f32 v111, v222, v223
    buffer_store_dwordx4 v[108:111], v7, s[44:47], s83 offen offset:1024 sc1
    v_pk_mul_f32 v[140:141], v[140:141], s[70:71]
    v_pk_mul_f32 v[142:143], v[142:143], s[70:71]
    v_pk_mul_f32 v[156:157], v[156:157], s[70:71]
    v_pk_mul_f32 v[158:159], v[158:159], s[70:71]
    v_exp_f32 v140, v140
    v_exp_f32 v141, v141
    v_exp_f32 v142, v142
    v_exp_f32 v143, v143
    v_exp_f32 v156, v156
    v_exp_f32 v157, v157
    v_exp_f32 v158, v158
    v_exp_f32 v159, v159
    v_pk_add_f32 v[140:141], v[140:141], s[72:73]
    v_pk_add_f32 v[142:143], v[142:143], s[72:73]
    v_pk_add_f32 v[156:157], v[156:157], s[72:73]
    v_pk_add_f32 v[158:159], v[158:159], s[72:73]
    v_rcp_f32 v140, v140
    v_rcp_f32 v141, v141
    v_rcp_f32 v142, v142
    v_rcp_f32 v143, v143
    v_rcp_f32 v156, v156
    v_rcp_f32 v157, v157
    v_rcp_f32 v158, v158
    v_rcp_f32 v159, v159
    v_pk_mul_f32 v[236:237], v[236:237], v[140:141]
    v_pk_mul_f32 v[238:239], v[238:239], v[142:143]
    v_pk_mul_f32 v[252:253], v[252:253], v[156:157]
    v_pk_mul_f32 v[254:255], v[254:255], v[158:159]
    v_cvt_pk_bf16_f32 v140, v236, v237
    v_cvt_pk_bf16_f32 v141, v238, v239
    v_cvt_pk_bf16_f32 v142, v252, v253
    v_cvt_pk_bf16_f32 v143, v254, v255
    buffer_store_dwordx4 v[140:143], v7, s[44:47], s83 offen offset:2048 sc1
    s_mov_b32 s49, 1
    s_lshl_b32 s4, s52, 7
    s_lshl_b32 s5, s53, 2
    s_add_u32 s4, s4, s5
    s_add_u32 s55, s4, 0
    s_branch L_p2_main_entry
L_cons_q:
    v_and_b32 v7, 15, v0
    v_lshrrev_b32 v8, 4, v0
    v_lshrrev_b32 v9, 1, v7
    v_xor_b32 v9, v9, v8
    v_lshlrev_b32 v9, 4, v9
    v_lshl_add_u32 v9, v7, 7, v9
    s_lshl_b32 s4, s3, 13
    v_add_u32 v2, s4, v9
    v_xor_b32 v3, 64, v2
    v_lshrrev_b32 v9, 1, v8
    v_mul_u32_u24 v9, 0x1800, v9
    v_and_b32 v10, 1, v8
    v_mul_u32_u24 v10, 0x220, v10
    v_add_u32 v9, v9, v10
    v_bfe_u32 v10, v0, 2, 2
    v_lshl_add_u32 v9, v10, 6, v9
    v_and_b32 v10, 3, v0
    v_lshl_add_u32 v9, v10, 3, v9
    v_add_u32 v4, 0x18000, v9
    v_xor_b32 v5, 32, v4
    v_lshlrev_b32 v9, 4, v8
    v_add_u32 v6, 0x27000, v9
    s_lshl_b32 s4, s39, 7
    v_add_u32 v6, s4, v6
    s_lshl_b32 s78, s39, 1
    s_mov_b32 s38, 0xfffffb40
    v_mov_b32 v64, 0
    v_mov_b32 v65, 0
    v_mov_b32 v66, 0
    v_mov_b32 v67, 0
    v_mov_b32 v68, 0
    v_mov_b32 v69, 0
    v_mov_b32 v70, 0
    v_mov_b32 v71, 0
    v_mov_b32 v72, 0
    v_mov_b32 v73, 0
    v_mov_b32 v74, 0
    v_mov_b32 v75, 0
    v_mov_b32 v76, 0
    v_mov_b32 v77, 0
    v_mov_b32 v78, 0
    v_mov_b32 v79, 0
    v_mov_b32 v80, 0
    v_mov_b32 v81, 0
    v_mov_b32 v82, 0
    v_mov_b32 v83, 0
    v_mov_b32 v84, 0
    v_mov_b32 v85, 0
    v_mov_b32 v86, 0
    v_mov_b32 v87, 0
    v_mov_b32 v88, 0
    v_mov_b32 v89, 0
    v_mov_b32 v90, 0
    v_mov_b32 v91, 0
    v_mov_b32 v92, 0
    v_mov_b32 v93, 0
    v_mov_b32 v94, 0
    v_mov_b32 v95, 0
    v_mov_b32 v96, 0
    v_mov_b32 v97, 0
    v_mov_b32 v98, 0
    v_mov_b32 v99, 0
    v_mov_b32 v100, 0
    v_mov_b32 v101, 0
    v_mov_b32 v102, 0
    v_mov_b32 v103, 0
    v_mov_b32 v104, 0
    v_mov_b32 v105, 0
    v_mov_b32 v106, 0
    v_mov_b32 v107, 0
    v_mov_b32 v108, 0
    v_mov_b32 v109, 0
    v_mov_b32 v110, 0
    v_mov_b32 v111, 0
    v_mov_b32 v112, 0
    v_mov_b32 v113, 0
    v_mov_b32 v114, 0
    v_mov_b32 v115, 0
    v_mov_b32 v116, 0
    v_mov_b32 v117, 0
    v_mov_b32 v118, 0
    v_mov_b32 v119, 0
    v_mov_b32 v120, 0
    v_mov_b32 v121, 0
    v_mov_b32 v122, 0
    v_mov_b32 v123, 0
    v_mov_b32 v124, 0
    v_mov_b32 v125, 0
    v_mov_b32 v126, 0
    v_mov_b32 v127, 0
    v_mov_b32 v128, 0
    v_mov_b32 v129, 0
    v_mov_b32 v130, 0
    v_mov_b32 v131, 0
    v_mov_b32 v132, 0
    v_mov_b32 v133, 0
    v_mov_b32 v134, 0
    v_mov_b32 v135, 0
    v_mov_b32 v136, 0
    v_mov_b32 v137, 0
    v_mov_b32 v138, 0
    v_mov_b32 v139, 0
    v_mov_b32 v140, 0
    v_mov_b32 v141, 0
    v_mov_b32 v142, 0
    v_mov_b32 v143, 0
    v_mov_b32 v144, 0
    v_mov_b32 v145, 0
    v_mov_b32 v146, 0
    v_mov_b32 v147, 0
    v_mov_b32 v148, 0
    v_mov_b32 v149, 0
    v_mov_b32 v150, 0
    v_mov_b32 v151, 0
    v_mov_b32 v152, 0
    v_mov_b32 v153, 0
    v_mov_b32 v154, 0
    v_mov_b32 v155, 0
    v_mov_b32 v156, 0
    v_mov_b32 v157, 0
    v_mov_b32 v158, 0
    v_mov_b32 v159, 0
    v_mov_b32 v160, 0
    v_mov_b32 v161, 0
    v_mov_b32 v162, 0
    v_mov_b32 v163, 0
    v_mov_b32 v164, 0
    v_mov_b32 v165, 0
    v_mov_b32 v166, 0
    v_mov_b32 v167, 0
    v_mov_b32 v168, 0
    v_mov_b32 v169, 0
    v_mov_b32 v170, 0
    v_mov_b32 v171, 0
    v_mov_b32 v172, 0
    v_mov_b32 v173, 0
    v_mov_b32 v174, 0
    v_mov_b32 v175, 0
    v_mov_b32 v176, 0
    v_mov_b32 v177, 0
    v_mov_b32 v178, 0
    v_mov_b32 v179, 0
    v_mov_b32 v180, 0
    v_mov_b32 v181, 0
    v_mov_b32 v182, 0
    v_mov_b32 v183, 0
    v_mov_b32 v184, 0
    v_mov_b32 v185, 0
    v_mov_b32 v186, 0
    v_mov_b32 v187, 0
    v_mov_b32 v188, 0
    v_mov_b32 v189, 0
    v_mov_b32 v190, 0
    v_mov_b32 v191, 0
    v_mov_b32 v192, 0
    v_mov_b32 v193, 0
    v_mov_b32 v194, 0
    v_mov_b32 v195, 0
    v_mov_b32 v196, 0
    v_mov_b32 v197, 0
    v_mov_b32 v198, 0
    v_mov_b32 v199, 0
    v_mov_b32 v200, 0
    v_mov_b32 v201, 0
    v_mov_b32 v202, 0
    v_mov_b32 v203, 0
    v_mov_b32 v204, 0
    v_mov_b32 v205, 0
    v_mov_b32 v206, 0
    v_mov_b32 v207, 0
    v_mov_b32 v208, 0
    v_mov_b32 v209, 0
    v_mov_b32 v210, 0
    v_mov_b32 v211, 0
    v_mov_b32 v212, 0
    v_mov_b32 v213, 0
    v_mov_b32 v214, 0
    v_mov_b32 v215, 0
    v_mov_b32 v216, 0
    v_mov_b32 v217, 0
    v_mov_b32 v218, 0
    v_mov_b32 v219, 0
    v_mov_b32 v220, 0
    v_mov_b32 v221, 0
    v_mov_b32 v222, 0
    v_mov_b32 v223, 0
    v_mov_b32 v224, 0
    v_mov_b32 v225, 0
    v_mov_b32 v226, 0
    v_mov_b32 v227, 0
    v_mov_b32 v228, 0
    v_mov_b32 v229, 0
    v_mov_b32 v230, 0
    v_mov_b32 v231, 0
    v_mov_b32 v232, 0
    v_mov_b32 v233, 0
    v_mov_b32 v234, 0
    v_mov_b32 v235, 0
    v_mov_b32 v236, 0
    v_mov_b32 v237, 0
    v_mov_b32 v238, 0
    v_mov_b32 v239, 0
    s_mov_b32 s61, 0
    s_mov_b32 s62, 0
    s_mov_b32 s63, 10
    s_mov_b32 s66, 0xffff4000
    s_mov_b32 s67, 12288
    s_mov_b32 s68, 0xffff0000
    s_mov_b32 s69, 32768
    s_mov_b32 s70, 0xbfb8aa3b
    s_mov_b32 s71, 0xbfb8aa3b
    s_mov_b32 s72, 1.0
    s_mov_b32 s73, 1.0
    s_mov_b32 s74, 0x3fb8aa3b
    s_mov_b32 s75, 0x3fb8aa3b
    s_mov_b32 s76, 0x358637bd
    s_mov_b32 s77, 0x358637bd
    s_cmp_lg_u32 s3, 0
    s_cbranch_scc1 L_cT_skip2
    s_mov_b32 s40, s34
    s_mov_b32 s41, s35
    s_mov_b32 s42, 0x100
    s_mov_b32 s43, 0x20000
    v_mov_b32 v7, 0
L_cT2_T:
    buffer_load_dword v8, v7, s[40:43], 0 offen sc1
    s_waitcnt vmcnt(0)
    v_readfirstlane_b32 s92, v8
    s_nop 3
    s_cmp_lg_u32 s92, 0
    s_cbranch_scc1 L_cT2_Tok
    s_sleep 8
    s_branch L_cT2_T
L_cT2_Tok:
L_cT_skip2:
    s_barrier
    ds_read_b128 v[16:19], v2 offset:0
    ds_read_b128 v[20:23], v2 offset:2048
    ds_read_b128 v[24:27], v2 offset:4096
    ds_read_b128 v[28:31], v2 offset:6144
    ds_read_b64_tr_b16 v[48:49], v4 offset:0
    ds_read_b64_tr_b16 v[50:51], v4 offset:256
    ds_read_b64_tr_b16 v[52:53], v5 offset:0
    ds_read_b64_tr_b16 v[54:55], v5 offset:256
    ds_read_b64_tr_b16 v[56:57], v4 offset:1024
    ds_read_b64_tr_b16 v[58:59], v4 offset:1280
    s_waitcnt lgkmcnt(0)
L_q_loop:
    s_waitcnt lgkmcnt(4)
    v_mfma_f32_16x16x32_bf16 v[64:67], v[48:51], v[16:19], v[64:67]
    s_add_u32 s61, s61, 1
    s_cmp_eq_u32 s61, 5
    v_mfma_f32_16x16x32_bf16 v[68:71], v[48:51], v[20:23], v[68:71]
    s_cselect_b32 s61, 0, s61
    s_cselect_b32 s64, s66, s67
    v_mfma_f32_16x16x32_bf16 v[72:75], v[48:51], v[24:27], v[72:75]
    ds_read_b64_tr_b16 v[60:61], v5 offset:1024
    v_mfma_f32_16x16x32_bf16 v[76:79], v[48:51], v[28:31], v[76:79]
    ds_read_b64_tr_b16 v[62:63], v5 offset:1280
    s_waitcnt lgkmcnt(4)
    v_mfma_f32_16x16x32_bf16 v[80:83], v[52:55], v[16:19], v[80:83]
    s_barrier
    s_add_u32 s62, s62, 1
    v_mfma_f32_16x16x32_bf16 v[84:87], v[52:55], v[20:23], v[84:87]
    s_cmp_eq_u32 s62, 3
    s_cselect_b32 s62, 0, s62
    v_mfma_f32_16x16x32_bf16 v[88:91], v[52:55], v[24:27], v[88:91]
    s_cselect_b32 s65, s68, s69
    ds_read_b64_tr_b16 v[48:49], v4 offset:2048
    v_mfma_f32_16x16x32_bf16 v[92:95], v[52:55], v[28:31], v[92:95]
    ds_read_b64_tr_b16 v[50:51], v4 offset:2304
    s_waitcnt lgkmcnt(4)
    v_mfma_f32_16x16x32_bf16 v[96:99], v[56:59], v[16:19], v[96:99]
    ds_read_b64_tr_b16 v[52:53], v5 offset:2048
    v_mfma_f32_16x16x32_bf16 v[100:103], v[56:59], v[20:23], v[100:103]
    ds_read_b64_tr_b16 v[54:55], v5 offset:2304
    v_mfma_f32_16x16x32_bf16 v[104:107], v[56:59], v[24:27], v[104:107]
    ds_read_b128 v[32:35], v3 offset:0
    v_mfma_f32_16x16x32_bf16 v[108:111], v[56:59], v[28:31], v[108:111]
    s_waitcnt lgkmcnt(5)
    v_mfma_f32_16x16x32_bf16 v[112:115], v[60:63], v[16:19], v[112:115]
    ds_read_b64_tr_b16 v[56:57], v4 offset:3072
    v_mfma_f32_16x16x32_bf16 v[116:119], v[60:63], v[20:23], v[116:119]
    ds_read_b64_tr_b16 v[58:59], v4 offset:3328
    v_mfma_f32_16x16x32_bf16 v[120:123], v[60:63], v[24:27], v[120:123]
    ds_read_b128 v[36:39], v3 offset:2048
    v_mfma_f32_16x16x32_bf16 v[124:127], v[60:63], v[28:31], v[124:127]
    s_waitcnt lgkmcnt(6)
    v_mfma_f32_16x16x32_bf16 v[128:131], v[48:51], v[16:19], v[128:131]
    ds_read_b64_tr_b16 v[60:61], v5 offset:3072
    v_mfma_f32_16x16x32_bf16 v[132:135], v[48:51], v[20:23], v[132:135]
    ds_read_b64_tr_b16 v[62:63], v5 offset:3328
    v_mfma_f32_16x16x32_bf16 v[136:139], v[48:51], v[24:27], v[136:139]
    ds_read_b128 v[40:43], v3 offset:4096
    v_mfma_f32_16x16x32_bf16 v[140:143], v[48:51], v[28:31], v[140:143]
    s_waitcnt lgkmcnt(7)
    v_mfma_f32_16x16x32_bf16 v[144:147], v[52:55], v[16:19], v[144:147]
    ds_read_b64_tr_b16 v[48:49], v4 offset:4096
    v_mfma_f32_16x16x32_bf16 v[148:151], v[52:55], v[20:23], v[148:151]
    ds_read_b64_tr_b16 v[50:51], v4 offset:4352
    v_mfma_f32_16x16x32_bf16 v[152:155], v[52:55], v[24:27], v[152:155]
    ds_read_b128 v[44:47], v3 offset:6144
    v_mfma_f32_16x16x32_bf16 v[156:159], v[52:55], v[28:31], v[156:159]
    s_waitcnt lgkmcnt(7)
    v_mfma_f32_16x16x32_bf16 v[160:163], v[56:59], v[16:19], v[160:163]
    ds_read_b64_tr_b16 v[52:53], v5 offset:4096
    v_mfma_f32_16x16x32_bf16 v[164:167], v[56:59], v[20:23], v[164:167]
    ds_read_b64_tr_b16 v[54:55], v5 offset:4352
    v_mfma_f32_16x16x32_bf16 v[168:171], v[56:59], v[24:27], v[168:171]
    v_add_u32 v3, s65, v3
    v_mfma_f32_16x16x32_bf16 v[172:175], v[56:59], v[28:31], v[172:175]
    ds_read_b128 v[240:243], v6
    s_waitcnt lgkmcnt(7)
    v_mfma_f32_16x16x32_bf16 v[176:179], v[60:63], v[16:19], v[176:179]
    v_add_u32 v4, s64, v4
    v_add_u32 v5, s64, v5
    ds_read_b64_tr_b16 v[56:57], v4 offset:0
    v_mfma_f32_16x16x32_bf16 v[180:183], v[60:63], v[20:23], v[180:183]
    ds_read_b64_tr_b16 v[58:59], v4 offset:256
    s_add_u32 s78, s78, 1
    v_mfma_f32_16x16x32_bf16 v[184:187], v[60:63], v[24:27], v[184:187]
    s_cmp_eq_u32 s78, 20
    s_cselect_b32 s78, 0, s78
    v_mfma_f32_16x16x32_bf16 v[188:191], v[60:63], v[28:31], v[188:191]
    s_cselect_b32 s79, s38, 64
    v_add_u32 v6, s79, v6
    s_waitcnt lgkmcnt(6)
    v_mfma_f32_16x16x32_bf16 v[192:195], v[48:51], v[16:19], v[192:195]
    ds_read_b64_tr_b16 v[60:61], v5 offset:0
    v_mfma_f32_16x16x32_bf16 v[196:199], v[48:51], v[20:23], v[196:199]
    ds_read_b64_tr_b16 v[62:63], v5 offset:256
    v_mfma_f32_16x16x32_bf16 v[200:203], v[48:51], v[24:27], v[200:203]
    v_mfma_f32_16x16x32_bf16 v[204:207], v[48:51], v[28:31], v[204:207]
    s_waitcnt lgkmcnt(5)
    v_mfma_f32_16x16x32_bf16 v[208:211], v[52:55], v[16:19], v[208:211]
    ds_read_b64_tr_b16 v[48:49], v4 offset:1024
    v_mfma_f32_16x16x32_bf16 v[212:215], v[52:55], v[20:23], v[212:215]
    ds_read_b64_tr_b16 v[50:51], v4 offset:1280
    v_mfma_f32_16x16x32_bf16 v[216:219], v[52:55], v[24:27], v[216:219]
    v_mfma_f32_16x16x32_bf16 v[220:223], v[52:55], v[28:31], v[220:223]
    s_waitcnt lgkmcnt(6)
    v_mfma_f32_16x16x32_bf16 v[224:227], v[240:243], v[16:19], v[224:227]
    v_mfma_f32_16x16x32_bf16 v[228:231], v[240:243], v[20:23], v[228:231]
    v_mfma_f32_16x16x32_bf16 v[232:235], v[240:243], v[24:27], v[232:235]
    v_mfma_f32_16x16x32_bf16 v[236:239], v[240:243], v[28:31], v[236:239]
    s_waitcnt lgkmcnt(4)
    v_mfma_f32_16x16x32_bf16 v[64:67], v[56:59], v[32:35], v[64:67]
    s_add_u32 s61, s61, 1
    s_cmp_eq_u32 s61, 5
    v_mfma_f32_16x16x32_bf16 v[68:71], v[56:59], v[36:39], v[68:71]
    s_cselect_b32 s61, 0, s61
    s_cselect_b32 s64, s66, s67
    v_mfma_f32_16x16x32_bf16 v[72:75], v[56:59], v[40:43], v[72:75]
    ds_read_b64_tr_b16 v[52:53], v5 offset:1024
    v_mfma_f32_16x16x32_bf16 v[76:79], v[56:59], v[44:47], v[76:79]
    ds_read_b64_tr_b16 v[54:55], v5 offset:1280
    s_waitcnt lgkmcnt(4)
    v_mfma_f32_16x16x32_bf16 v[80:83], v[60:63], v[32:35], v[80:83]
    s_barrier
    v_mfma_f32_16x16x32_bf16 v[84:87], v[60:63], v[36:39], v[84:87]
    v_add_u32 v2, s65, v2
    v_mfma_f32_16x16x32_bf16 v[88:91], v[60:63], v[40:43], v[88:91]
    ds_read_b64_tr_b16 v[56:57], v4 offset:2048
    v_mfma_f32_16x16x32_bf16 v[92:95], v[60:63], v[44:47], v[92:95]
    ds_read_b64_tr_b16 v[58:59], v4 offset:2304
    s_waitcnt lgkmcnt(4)
    v_mfma_f32_16x16x32_bf16 v[96:99], v[48:51], v[32:35], v[96:99]
    ds_read_b64_tr_b16 v[60:61], v5 offset:2048
    v_mfma_f32_16x16x32_bf16 v[100:103], v[48:51], v[36:39], v[100:103]
    ds_read_b64_tr_b16 v[62:63], v5 offset:2304
    v_mfma_f32_16x16x32_bf16 v[104:107], v[48:51], v[40:43], v[104:107]
    ds_read_b128 v[16:19], v2 offset:0
    v_mfma_f32_16x16x32_bf16 v[108:111], v[48:51], v[44:47], v[108:111]
    s_waitcnt lgkmcnt(5)
    v_mfma_f32_16x16x32_bf16 v[112:115], v[52:55], v[32:35], v[112:115]
    ds_read_b64_tr_b16 v[48:49], v4 offset:3072
    v_mfma_f32_16x16x32_bf16 v[116:119], v[52:55], v[36:39], v[116:119]
    ds_read_b64_tr_b16 v[50:51], v4 offset:3328
    v_mfma_f32_16x16x32_bf16 v[120:123], v[52:55], v[40:43], v[120:123]
    ds_read_b128 v[20:23], v2 offset:2048
    v_mfma_f32_16x16x32_bf16 v[124:127], v[52:55], v[44:47], v[124:127]
    s_waitcnt lgkmcnt(6)
    v_mfma_f32_16x16x32_bf16 v[128:131], v[56:59], v[32:35], v[128:131]
    ds_read_b64_tr_b16 v[52:53], v5 offset:3072
    v_mfma_f32_16x16x32_bf16 v[132:135], v[56:59], v[36:39], v[132:135]
    ds_read_b64_tr_b16 v[54:55], v5 offset:3328
    v_mfma_f32_16x16x32_bf16 v[136:139], v[56:59], v[40:43], v[136:139]
    ds_read_b128 v[24:27], v2 offset:4096
    v_mfma_f32_16x16x32_bf16 v[140:143], v[56:59], v[44:47], v[140:143]
    s_waitcnt lgkmcnt(7)
    v_mfma_f32_16x16x32_bf16 v[144:147], v[60:63], v[32:35], v[144:147]
    ds_read_b64_tr_b16 v[56:57], v4 offset:4096
    v_mfma_f32_16x16x32_bf16 v[148:151], v[60:63], v[36:39], v[148:151]
    ds_read_b64_tr_b16 v[58:59], v4 offset:4352
    v_mfma_f32_16x16x32_bf16 v[152:155], v[60:63], v[40:43], v[152:155]
    ds_read_b128 v[28:31], v2 offset:6144
    v_mfma_f32_16x16x32_bf16 v[156:159], v[60:63], v[44:47], v[156:159]
    s_waitcnt lgkmcnt(7)
    v_mfma_f32_16x16x32_bf16 v[160:163], v[48:51], v[32:35], v[160:163]
    ds_read_b64_tr_b16 v[60:61], v5 offset:4096
    v_mfma_f32_16x16x32_bf16 v[164:167], v[48:51], v[36:39], v[164:167]
    ds_read_b64_tr_b16 v[62:63], v5 offset:4352
    v_mfma_f32_16x16x32_bf16 v[168:171], v[48:51], v[40:43], v[168:171]
    ds_read_b128 v[240:243], v6
    v_mfma_f32_16x16x32_bf16 v[172:175], v[48:51], v[44:47], v[172:175]
    s_waitcnt lgkmcnt(7)
    v_mfma_f32_16x16x32_bf16 v[176:179], v[52:55], v[32:35], v[176:179]
    v_add_u32 v4, s64, v4
    v_add_u32 v5, s64, v5
    ds_read_b64_tr_b16 v[48:49], v4 offset:0
    v_mfma_f32_16x16x32_bf16 v[180:183], v[52:55], v[36:39], v[180:183]
    ds_read_b64_tr_b16 v[50:51], v4 offset:256
    s_add_u32 s78, s78, 1
    v_mfma_f32_16x16x32_bf16 v[184:187], v[52:55], v[40:43], v[184:187]
    s_cmp_eq_u32 s78, 20
    s_cselect_b32 s78, 0, s78
    v_mfma_f32_16x16x32_bf16 v[188:191], v[52:55], v[44:47], v[188:191]
    s_cselect_b32 s79, s38, 64
    v_add_u32 v6, s79, v6
    s_waitcnt lgkmcnt(6)
    v_mfma_f32_16x16x32_bf16 v[192:195], v[56:59], v[32:35], v[192:195]
    ds_read_b64_tr_b16 v[52:53], v5 offset:0
    v_mfma_f32_16x16x32_bf16 v[196:199], v[56:59], v[36:39], v[196:199]
    ds_read_b64_tr_b16 v[54:55], v5 offset:256
    v_mfma_f32_16x16x32_bf16 v[200:203], v[56:59], v[40:43], v[200:203]
    v_mfma_f32_16x16x32_bf16 v[204:207], v[56:59], v[44:47], v[204:207]
    s_waitcnt lgkmcnt(5)
    v_mfma_f32_16x16x32_bf16 v[208:211], v[60:63], v[32:35], v[208:211]
    ds_read_b64_tr_b16 v[56:57], v4 offset:1024
    v_mfma_f32_16x16x32_bf16 v[212:215], v[60:63], v[36:39], v[212:215]
    ds_read_b64_tr_b16 v[58:59], v4 offset:1280
    v_mfma_f32_16x16x32_bf16 v[216:219], v[60:63], v[40:43], v[216:219]
    v_mfma_f32_16x16x32_bf16 v[220:223], v[60:63], v[44:47], v[220:223]
    s_waitcnt lgkmcnt(6)
    v_mfma_f32_16x16x32_bf16 v[224:227], v[240:243], v[32:35], v[224:227]
    v_mfma_f32_16x16x32_bf16 v[228:231], v[240:243], v[36:39], v[228:231]
    v_mfma_f32_16x16x32_bf16 v[232:235], v[240:243], v[40:43], v[232:235]
    v_mfma_f32_16x16x32_bf16 v[236:239], v[240:243], v[44:47], v[236:239]
    s_sub_u32 s63, s63, 1
    s_cmp_lg_u32 s63, 0
    s_cbranch_scc1 L_q_loop
    s_waitcnt lgkmcnt(0)
    s_barrier
    s_nop 7
    s_mov_b32 s44, s36
    s_mov_b32 s45, s37
    s_mov_b32 s46, 0x960000
    s_mov_b32 s47, 0x20000
    s_add_u32 s48, s36, 0xf80000
    s_addc_u32 s49, s37, 0
    s_mov_b32 s50, 0x2000
    s_mov_b32 s51, 0x20000
    s_lshl_b32 s4, s52, 4
    s_lshl_b32 s5, s3, 2
    s_add_u32 s4, s4, s5
    s_mul_i32 s4, s4, 75
    s_mul_i32 s5, s53, 5
    s_add_u32 s4, s4, s5
    s_add_u32 s4, s4, 54
    s_lshl_b32 s80, s4, 10
    s_add_u32 s81, s80, 76800
    s_add_u32 s82, s80, 153600
    s_add_u32 s83, s80, 230400
    v_lshlrev_b32 v7, 4, v0
    v_add_u32 v8, 0x1000, v7
    s_lshl_b32 s4, s52, 8
    s_lshl_b32 s5, s3, 6
    s_add_u32 s4, s4, s5
    s_lshl_b32 s79, s4, 2
    v_and_b32 v9, 15, v0
    v_lshlrev_b32 v9, 2, v9
    v_mul_f32 v224, s70, v224
    v_mul_f32 v228, s70, v228
    v_mul_f32 v232, s70, v232
    v_mul_f32 v236, s70, v236
    v_exp_f32 v224, v224
    v_exp_f32 v228, v228
    v_exp_f32 v232, v232
    v_exp_f32 v236, v236
    s_nop 0
    v_add_f32 v224, 1.0, v224
    v_add_f32 v228, 1.0, v228
    v_add_f32 v232, 1.0, v232
    v_add_f32 v236, 1.0, v236
    v_rcp_f32 v224, v224
    v_rcp_f32 v228, v228
    v_rcp_f32 v232, v232
    v_rcp_f32 v236, v236
    s_cmp_lg_u32 s53, 0
    s_cbranch_scc1 L_q_nogate
    buffer_store_dword v224, v9, s[48:51], s79 offen offset:0 sc1
    buffer_store_dword v228, v9, s[48:51], s79 offen offset:64 sc1
    buffer_store_dword v232, v9, s[48:51], s79 offen offset:128 sc1
    buffer_store_dword v236, v9, s[48:51], s79 offen offset:192 sc1
L_q_nogate:
    v_pk_mul_f32 v[16:17], v[64:65], s[74:75]
    v_pk_mul_f32 v[18:19], v[66:67], s[74:75]
    v_pk_mul_f32 v[20:21], v[80:81], s[74:75]
    v_pk_mul_f32 v[22:23], v[82:83], s[74:75]
    v_exp_f32_e64 v16, v16 clamp
    v_exp_f32_e64 v17, v17 clamp
    v_exp_f32_e64 v18, v18 clamp
    v_exp_f32_e64 v19, v19 clamp
    v_exp_f32_e64 v20, v20 clamp
    v_exp_f32_e64 v21, v21 clamp
    v_exp_f32_e64 v22, v22 clamp
    v_exp_f32_e64 v23, v23 clamp
    v_pk_add_f32 v[64:65], v[64:65], s[72:73]
    v_pk_add_f32 v[66:67], v[66:67], s[72:73]
    v_pk_add_f32 v[80:81], v[80:81], s[72:73]
    v_pk_add_f32 v[82:83], v[82:83], s[72:73]
    v_max_f32 v64, v64, v16
    v_max_f32 v65, v65, v17
    v_max_f32 v66, v66, v18
    v_max_f32 v67, v67, v19
    v_max_f32 v80, v80, v20
    v_max_f32 v81, v81, v21
    v_max_f32 v82, v82, v22
    v_max_f32 v83, v83, v23
    v_pk_add_f32 v[64:65], v[64:65], s[76:77]
    v_pk_add_f32 v[66:67], v[66:67], s[76:77]
    v_pk_add_f32 v[80:81], v[80:81], s[76:77]
    v_pk_add_f32 v[82:83], v[82:83], s[76:77]
    v_cvt_pk_bf16_f32 v64, v64, v65
    v_cvt_pk_bf16_f32 v65, v66, v67
    v_cvt_pk_bf16_f32 v66, v80, v81
    v_cvt_pk_bf16_f32 v67, v82, v83
    buffer_store_dwordx4 v[64:67], v7, s[44:47], s80 offen offset:0 sc1
    v_pk_mul_f32 v[16:17], v[96:97], s[74:75]
    v_pk_mul_f32 v[18:19], v[98:99], s[74:75]
    v_pk_mul_f32 v[20:21], v[112:113], s[74:75]
    v_pk_mul_f32 v[22:23], v[114:115], s[74:75]
    v_exp_f32_e64 v16, v16 clamp
    v_exp_f32_e64 v17, v17 clamp
    v_exp_f32_e64 v18, v18 clamp
    v_exp_f32_e64 v19, v19 clamp
    v_exp_f32_e64 v20, v20 clamp
    v_exp_f32_e64 v21, v21 clamp
    v_exp_f32_e64 v22, v22 clamp
    v_exp_f32_e64 v23, v23 clamp
    v_pk_add_f32 v[96:97], v[96:97], s[72:73]
    v_pk_add_f32 v[98:99], v[98:99], s[72:73]
    v_pk_add_f32 v[112:113], v[112:113], s[72:73]
    v_pk_add_f32 v[114:115], v[114:115], s[72:73]
    v_max_f32 v96, v96, v16
    v_max_f32 v97, v97, v17
    v_max_f32 v98, v98, v18
    v_max_f32 v99, v99, v19
    v_max_f32 v112, v112, v20
    v_max_f32 v113, v113, v21
    v_max_f32 v114, v114, v22
    v_max_f32 v115, v115, v23
    v_pk_add_f32 v[96:97], v[96:97], s[76:77]
    v_pk_add_f32 v[98:99], v[98:99], s[76:77]
    v_pk_add_f32 v[112:113], v[112:113], s[76:77]
    v_pk_add_f32 v[114:115], v[114:115], s[76:77]
    v_cvt_pk_bf16_f32 v96, v96, v97
    v_cvt_pk_bf16_f32 v97, v98, v99
    v_cvt_pk_bf16_f32 v98, v112, v113
    v_cvt_pk_bf16_f32 v99, v114, v115
    buffer_store_dwordx4 v[96:99], v7, s[44:47], s80 offen offset:1024 sc1
    v_pk_mul_f32 v[16:17], v[128:129], s[74:75]
    v_pk_mul_f32 v[18:19], v[130:131], s[74:75]
    v_pk_mul_f32 v[20:21], v[144:145], s[74:75]
    v_pk_mul_f32 v[22:23], v[146:147], s[74:75]
    v_exp_f32_e64 v16, v16 clamp
    v_exp_f32_e64 v17, v17 clamp
    v_exp_f32_e64 v18, v18 clamp
    v_exp_f32_e64 v19, v19 clamp
    v_exp_f32_e64 v20, v20 clamp
    v_exp_f32_e64 v21, v21 clamp
    v_exp_f32_e64 v22, v22 clamp
    v_exp_f32_e64 v23, v23 clamp
    v_pk_add_f32 v[128:129], v[128:129], s[72:73]
    v_pk_add_f32 v[130:131], v[130:131], s[72:73]
    v_pk_add_f32 v[144:145], v[144:145], s[72:73]
    v_pk_add_f32 v[146:147], v[146:147], s[72:73]
    v_max_f32 v128, v128, v16
    v_max_f32 v129, v129, v17
    v_max_f32 v130, v130, v18
    v_max_f32 v131, v131, v19
    v_max_f32 v144, v144, v20
    v_max_f32 v145, v145, v21
    v_max_f32 v146, v146, v22
    v_max_f32 v147, v147, v23
    v_pk_add_f32 v[128:129], v[128:129], s[76:77]
    v_pk_add_f32 v[130:131], v[130:131], s[76:77]
    v_pk_add_f32 v[144:145], v[144:145], s[76:77]
    v_pk_add_f32 v[146:147], v[146:147], s[76:77]
    v_cvt_pk_bf16_f32 v128, v128, v129
    v_cvt_pk_bf16_f32 v129, v130, v131
    v_cvt_pk_bf16_f32 v130, v144, v145
    v_cvt_pk_bf16_f32 v131, v146, v147
    buffer_store_dwordx4 v[128:131], v7, s[44:47], s80 offen offset:2048 sc1
    v_pk_mul_f32 v[16:17], v[160:161], s[74:75]
    v_pk_mul_f32 v[18:19], v[162:163], s[74:75]
    v_pk_mul_f32 v[20:21], v[176:177], s[74:75]
    v_pk_mul_f32 v[22:23], v[178:179], s[74:75]
    v_exp_f32_e64 v16, v16 clamp
    v_exp_f32_e64 v17, v17 clamp
    v_exp_f32_e64 v18, v18 clamp
    v_exp_f32_e64 v19, v19 clamp
    v_exp_f32_e64 v20, v20 clamp
    v_exp_f32_e64 v21, v21 clamp
    v_exp_f32_e64 v22, v22 clamp
    v_exp_f32_e64 v23, v23 clamp
    v_pk_add_f32 v[160:161], v[160:161], s[72:73]
    v_pk_add_f32 v[162:163], v[162:163], s[72:73]
    v_pk_add_f32 v[176:177], v[176:177], s[72:73]
    v_pk_add_f32 v[178:179], v[178:179], s[72:73]
    v_max_f32 v160, v160, v16
    v_max_f32 v161, v161, v17
    v_max_f32 v162, v162, v18
    v_max_f32 v163, v163, v19
    v_max_f32 v176, v176, v20
    v_max_f32 v177, v177, v21
    v_max_f32 v178, v178, v22
    v_max_f32 v179, v179, v23
    v_pk_add_f32 v[160:161], v[160:161], s[76:77]
    v_pk_add_f32 v[162:163], v[162:163], s[76:77]
    v_pk_add_f32 v[176:177], v[176:177], s[76:77]
    v_pk_add_f32 v[178:179], v[178:179], s[76:77]
    v_cvt_pk_bf16_f32 v160, v160, v161
    v_cvt_pk_bf16_f32 v161, v162, v163
    v_cvt_pk_bf16_f32 v162, v176, v177
    v_cvt_pk_bf16_f32 v163, v178, v179
    buffer_store_dwordx4 v[160:163], v7, s[44:47], s80 offen offset:3072 sc1
    v_pk_mul_f32 v[16:17], v[192:193], s[74:75]
    v_pk_mul_f32 v[18:19], v[194:195], s[74:75]
    v_pk_mul_f32 v[20:21], v[208:209], s[74:75]
    v_pk_mul_f32 v[22:23], v[210:211], s[74:75]
    v_exp_f32_e64 v16, v16 clamp
    v_exp_f32_e64 v17, v17 clamp
    v_exp_f32_e64 v18, v18 clamp
    v_exp_f32_e64 v19, v19 clamp
    v_exp_f32_e64 v20, v20 clamp
    v_exp_f32_e64 v21, v21 clamp
    v_exp_f32_e64 v22, v22 clamp
    v_exp_f32_e64 v23, v23 clamp
    v_pk_add_f32 v[192:193], v[192:193], s[72:73]
    v_pk_add_f32 v[194:195], v[194:195], s[72:73]
    v_pk_add_f32 v[208:209], v[208:209], s[72:73]
    v_pk_add_f32 v[210:211], v[210:211], s[72:73]
    v_max_f32 v192, v192, v16
    v_max_f32 v193, v193, v17
    v_max_f32 v194, v194, v18
    v_max_f32 v195, v195, v19
    v_max_f32 v208, v208, v20
    v_max_f32 v209, v209, v21
    v_max_f32 v210, v210, v22
    v_max_f32 v211, v211, v23
    v_pk_add_f32 v[192:193], v[192:193], s[76:77]
    v_pk_add_f32 v[194:195], v[194:195], s[76:77]
    v_pk_add_f32 v[208:209], v[208:209], s[76:77]
    v_pk_add_f32 v[210:211], v[210:211], s[76:77]
    v_cvt_pk_bf16_f32 v192, v192, v193
    v_cvt_pk_bf16_f32 v193, v194, v195
    v_cvt_pk_bf16_f32 v194, v208, v209
    v_cvt_pk_bf16_f32 v195, v210, v211
    buffer_store_dwordx4 v[192:195], v8, s[44:47], s80 offen sc1
    v_pk_mul_f32 v[16:17], v[68:69], s[74:75]
    v_pk_mul_f32 v[18:19], v[70:71], s[74:75]
    v_pk_mul_f32 v[20:21], v[84:85], s[74:75]
    v_pk_mul_f32 v[22:23], v[86:87], s[74:75]
    v_exp_f32_e64 v16, v16 clamp
    v_exp_f32_e64 v17, v17 clamp
    v_exp_f32_e64 v18, v18 clamp
    v_exp_f32_e64 v19, v19 clamp
    v_exp_f32_e64 v20, v20 clamp
    v_exp_f32_e64 v21, v21 clamp
    v_exp_f32_e64 v22, v22 clamp
    v_exp_f32_e64 v23, v23 clamp
    v_pk_add_f32 v[68:69], v[68:69], s[72:73]
    v_pk_add_f32 v[70:71], v[70:71], s[72:73]
    v_pk_add_f32 v[84:85], v[84:85], s[72:73]
    v_pk_add_f32 v[86:87], v[86:87], s[72:73]
    v_max_f32 v68, v68, v16
    v_max_f32 v69, v69, v17
    v_max_f32 v70, v70, v18
    v_max_f32 v71, v71, v19
    v_max_f32 v84, v84, v20
    v_max_f32 v85, v85, v21
    v_max_f32 v86, v86, v22
    v_max_f32 v87, v87, v23
    v_pk_add_f32 v[68:69], v[68:69], s[76:77]
    v_pk_add_f32 v[70:71], v[70:71], s[76:77]
    v_pk_add_f32 v[84:85], v[84:85], s[76:77]
    v_pk_add_f32 v[86:87], v[86:87], s[76:77]
    v_cvt_pk_bf16_f32 v68, v68, v69
    v_cvt_pk_bf16_f32 v69, v70, v71
    v_cvt_pk_bf16_f32 v70, v84, v85
    v_cvt_pk_bf16_f32 v71, v86, v87
    buffer_store_dwordx4 v[68:71], v7, s[44:47], s81 offen offset:0 sc1
    v_pk_mul_f32 v[16:17], v[100:101], s[74:75]
    v_pk_mul_f32 v[18:19], v[102:103], s[74:75]
    v_pk_mul_f32 v[20:21], v[116:117], s[74:75]
    v_pk_mul_f32 v[22:23], v[118:119], s[74:75]
    v_exp_f32_e64 v16, v16 clamp
    v_exp_f32_e64 v17, v17 clamp
    v_exp_f32_e64 v18, v18 clamp
    v_exp_f32_e64 v19, v19 clamp
    v_exp_f32_e64 v20, v20 clamp
    v_exp_f32_e64 v21, v21 clamp
    v_exp_f32_e64 v22, v22 clamp
    v_exp_f32_e64 v23, v23 clamp
    v_pk_add_f32 v[100:101], v[100:101], s[72:73]
    v_pk_add_f32 v[102:103], v[102:103], s[72:73]
    v_pk_add_f32 v[116:117], v[116:117], s[72:73]
    v_pk_add_f32 v[118:119], v[118:119], s[72:73]
    v_max_f32 v100, v100, v16
    v_max_f32 v101, v101, v17
    v_max_f32 v102, v102, v18
    v_max_f32 v103, v103, v19
    v_max_f32 v116, v116, v20
    v_max_f32 v117, v117, v21
    v_max_f32 v118, v118, v22
    v_max_f32 v119, v119, v23
    v_pk_add_f32 v[100:101], v[100:101], s[76:77]
    v_pk_add_f32 v[102:103], v[102:103], s[76:77]
    v_pk_add_f32 v[116:117], v[116:117], s[76:77]
    v_pk_add_f32 v[118:119], v[118:119], s[76:77]
    v_cvt_pk_bf16_f32 v100, v100, v101
    v_cvt_pk_bf16_f32 v101, v102, v103
    v_cvt_pk_bf16_f32 v102, v116, v117
    v_cvt_pk_bf16_f32 v103, v118, v119
    buffer_store_dwordx4 v[100:103], v7, s[44:47], s81 offen offset:1024 sc1
    v_pk_mul_f32 v[16:17], v[132:133], s[74:75]
    v_pk_mul_f32 v[18:19], v[134:135], s[74:75]
    v_pk_mul_f32 v[20:21], v[148:149], s[74:75]
    v_pk_mul_f32 v[22:23], v[150:151], s[74:75]
    v_exp_f32_e64 v16, v16 clamp
    v_exp_f32_e64 v17, v17 clamp
    v_exp_f32_e64 v18, v18 clamp
    v_exp_f32_e64 v19, v19 clamp
    v_exp_f32_e64 v20, v20 clamp
    v_exp_f32_e64 v21, v21 clamp
    v_exp_f32_e64 v22, v22 clamp
    v_exp_f32_e64 v23, v23 clamp
    v_pk_add_f32 v[132:133], v[132:133], s[72:73]
    v_pk_add_f32 v[134:135], v[134:135], s[72:73]
    v_pk_add_f32 v[148:149], v[148:149], s[72:73]
    v_pk_add_f32 v[150:151], v[150:151], s[72:73]
    v_max_f32 v132, v132, v16
    v_max_f32 v133, v133, v17
    v_max_f32 v134, v134, v18
    v_max_f32 v135, v135, v19
    v_max_f32 v148, v148, v20
    v_max_f32 v149, v149, v21
    v_max_f32 v150, v150, v22
    v_max_f32 v151, v151, v23
    v_pk_add_f32 v[132:133], v[132:133], s[76:77]
    v_pk_add_f32 v[134:135], v[134:135], s[76:77]
    v_pk_add_f32 v[148:149], v[148:149], s[76:77]
    v_pk_add_f32 v[150:151], v[150:151], s[76:77]
    v_cvt_pk_bf16_f32 v132, v132, v133
    v_cvt_pk_bf16_f32 v133, v134, v135
    v_cvt_pk_bf16_f32 v134, v148, v149
    v_cvt_pk_bf16_f32 v135, v150, v151
    buffer_store_dwordx4 v[132:135], v7, s[44:47], s81 offen offset:2048 sc1
    v_pk_mul_f32 v[16:17], v[164:165], s[74:75]
    v_pk_mul_f32 v[18:19], v[166:167], s[74:75]
    v_pk_mul_f32 v[20:21], v[180:181], s[74:75]
    v_pk_mul_f32 v[22:23], v[182:183], s[74:75]
    v_exp_f32_e64 v16, v16 clamp
    v_exp_f32_e64 v17, v17 clamp
    v_exp_f32_e64 v18, v18 clamp
    v_exp_f32_e64 v19, v19 clamp
    v_exp_f32_e64 v20, v20 clamp
    v_exp_f32_e64 v21, v21 clamp
    v_exp_f32_e64 v22, v22 clamp
    v_exp_f32_e64 v23, v23 clamp
    v_pk_add_f32 v[164:165], v[164:165], s[72:73]
    v_pk_add_f32 v[166:167], v[166:167], s[72:73]
    v_pk_add_f32 v[180:181], v[180:181], s[72:73]
    v_pk_add_f32 v[182:183], v[182:183], s[72:73]
    v_max_f32 v164, v164, v16
    v_max_f32 v165, v165, v17
    v_max_f32 v166, v166, v18
    v_max_f32 v167, v167, v19
    v_max_f32 v180, v180, v20
    v_max_f32 v181, v181, v21
    v_max_f32 v182, v182, v22
    v_max_f32 v183, v183, v23
    v_pk_add_f32 v[164:165], v[164:165], s[76:77]
    v_pk_add_f32 v[166:167], v[166:167], s[76:77]
    v_pk_add_f32 v[180:181], v[180:181], s[76:77]
    v_pk_add_f32 v[182:183], v[182:183], s[76:77]
    v_cvt_pk_bf16_f32 v164, v164, v165
    v_cvt_pk_bf16_f32 v165, v166, v167
    v_cvt_pk_bf16_f32 v166, v180, v181
    v_cvt_pk_bf16_f32 v167, v182, v183
    buffer_store_dwordx4 v[164:167], v7, s[44:47], s81 offen offset:3072 sc1
    v_pk_mul_f32 v[16:17], v[196:197], s[74:75]
    v_pk_mul_f32 v[18:19], v[198:199], s[74:75]
    v_pk_mul_f32 v[20:21], v[212:213], s[74:75]
    v_pk_mul_f32 v[22:23], v[214:215], s[74:75]
    v_exp_f32_e64 v16, v16 clamp
    v_exp_f32_e64 v17, v17 clamp
    v_exp_f32_e64 v18, v18 clamp
    v_exp_f32_e64 v19, v19 clamp
    v_exp_f32_e64 v20, v20 clamp
    v_exp_f32_e64 v21, v21 clamp
    v_exp_f32_e64 v22, v22 clamp
    v_exp_f32_e64 v23, v23 clamp
    v_pk_add_f32 v[196:197], v[196:197], s[72:73]
    v_pk_add_f32 v[198:199], v[198:199], s[72:73]
    v_pk_add_f32 v[212:213], v[212:213], s[72:73]
    v_pk_add_f32 v[214:215], v[214:215], s[72:73]
    v_max_f32 v196, v196, v16
    v_max_f32 v197, v197, v17
    v_max_f32 v198, v198, v18
    v_max_f32 v199, v199, v19
    v_max_f32 v212, v212, v20
    v_max_f32 v213, v213, v21
    v_max_f32 v214, v214, v22
    v_max_f32 v215, v215, v23
    v_pk_add_f32 v[196:197], v[196:197], s[76:77]
    v_pk_add_f32 v[198:199], v[198:199], s[76:77]
    v_pk_add_f32 v[212:213], v[212:213], s[76:77]
    v_pk_add_f32 v[214:215], v[214:215], s[76:77]
    v_cvt_pk_bf16_f32 v196, v196, v197
    v_cvt_pk_bf16_f32 v197, v198, v199
    v_cvt_pk_bf16_f32 v198, v212, v213
    v_cvt_pk_bf16_f32 v199, v214, v215
    buffer_store_dwordx4 v[196:199], v8, s[44:47], s81 offen sc1
    v_pk_mul_f32 v[16:17], v[72:73], s[74:75]
    v_pk_mul_f32 v[18:19], v[74:75], s[74:75]
    v_pk_mul_f32 v[20:21], v[88:89], s[74:75]
    v_pk_mul_f32 v[22:23], v[90:91], s[74:75]
    v_exp_f32_e64 v16, v16 clamp
    v_exp_f32_e64 v17, v17 clamp
    v_exp_f32_e64 v18, v18 clamp
    v_exp_f32_e64 v19, v19 clamp
    v_exp_f32_e64 v20, v20 clamp
    v_exp_f32_e64 v21, v21 clamp
    v_exp_f32_e64 v22, v22 clamp
    v_exp_f32_e64 v23, v23 clamp
    v_pk_add_f32 v[72:73], v[72:73], s[72:73]
    v_pk_add_f32 v[74:75], v[74:75], s[72:73]
    v_pk_add_f32 v[88:89], v[88:89], s[72:73]
    v_pk_add_f32 v[90:91], v[90:91], s[72:73]
    v_max_f32 v72, v72, v16
    v_max_f32 v73, v73, v17
    v_max_f32 v74, v74, v18
    v_max_f32 v75, v75, v19
    v_max_f32 v88, v88, v20
    v_max_f32 v89, v89, v21
    v_max_f32 v90, v90, v22
    v_max_f32 v91, v91, v23
    v_pk_add_f32 v[72:73], v[72:73], s[76:77]
    v_pk_add_f32 v[74:75], v[74:75], s[76:77]
    v_pk_add_f32 v[88:89], v[88:89], s[76:77]
    v_pk_add_f32 v[90:91], v[90:91], s[76:77]
    v_cvt_pk_bf16_f32 v72, v72, v73
    v_cvt_pk_bf16_f32 v73, v74, v75
    v_cvt_pk_bf16_f32 v74, v88, v89
    v_cvt_pk_bf16_f32 v75, v90, v91
    buffer_store_dwordx4 v[72:75], v7, s[44:47], s82 offen offset:0 sc1
    v_pk_mul_f32 v[16:17], v[104:105], s[74:75]
    v_pk_mul_f32 v[18:19], v[106:107], s[74:75]
    v_pk_mul_f32 v[20:21], v[120:121], s[74:75]
    v_pk_mul_f32 v[22:23], v[122:123], s[74:75]
    v_exp_f32_e64 v16, v16 clamp
    v_exp_f32_e64 v17, v17 clamp
    v_exp_f32_e64 v18, v18 clamp
    v_exp_f32_e64 v19, v19 clamp
    v_exp_f32_e64 v20, v20 clamp
    v_exp_f32_e64 v21, v21 clamp
    v_exp_f32_e64 v22, v22 clamp
    v_exp_f32_e64 v23, v23 clamp
    v_pk_add_f32 v[104:105], v[104:105], s[72:73]
    v_pk_add_f32 v[106:107], v[106:107], s[72:73]
    v_pk_add_f32 v[120:121], v[120:121], s[72:73]
    v_pk_add_f32 v[122:123], v[122:123], s[72:73]
    v_max_f32 v104, v104, v16
    v_max_f32 v105, v105, v17
    v_max_f32 v106, v106, v18
    v_max_f32 v107, v107, v19
    v_max_f32 v120, v120, v20
    v_max_f32 v121, v121, v21
    v_max_f32 v122, v122, v22
    v_max_f32 v123, v123, v23
    v_pk_add_f32 v[104:105], v[104:105], s[76:77]
    v_pk_add_f32 v[106:107], v[106:107], s[76:77]
    v_pk_add_f32 v[120:121], v[120:121], s[76:77]
    v_pk_add_f32 v[122:123], v[122:123], s[76:77]
    v_cvt_pk_bf16_f32 v104, v104, v105
    v_cvt_pk_bf16_f32 v105, v106, v107
    v_cvt_pk_bf16_f32 v106, v120, v121
    v_cvt_pk_bf16_f32 v107, v122, v123
    buffer_store_dwordx4 v[104:107], v7, s[44:47], s82 offen offset:1024 sc1
    v_pk_mul_f32 v[16:17], v[136:137], s[74:75]
    v_pk_mul_f32 v[18:19], v[138:139], s[74:75]
    v_pk_mul_f32 v[20:21], v[152:153], s[74:75]
    v_pk_mul_f32 v[22:23], v[154:155], s[74:75]
    v_exp_f32_e64 v16, v16 clamp
    v_exp_f32_e64 v17, v17 clamp
    v_exp_f32_e64 v18, v18 clamp
    v_exp_f32_e64 v19, v19 clamp
    v_exp_f32_e64 v20, v20 clamp
    v_exp_f32_e64 v21, v21 clamp
    v_exp_f32_e64 v22, v22 clamp
    v_exp_f32_e64 v23, v23 clamp
    v_pk_add_f32 v[136:137], v[136:137], s[72:73]
    v_pk_add_f32 v[138:139], v[138:139], s[72:73]
    v_pk_add_f32 v[152:153], v[152:153], s[72:73]
    v_pk_add_f32 v[154:155], v[154:155], s[72:73]
    v_max_f32 v136, v136, v16
    v_max_f32 v137, v137, v17
    v_max_f32 v138, v138, v18
    v_max_f32 v139, v139, v19
    v_max_f32 v152, v152, v20
    v_max_f32 v153, v153, v21
    v_max_f32 v154, v154, v22
    v_max_f32 v155, v155, v23
    v_pk_add_f32 v[136:137], v[136:137], s[76:77]
    v_pk_add_f32 v[138:139], v[138:139], s[76:77]
    v_pk_add_f32 v[152:153], v[152:153], s[76:77]
    v_pk_add_f32 v[154:155], v[154:155], s[76:77]
    v_cvt_pk_bf16_f32 v136, v136, v137
    v_cvt_pk_bf16_f32 v137, v138, v139
    v_cvt_pk_bf16_f32 v138, v152, v153
    v_cvt_pk_bf16_f32 v139, v154, v155
    buffer_store_dwordx4 v[136:139], v7, s[44:47], s82 offen offset:2048 sc1
    v_pk_mul_f32 v[16:17], v[168:169], s[74:75]
    v_pk_mul_f32 v[18:19], v[170:171], s[74:75]
    v_pk_mul_f32 v[20:21], v[184:185], s[74:75]
    v_pk_mul_f32 v[22:23], v[186:187], s[74:75]
    v_exp_f32_e64 v16, v16 clamp
    v_exp_f32_e64 v17, v17 clamp
    v_exp_f32_e64 v18, v18 clamp
    v_exp_f32_e64 v19, v19 clamp
    v_exp_f32_e64 v20, v20 clamp
    v_exp_f32_e64 v21, v21 clamp
    v_exp_f32_e64 v22, v22 clamp
    v_exp_f32_e64 v23, v23 clamp
    v_pk_add_f32 v[168:169], v[168:169], s[72:73]
    v_pk_add_f32 v[170:171], v[170:171], s[72:73]
    v_pk_add_f32 v[184:185], v[184:185], s[72:73]
    v_pk_add_f32 v[186:187], v[186:187], s[72:73]
    v_max_f32 v168, v168, v16
    v_max_f32 v169, v169, v17
    v_max_f32 v170, v170, v18
    v_max_f32 v171, v171, v19
    v_max_f32 v184, v184, v20
    v_max_f32 v185, v185, v21
    v_max_f32 v186, v186, v22
    v_max_f32 v187, v187, v23
    v_pk_add_f32 v[168:169], v[168:169], s[76:77]
    v_pk_add_f32 v[170:171], v[170:171], s[76:77]
    v_pk_add_f32 v[184:185], v[184:185], s[76:77]
    v_pk_add_f32 v[186:187], v[186:187], s[76:77]
    v_cvt_pk_bf16_f32 v168, v168, v169
    v_cvt_pk_bf16_f32 v169, v170, v171
    v_cvt_pk_bf16_f32 v170, v184, v185
    v_cvt_pk_bf16_f32 v171, v186, v187
    buffer_store_dwordx4 v[168:171], v7, s[44:47], s82 offen offset:3072 sc1
    v_pk_mul_f32 v[16:17], v[200:201], s[74:75]
    v_pk_mul_f32 v[18:19], v[202:203], s[74:75]
    v_pk_mul_f32 v[20:21], v[216:217], s[74:75]
    v_pk_mul_f32 v[22:23], v[218:219], s[74:75]
    v_exp_f32_e64 v16, v16 clamp
    v_exp_f32_e64 v17, v17 clamp
    v_exp_f32_e64 v18, v18 clamp
    v_exp_f32_e64 v19, v19 clamp
    v_exp_f32_e64 v20, v20 clamp
    v_exp_f32_e64 v21, v21 clamp
    v_exp_f32_e64 v22, v22 clamp
    v_exp_f32_e64 v23, v23 clamp
    v_pk_add_f32 v[200:201], v[200:201], s[72:73]
    v_pk_add_f32 v[202:203], v[202:203], s[72:73]
    v_pk_add_f32 v[216:217], v[216:217], s[72:73]
    v_pk_add_f32 v[218:219], v[218:219], s[72:73]
    v_max_f32 v200, v200, v16
    v_max_f32 v201, v201, v17
    v_max_f32 v202, v202, v18
    v_max_f32 v203, v203, v19
    v_max_f32 v216, v216, v20
    v_max_f32 v217, v217, v21
    v_max_f32 v218, v218, v22
    v_max_f32 v219, v219, v23
    v_pk_add_f32 v[200:201], v[200:201], s[76:77]
    v_pk_add_f32 v[202:203], v[202:203], s[76:77]
    v_pk_add_f32 v[216:217], v[216:217], s[76:77]
    v_pk_add_f32 v[218:219], v[218:219], s[76:77]
    v_cvt_pk_bf16_f32 v200, v200, v201
    v_cvt_pk_bf16_f32 v201, v202, v203
    v_cvt_pk_bf16_f32 v202, v216, v217
    v_cvt_pk_bf16_f32 v203, v218, v219
    buffer_store_dwordx4 v[200:203], v8, s[44:47], s82 offen sc1
    v_pk_mul_f32 v[16:17], v[76:77], s[74:75]
    v_pk_mul_f32 v[18:19], v[78:79], s[74:75]
    v_pk_mul_f32 v[20:21], v[92:93], s[74:75]
    v_pk_mul_f32 v[22:23], v[94:95], s[74:75]
    v_exp_f32_e64 v16, v16 clamp
    v_exp_f32_e64 v17, v17 clamp
    v_exp_f32_e64 v18, v18 clamp
    v_exp_f32_e64 v19, v19 clamp
    v_exp_f32_e64 v20, v20 clamp
    v_exp_f32_e64 v21, v21 clamp
    v_exp_f32_e64 v22, v22 clamp
    v_exp_f32_e64 v23, v23 clamp
    v_pk_add_f32 v[76:77], v[76:77], s[72:73]
    v_pk_add_f32 v[78:79], v[78:79], s[72:73]
    v_pk_add_f32 v[92:93], v[92:93], s[72:73]
    v_pk_add_f32 v[94:95], v[94:95], s[72:73]
    v_max_f32 v76, v76, v16
    v_max_f32 v77, v77, v17
    v_max_f32 v78, v78, v18
    v_max_f32 v79, v79, v19
    v_max_f32 v92, v92, v20
    v_max_f32 v93, v93, v21
    v_max_f32 v94, v94, v22
    v_max_f32 v95, v95, v23
    v_pk_add_f32 v[76:77], v[76:77], s[76:77]
    v_pk_add_f32 v[78:79], v[78:79], s[76:77]
    v_pk_add_f32 v[92:93], v[92:93], s[76:77]
    v_pk_add_f32 v[94:95], v[94:95], s[76:77]
    v_cvt_pk_bf16_f32 v76, v76, v77
    v_cvt_pk_bf16_f32 v77, v78, v79
    v_cvt_pk_bf16_f32 v78, v92, v93
    v_cvt_pk_bf16_f32 v79, v94, v95
    buffer_store_dwordx4 v[76:79], v7, s[44:47], s83 offen offset:0 sc1
    v_pk_mul_f32 v[16:17], v[108:109], s[74:75]
    v_pk_mul_f32 v[18:19], v[110:111], s[74:75]
    v_pk_mul_f32 v[20:21], v[124:125], s[74:75]
    v_pk_mul_f32 v[22:23], v[126:127], s[74:75]
    v_exp_f32_e64 v16, v16 clamp
    v_exp_f32_e64 v17, v17 clamp
    v_exp_f32_e64 v18, v18 clamp
    v_exp_f32_e64 v19, v19 clamp
    v_exp_f32_e64 v20, v20 clamp
    v_exp_f32_e64 v21, v21 clamp
    v_exp_f32_e64 v22, v22 clamp
    v_exp_f32_e64 v23, v23 clamp
    v_pk_add_f32 v[108:109], v[108:109], s[72:73]
    v_pk_add_f32 v[110:111], v[110:111], s[72:73]
    v_pk_add_f32 v[124:125], v[124:125], s[72:73]
    v_pk_add_f32 v[126:127], v[126:127], s[72:73]
    v_max_f32 v108, v108, v16
    v_max_f32 v109, v109, v17
    v_max_f32 v110, v110, v18
    v_max_f32 v111, v111, v19
    v_max_f32 v124, v124, v20
    v_max_f32 v125, v125, v21
    v_max_f32 v126, v126, v22
    v_max_f32 v127, v127, v23
    v_pk_add_f32 v[108:109], v[108:109], s[76:77]
    v_pk_add_f32 v[110:111], v[110:111], s[76:77]
    v_pk_add_f32 v[124:125], v[124:125], s[76:77]
    v_pk_add_f32 v[126:127], v[126:127], s[76:77]
    v_cvt_pk_bf16_f32 v108, v108, v109
    v_cvt_pk_bf16_f32 v109, v110, v111
    v_cvt_pk_bf16_f32 v110, v124, v125
    v_cvt_pk_bf16_f32 v111, v126, v127
    buffer_store_dwordx4 v[108:111], v7, s[44:47], s83 offen offset:1024 sc1
    v_pk_mul_f32 v[16:17], v[140:141], s[74:75]
    v_pk_mul_f32 v[18:19], v[142:143], s[74:75]
    v_pk_mul_f32 v[20:21], v[156:157], s[74:75]
    v_pk_mul_f32 v[22:23], v[158:159], s[74:75]
    v_exp_f32_e64 v16, v16 clamp
    v_exp_f32_e64 v17, v17 clamp
    v_exp_f32_e64 v18, v18 clamp
    v_exp_f32_e64 v19, v19 clamp
    v_exp_f32_e64 v20, v20 clamp
    v_exp_f32_e64 v21, v21 clamp
    v_exp_f32_e64 v22, v22 clamp
    v_exp_f32_e64 v23, v23 clamp
    v_pk_add_f32 v[140:141], v[140:141], s[72:73]
    v_pk_add_f32 v[142:143], v[142:143], s[72:73]
    v_pk_add_f32 v[156:157], v[156:157], s[72:73]
    v_pk_add_f32 v[158:159], v[158:159], s[72:73]
    v_max_f32 v140, v140, v16
    v_max_f32 v141, v141, v17
    v_max_f32 v142, v142, v18
    v_max_f32 v143, v143, v19
    v_max_f32 v156, v156, v20
    v_max_f32 v157, v157, v21
    v_max_f32 v158, v158, v22
    v_max_f32 v159, v159, v23
    v_pk_add_f32 v[140:141], v[140:141], s[76:77]
    v_pk_add_f32 v[142:143], v[142:143], s[76:77]
    v_pk_add_f32 v[156:157], v[156:157], s[76:77]
    v_pk_add_f32 v[158:159], v[158:159], s[76:77]
    v_cvt_pk_bf16_f32 v140, v140, v141
    v_cvt_pk_bf16_f32 v141, v142, v143
    v_cvt_pk_bf16_f32 v142, v156, v157
    v_cvt_pk_bf16_f32 v143, v158, v159
    buffer_store_dwordx4 v[140:143], v7, s[44:47], s83 offen offset:2048 sc1
    v_pk_mul_f32 v[16:17], v[172:173], s[74:75]
    v_pk_mul_f32 v[18:19], v[174:175], s[74:75]
    v_pk_mul_f32 v[20:21], v[188:189], s[74:75]
    v_pk_mul_f32 v[22:23], v[190:191], s[74:75]
    v_exp_f32_e64 v16, v16 clamp
    v_exp_f32_e64 v17, v17 clamp
    v_exp_f32_e64 v18, v18 clamp
    v_exp_f32_e64 v19, v19 clamp
    v_exp_f32_e64 v20, v20 clamp
    v_exp_f32_e64 v21, v21 clamp
    v_exp_f32_e64 v22, v22 clamp
    v_exp_f32_e64 v23, v23 clamp
    v_pk_add_f32 v[172:173], v[172:173], s[72:73]
    v_pk_add_f32 v[174:175], v[174:175], s[72:73]
    v_pk_add_f32 v[188:189], v[188:189], s[72:73]
    v_pk_add_f32 v[190:191], v[190:191], s[72:73]
    v_max_f32 v172, v172, v16
    v_max_f32 v173, v173, v17
    v_max_f32 v174, v174, v18
    v_max_f32 v175, v175, v19
    v_max_f32 v188, v188, v20
    v_max_f32 v189, v189, v21
    v_max_f32 v190, v190, v22
    v_max_f32 v191, v191, v23
    v_pk_add_f32 v[172:173], v[172:173], s[76:77]
    v_pk_add_f32 v[174:175], v[174:175], s[76:77]
    v_pk_add_f32 v[188:189], v[188:189], s[76:77]
    v_pk_add_f32 v[190:191], v[190:191], s[76:77]
    v_cvt_pk_bf16_f32 v172, v172, v173
    v_cvt_pk_bf16_f32 v173, v174, v175
    v_cvt_pk_bf16_f32 v174, v188, v189
    v_cvt_pk_bf16_f32 v175, v190, v191
    buffer_store_dwordx4 v[172:175], v7, s[44:47], s83 offen offset:3072 sc1
    v_pk_mul_f32 v[16:17], v[204:205], s[74:75]
    v_pk_mul_f32 v[18:19], v[206:207], s[74:75]
    v_pk_mul_f32 v[20:21], v[220:221], s[74:75]
    v_pk_mul_f32 v[22:23], v[222:223], s[74:75]
    v_exp_f32_e64 v16, v16 clamp
    v_exp_f32_e64 v17, v17 clamp
    v_exp_f32_e64 v18, v18 clamp
    v_exp_f32_e64 v19, v19 clamp
    v_exp_f32_e64 v20, v20 clamp
    v_exp_f32_e64 v21, v21 clamp
    v_exp_f32_e64 v22, v22 clamp
    v_exp_f32_e64 v23, v23 clamp
    v_pk_add_f32 v[204:205], v[204:205], s[72:73]
    v_pk_add_f32 v[206:207], v[206:207], s[72:73]
    v_pk_add_f32 v[220:221], v[220:221], s[72:73]
    v_pk_add_f32 v[222:223], v[222:223], s[72:73]
    v_max_f32 v204, v204, v16
    v_max_f32 v205, v205, v17
    v_max_f32 v206, v206, v18
    v_max_f32 v207, v207, v19
    v_max_f32 v220, v220, v20
    v_max_f32 v221, v221, v21
    v_max_f32 v222, v222, v22
    v_max_f32 v223, v223, v23
    v_pk_add_f32 v[204:205], v[204:205], s[76:77]
    v_pk_add_f32 v[206:207], v[206:207], s[76:77]
    v_pk_add_f32 v[220:221], v[220:221], s[76:77]
    v_pk_add_f32 v[222:223], v[222:223], s[76:77]
    v_cvt_pk_bf16_f32 v204, v204, v205
    v_cvt_pk_bf16_f32 v205, v206, v207
    v_cvt_pk_bf16_f32 v206, v220, v221
    v_cvt_pk_bf16_f32 v207, v222, v223
    buffer_store_dwordx4 v[204:207], v8, s[44:47], s83 offen sc1
    s_mov_b32 s49, 1
    s_lshl_b32 s4, s52, 7
    s_lshl_b32 s5, s53, 2
    s_add_u32 s4, s4, s5
    s_add_u32 s55, s4, 72
    s_branch L_p2_main_entry
L_cons_kv:
    v_and_b32 v7, 15, v0
    v_lshrrev_b32 v8, 4, v0
    v_lshrrev_b32 v9, 1, v7
    v_xor_b32 v9, v9, v8
    v_lshlrev_b32 v9, 4, v9
    v_lshl_add_u32 v9, v7, 7, v9
    s_lshl_b32 s4, s3, 13
    v_add_u32 v2, s4, v9
    v_xor_b32 v3, 64, v2
    v_lshrrev_b32 v9, 1, v8
    v_mul_u32_u24 v9, 0x1800, v9
    v_and_b32 v10, 1, v8
    v_mul_u32_u24 v10, 0x220, v10
    v_add_u32 v9, v9, v10
    v_bfe_u32 v10, v0, 2, 2
    v_lshl_add_u32 v9, v10, 6, v9
    v_and_b32 v10, 3, v0
    v_lshl_add_u32 v9, v10, 3, v9
    v_add_u32 v4, 0x18000, v9
    v_xor_b32 v5, 32, v4
    v_mov_b32 v64, 0
    v_mov_b32 v65, 0
    v_mov_b32 v66, 0
    v_mov_b32 v67, 0
    v_mov_b32 v68, 0
    v_mov_b32 v69, 0
    v_mov_b32 v70, 0
    v_mov_b32 v71, 0
    v_mov_b32 v72, 0
    v_mov_b32 v73, 0
    v_mov_b32 v74, 0
    v_mov_b32 v75, 0
    v_mov_b32 v76, 0
    v_mov_b32 v77, 0
    v_mov_b32 v78, 0
    v_mov_b32 v79, 0
    v_mov_b32 v80, 0
    v_mov_b32 v81, 0
    v_mov_b32 v82, 0
    v_mov_b32 v83, 0
    v_mov_b32 v84, 0
    v_mov_b32 v85, 0
    v_mov_b32 v86, 0
    v_mov_b32 v87, 0
    v_mov_b32 v88, 0
    v_mov_b32 v89, 0
    v_mov_b32 v90, 0
    v_mov_b32 v91, 0
    v_mov_b32 v92, 0
    v_mov_b32 v93, 0
    v_mov_b32 v94, 0
    v_mov_b32 v95, 0
    v_mov_b32 v96, 0
    v_mov_b32 v97, 0
    v_mov_b32 v98, 0
    v_mov_b32 v99, 0
    v_mov_b32 v100, 0
    v_mov_b32 v101, 0
    v_mov_b32 v102, 0
    v_mov_b32 v103, 0
    v_mov_b32 v104, 0
    v_mov_b32 v105, 0
    v_mov_b32 v106, 0
    v_mov_b32 v107, 0
    v_mov_b32 v108, 0
    v_mov_b32 v109, 0
    v_mov_b32 v110, 0
    v_mov_b32 v111, 0
    v_mov_b32 v112, 0
    v_mov_b32 v113, 0
    v_mov_b32 v114, 0
    v_mov_b32 v115, 0
    v_mov_b32 v116, 0
    v_mov_b32 v117, 0
    v_mov_b32 v118, 0
    v_mov_b32 v119, 0
    v_mov_b32 v120, 0
    v_mov_b32 v121, 0
    v_mov_b32 v122, 0
    v_mov_b32 v123, 0
    v_mov_b32 v124, 0
    v_mov_b32 v125, 0
    v_mov_b32 v126, 0
    v_mov_b32 v127, 0
    v_mov_b32 v128, 0
    v_mov_b32 v129, 0
    v_mov_b32 v130, 0
    v_mov_b32 v131, 0
    v_mov_b32 v132, 0
    v_mov_b32 v133, 0
    v_mov_b32 v134, 0
    v_mov_b32 v135, 0
    v_mov_b32 v136, 0
    v_mov_b32 v137, 0
    v_mov_b32 v138, 0
    v_mov_b32 v139, 0
    v_mov_b32 v140, 0
    v_mov_b32 v141, 0
    v_mov_b32 v142, 0
    v_mov_b32 v143, 0
    v_mov_b32 v144, 0
    v_mov_b32 v145, 0
    v_mov_b32 v146, 0
    v_mov_b32 v147, 0
    v_mov_b32 v148, 0
    v_mov_b32 v149, 0
    v_mov_b32 v150, 0
    v_mov_b32 v151, 0
    v_mov_b32 v152, 0
    v_mov_b32 v153, 0
    v_mov_b32 v154, 0
    v_mov_b32 v155, 0
    v_mov_b32 v156, 0
    v_mov_b32 v157, 0
    v_mov_b32 v158, 0
    v_mov_b32 v159, 0
    v_mov_b32 v160, 0
    v_mov_b32 v161, 0
    v_mov_b32 v162, 0
    v_mov_b32 v163, 0
    v_mov_b32 v164, 0
    v_mov_b32 v165, 0
    v_mov_b32 v166, 0
    v_mov_b32 v167, 0
    v_mov_b32 v168, 0
    v_mov_b32 v169, 0
    v_mov_b32 v170, 0
    v_mov_b32 v171, 0
    v_mov_b32 v172, 0
    v_mov_b32 v173, 0
    v_mov_b32 v174, 0
    v_mov_b32 v175, 0
    v_mov_b32 v176, 0
    v_mov_b32 v177, 0
    v_mov_b32 v178, 0
    v_mov_b32 v179, 0
    v_mov_b32 v180, 0
    v_mov_b32 v181, 0
    v_mov_b32 v182, 0
    v_mov_b32 v183, 0
    v_mov_b32 v184, 0
    v_mov_b32 v185, 0
    v_mov_b32 v186, 0
    v_mov_b32 v187, 0
    v_mov_b32 v188, 0
    v_mov_b32 v189, 0
    v_mov_b32 v190, 0
    v_mov_b32 v191, 0
    v_mov_b32 v192, 0
    v_mov_b32 v193, 0
    v_mov_b32 v194, 0
    v_mov_b32 v195, 0
    v_mov_b32 v196, 0
    v_mov_b32 v197, 0
    v_mov_b32 v198, 0
    v_mov_b32 v199, 0
    v_mov_b32 v200, 0
    v_mov_b32 v201, 0
    v_mov_b32 v202, 0
    v_mov_b32 v203, 0
    v_mov_b32 v204, 0
    v_mov_b32 v205, 0
    v_mov_b32 v206, 0
    v_mov_b32 v207, 0
    v_mov_b32 v208, 0
    v_mov_b32 v209, 0
    v_mov_b32 v210, 0
    v_mov_b32 v211, 0
    v_mov_b32 v212, 0
    v_mov_b32 v213, 0
    v_mov_b32 v214, 0
    v_mov_b32 v215, 0
    v_mov_b32 v216, 0
    v_mov_b32 v217, 0
    v_mov_b32 v218, 0
    v_mov_b32 v219, 0
    v_mov_b32 v220, 0
    v_mov_b32 v221, 0
    v_mov_b32 v222, 0
    v_mov_b32 v223, 0
    s_mov_b32 s61, 0
    s_mov_b32 s62, 0
    s_mov_b32 s63, 10
    s_mov_b32 s66, 0xffff4000
    s_mov_b32 s67, 12288
    s_mov_b32 s68, 0xffff0000
    s_mov_b32 s69, 32768
    s_mov_b32 s70, 0xbfb8aa3b
    s_mov_b32 s71, 0xbfb8aa3b
    s_mov_b32 s72, 1.0
    s_mov_b32 s73, 1.0
    s_mov_b32 s74, 0x3fb8aa3b
    s_mov_b32 s75, 0x3fb8aa3b
    s_mov_b32 s76, 0x358637bd
    s_mov_b32 s77, 0x358637bd
    s_cmp_lg_u32 s3, 0
    s_cbranch_scc1 L_cT_skip3
    s_mov_b32 s40, s34
    s_mov_b32 s41, s35
    s_mov_b32 s42, 0x100
    s_mov_b32 s43, 0x20000
    v_mov_b32 v7, 0
L_cT3_T:
    buffer_load_dword v8, v7, s[40:43], 0 offen sc1
    s_waitcnt vmcnt(0)
    v_readfirstlane_b32 s92, v8
    s_nop 3
    s_cmp_lg_u32 s92, 0
    s_cbranch_scc1 L_cT3_Tok
    s_sleep 8
    s_branch L_cT3_T
L_cT3_Tok:
L_cT_skip3:
    s_barrier
    ds_read_b128 v[16:19], v2 offset:0
    ds_read_b128 v[20:23], v2 offset:2048
    ds_read_b128 v[24:27], v2 offset:4096
    ds_read_b128 v[28:31], v2 offset:6144
    ds_read_b64_tr_b16 v[48:49], v4 offset:0
    ds_read_b64_tr_b16 v[50:51], v4 offset:256
    ds_read_b64_tr_b16 v[52:53], v5 offset:0
    ds_read_b64_tr_b16 v[54:55], v5 offset:256
    ds_read_b64_tr_b16 v[56:57], v4 offset:1024
    ds_read_b64_tr_b16 v[58:59], v4 offset:1280
    s_waitcnt lgkmcnt(0)
L_kv_loop:
    s_waitcnt lgkmcnt(4)
    v_mfma_f32_16x16x32_bf16 v[64:67], v[16:19], v[48:51], v[64:67]
    s_add_u32 s61, s61, 1
    s_cmp_eq_u32 s61, 5
    v_mfma_f32_16x16x32_bf16 v[68:71], v[20:23], v[48:51], v[68:71]
    s_cselect_b32 s61, 0, s61
    s_cselect_b32 s64, s66, s67
    v_mfma_f32_16x16x32_bf16 v[72:75], v[24:27], v[48:51], v[72:75]
    ds_read_b64_tr_b16 v[60:61], v5 offset:1024
    v_mfma_f32_16x16x32_bf16 v[76:79], v[28:31], v[48:51], v[76:79]
    ds_read_b64_tr_b16 v[62:63], v5 offset:1280
    s_waitcnt lgkmcnt(4)
    v_mfma_f32_16x16x32_bf16 v[80:83], v[16:19], v[52:55], v[80:83]
    s_barrier
    s_add_u32 s62, s62, 1
    v_mfma_f32_16x16x32_bf16 v[84:87], v[20:23], v[52:55], v[84:87]
    s_cmp_eq_u32 s62, 3
    s_cselect_b32 s62, 0, s62
    v_mfma_f32_16x16x32_bf16 v[88:91], v[24:27], v[52:55], v[88:91]
    s_cselect_b32 s65, s68, s69
    ds_read_b64_tr_b16 v[48:49], v4 offset:2048
    v_mfma_f32_16x16x32_bf16 v[92:95], v[28:31], v[52:55], v[92:95]
    ds_read_b64_tr_b16 v[50:51], v4 offset:2304
    s_waitcnt lgkmcnt(4)
    v_mfma_f32_16x16x32_bf16 v[96:99], v[16:19], v[56:59], v[96:99]
    ds_read_b64_tr_b16 v[52:53], v5 offset:2048
    v_mfma_f32_16x16x32_bf16 v[100:103], v[20:23], v[56:59], v[100:103]
    ds_read_b64_tr_b16 v[54:55], v5 offset:2304
    v_mfma_f32_16x16x32_bf16 v[104:107], v[24:27], v[56:59], v[104:107]
    ds_read_b128 v[32:35], v3 offset:0
    v_mfma_f32_16x16x32_bf16 v[108:111], v[28:31], v[56:59], v[108:111]
    s_waitcnt lgkmcnt(5)
    v_mfma_f32_16x16x32_bf16 v[112:115], v[16:19], v[60:63], v[112:115]
    ds_read_b64_tr_b16 v[56:57], v4 offset:3072
    v_mfma_f32_16x16x32_bf16 v[116:119], v[20:23], v[60:63], v[116:119]
    ds_read_b64_tr_b16 v[58:59], v4 offset:3328
    v_mfma_f32_16x16x32_bf16 v[120:123], v[24:27], v[60:63], v[120:123]
    ds_read_b128 v[36:39], v3 offset:2048
    v_mfma_f32_16x16x32_bf16 v[124:127], v[28:31], v[60:63], v[124:127]
    s_waitcnt lgkmcnt(6)
    v_mfma_f32_16x16x32_bf16 v[128:131], v[16:19], v[48:51], v[128:131]
    ds_read_b64_tr_b16 v[60:61], v5 offset:3072
    v_mfma_f32_16x16x32_bf16 v[132:135], v[20:23], v[48:51], v[132:135]
    ds_read_b64_tr_b16 v[62:63], v5 offset:3328
    v_mfma_f32_16x16x32_bf16 v[136:139], v[24:27], v[48:51], v[136:139]
    ds_read_b128 v[40:43], v3 offset:4096
    v_mfma_f32_16x16x32_bf16 v[140:143], v[28:31], v[48:51], v[140:143]
    s_waitcnt lgkmcnt(7)
    v_mfma_f32_16x16x32_bf16 v[144:147], v[16:19], v[52:55], v[144:147]
    ds_read_b64_tr_b16 v[48:49], v4 offset:4096
    v_mfma_f32_16x16x32_bf16 v[148:151], v[20:23], v[52:55], v[148:151]
    ds_read_b64_tr_b16 v[50:51], v4 offset:4352
    v_mfma_f32_16x16x32_bf16 v[152:155], v[24:27], v[52:55], v[152:155]
    ds_read_b128 v[44:47], v3 offset:6144
    v_mfma_f32_16x16x32_bf16 v[156:159], v[28:31], v[52:55], v[156:159]
    s_waitcnt lgkmcnt(7)
    v_mfma_f32_16x16x32_bf16 v[160:163], v[16:19], v[56:59], v[160:163]
    ds_read_b64_tr_b16 v[52:53], v5 offset:4096
    v_mfma_f32_16x16x32_bf16 v[164:167], v[20:23], v[56:59], v[164:167]
    ds_read_b64_tr_b16 v[54:55], v5 offset:4352
    v_mfma_f32_16x16x32_bf16 v[168:171], v[24:27], v[56:59], v[168:171]
    v_add_u32 v3, s65, v3
    v_mfma_f32_16x16x32_bf16 v[172:175], v[28:31], v[56:59], v[172:175]
    s_waitcnt lgkmcnt(6)
    v_mfma_f32_16x16x32_bf16 v[176:179], v[16:19], v[60:63], v[176:179]
    v_add_u32 v4, s64, v4
    v_mfma_f32_16x16x32_bf16 v[180:183], v[20:23], v[60:63], v[180:183]
    v_add_u32 v5, s64, v5
    v_mfma_f32_16x16x32_bf16 v[184:187], v[24:27], v[60:63], v[184:187]
    ds_read_b64_tr_b16 v[56:57], v4 offset:0
    v_mfma_f32_16x16x32_bf16 v[188:191], v[28:31], v[60:63], v[188:191]
    ds_read_b64_tr_b16 v[58:59], v4 offset:256
    s_waitcnt lgkmcnt(5)
    v_mfma_f32_16x16x32_bf16 v[192:195], v[16:19], v[48:51], v[192:195]
    ds_read_b64_tr_b16 v[60:61], v5 offset:0
    v_mfma_f32_16x16x32_bf16 v[196:199], v[20:23], v[48:51], v[196:199]
    ds_read_b64_tr_b16 v[62:63], v5 offset:256
    v_mfma_f32_16x16x32_bf16 v[200:203], v[24:27], v[48:51], v[200:203]
    v_mfma_f32_16x16x32_bf16 v[204:207], v[28:31], v[48:51], v[204:207]
    s_waitcnt lgkmcnt(4)
    v_mfma_f32_16x16x32_bf16 v[208:211], v[16:19], v[52:55], v[208:211]
    ds_read_b64_tr_b16 v[48:49], v4 offset:1024
    v_mfma_f32_16x16x32_bf16 v[212:215], v[20:23], v[52:55], v[212:215]
    ds_read_b64_tr_b16 v[50:51], v4 offset:1280
    v_mfma_f32_16x16x32_bf16 v[216:219], v[24:27], v[52:55], v[216:219]
    v_mfma_f32_16x16x32_bf16 v[220:223], v[28:31], v[52:55], v[220:223]
    s_waitcnt lgkmcnt(4)
    v_mfma_f32_16x16x32_bf16 v[64:67], v[32:35], v[56:59], v[64:67]
    s_add_u32 s61, s61, 1
    s_cmp_eq_u32 s61, 5
    v_mfma_f32_16x16x32_bf16 v[68:71], v[36:39], v[56:59], v[68:71]
    s_cselect_b32 s61, 0, s61
    s_cselect_b32 s64, s66, s67
    v_mfma_f32_16x16x32_bf16 v[72:75], v[40:43], v[56:59], v[72:75]
    ds_read_b64_tr_b16 v[52:53], v5 offset:1024
    v_mfma_f32_16x16x32_bf16 v[76:79], v[44:47], v[56:59], v[76:79]
    ds_read_b64_tr_b16 v[54:55], v5 offset:1280
    s_waitcnt lgkmcnt(4)
    v_mfma_f32_16x16x32_bf16 v[80:83], v[32:35], v[60:63], v[80:83]
    s_barrier
    v_mfma_f32_16x16x32_bf16 v[84:87], v[36:39], v[60:63], v[84:87]
    v_add_u32 v2, s65, v2
    v_mfma_f32_16x16x32_bf16 v[88:91], v[40:43], v[60:63], v[88:91]
    ds_read_b64_tr_b16 v[56:57], v4 offset:2048
    v_mfma_f32_16x16x32_bf16 v[92:95], v[44:47], v[60:63], v[92:95]
    ds_read_b64_tr_b16 v[58:59], v4 offset:2304
    s_waitcnt lgkmcnt(4)
    v_mfma_f32_16x16x32_bf16 v[96:99], v[32:35], v[48:51], v[96:99]
    ds_read_b64_tr_b16 v[60:61], v5 offset:2048
    v_mfma_f32_16x16x32_bf16 v[100:103], v[36:39], v[48:51], v[100:103]
    ds_read_b64_tr_b16 v[62:63], v5 offset:2304
    v_mfma_f32_16x16x32_bf16 v[104:107], v[40:43], v[48:51], v[104:107]
    ds_read_b128 v[16:19], v2 offset:0
    v_mfma_f32_16x16x32_bf16 v[108:111], v[44:47], v[48:51], v[108:111]
    s_waitcnt lgkmcnt(5)
    v_mfma_f32_16x16x32_bf16 v[112:115], v[32:35], v[52:55], v[112:115]
    ds_read_b64_tr_b16 v[48:49], v4 offset:3072
    v_mfma_f32_16x16x32_bf16 v[116:119], v[36:39], v[52:55], v[116:119]
    ds_read_b64_tr_b16 v[50:51], v4 offset:3328
    v_mfma_f32_16x16x32_bf16 v[120:123], v[40:43], v[52:55], v[120:123]
    ds_read_b128 v[20:23], v2 offset:2048
    v_mfma_f32_16x16x32_bf16 v[124:127], v[44:47], v[52:55], v[124:127]
    s_waitcnt lgkmcnt(6)
    v_mfma_f32_16x16x32_bf16 v[128:131], v[32:35], v[56:59], v[128:131]
    ds_read_b64_tr_b16 v[52:53], v5 offset:3072
    v_mfma_f32_16x16x32_bf16 v[132:135], v[36:39], v[56:59], v[132:135]
    ds_read_b64_tr_b16 v[54:55], v5 offset:3328
    v_mfma_f32_16x16x32_bf16 v[136:139], v[40:43], v[56:59], v[136:139]
    ds_read_b128 v[24:27], v2 offset:4096
    v_mfma_f32_16x16x32_bf16 v[140:143], v[44:47], v[56:59], v[140:143]
    s_waitcnt lgkmcnt(7)
    v_mfma_f32_16x16x32_bf16 v[144:147], v[32:35], v[60:63], v[144:147]
    ds_read_b64_tr_b16 v[56:57], v4 offset:4096
    v_mfma_f32_16x16x32_bf16 v[148:151], v[36:39], v[60:63], v[148:151]
    ds_read_b64_tr_b16 v[58:59], v4 offset:4352
    v_mfma_f32_16x16x32_bf16 v[152:155], v[40:43], v[60:63], v[152:155]
    ds_read_b128 v[28:31], v2 offset:6144
    v_mfma_f32_16x16x32_bf16 v[156:159], v[44:47], v[60:63], v[156:159]
    s_waitcnt lgkmcnt(7)
    v_mfma_f32_16x16x32_bf16 v[160:163], v[32:35], v[48:51], v[160:163]
    ds_read_b64_tr_b16 v[60:61], v5 offset:4096
    v_mfma_f32_16x16x32_bf16 v[164:167], v[36:39], v[48:51], v[164:167]
    ds_read_b64_tr_b16 v[62:63], v5 offset:4352
    v_mfma_f32_16x16x32_bf16 v[168:171], v[40:43], v[48:51], v[168:171]
    v_mfma_f32_16x16x32_bf16 v[172:175], v[44:47], v[48:51], v[172:175]
    s_waitcnt lgkmcnt(6)
    v_mfma_f32_16x16x32_bf16 v[176:179], v[32:35], v[52:55], v[176:179]
    v_add_u32 v4, s64, v4
    v_mfma_f32_16x16x32_bf16 v[180:183], v[36:39], v[52:55], v[180:183]
    v_add_u32 v5, s64, v5
    v_mfma_f32_16x16x32_bf16 v[184:187], v[40:43], v[52:55], v[184:187]
    ds_read_b64_tr_b16 v[48:49], v4 offset:0
    v_mfma_f32_16x16x32_bf16 v[188:191], v[44:47], v[52:55], v[188:191]
    ds_read_b64_tr_b16 v[50:51], v4 offset:256
    s_waitcnt lgkmcnt(5)
    v_mfma_f32_16x16x32_bf16 v[192:195], v[32:35], v[56:59], v[192:195]
    ds_read_b64_tr_b16 v[52:53], v5 offset:0
    v_mfma_f32_16x16x32_bf16 v[196:199], v[36:39], v[56:59], v[196:199]
    ds_read_b64_tr_b16 v[54:55], v5 offset:256
    v_mfma_f32_16x16x32_bf16 v[200:203], v[40:43], v[56:59], v[200:203]
    v_mfma_f32_16x16x32_bf16 v[204:207], v[44:47], v[56:59], v[204:207]
    s_waitcnt lgkmcnt(4)
    v_mfma_f32_16x16x32_bf16 v[208:211], v[32:35], v[60:63], v[208:211]
    ds_read_b64_tr_b16 v[56:57], v4 offset:1024
    v_mfma_f32_16x16x32_bf16 v[212:215], v[36:39], v[60:63], v[212:215]
    ds_read_b64_tr_b16 v[58:59], v4 offset:1280
    v_mfma_f32_16x16x32_bf16 v[216:219], v[40:43], v[60:63], v[216:219]
    v_mfma_f32_16x16x32_bf16 v[220:223], v[44:47], v[60:63], v[220:223]
    s_sub_u32 s63, s63, 1
    s_cmp_lg_u32 s63, 0
    s_cbranch_scc1 L_kv_loop
    s_waitcnt lgkmcnt(0)
    s_barrier
    s_nop 7
    s_add_u32 s44, s36, 0xe00000
    s_addc_u32 s45, s37, 0
    s_mov_b32 s46, 0x1b000
    s_mov_b32 s47, 0x20000
    v_lshlrev_b32 v7, 4, v0
    v_mov_b32 v24, 0x3f803f80
    v_mov_b32 v25, 0x3f803f80
    v_mov_b32 v26, 0x3f803f80
    v_mov_b32 v27, 0x3f803f80
    v_pk_mul_f32 v[16:17], v[64:65], s[74:75]
    v_pk_mul_f32 v[18:19], v[66:67], s[74:75]
    v_pk_mul_f32 v[20:21], v[68:69], s[74:75]
    v_pk_mul_f32 v[22:23], v[70:71], s[74:75]
    v_exp_f32_e64 v16, v16 clamp
    v_exp_f32_e64 v17, v17 clamp
    v_exp_f32_e64 v18, v18 clamp
    v_exp_f32_e64 v19, v19 clamp
    v_exp_f32_e64 v20, v20 clamp
    v_exp_f32_e64 v21, v21 clamp
    v_exp_f32_e64 v22, v22 clamp
    v_exp_f32_e64 v23, v23 clamp
    v_pk_add_f32 v[64:65], v[64:65], s[72:73]
    v_pk_add_f32 v[66:67], v[66:67], s[72:73]
    v_pk_add_f32 v[68:69], v[68:69], s[72:73]
    v_pk_add_f32 v[70:71], v[70:71], s[72:73]
    v_max_f32 v64, v64, v16
    v_max_f32 v65, v65, v17
    v_max_f32 v66, v66, v18
    v_max_f32 v67, v67, v19
    v_max_f32 v68, v68, v20
    v_max_f32 v69, v69, v21
    v_max_f32 v70, v70, v22
    v_max_f32 v71, v71, v23
    v_pk_add_f32 v[64:65], v[64:65], s[76:77]
    v_pk_add_f32 v[66:67], v[66:67], s[76:77]
    v_pk_add_f32 v[68:69], v[68:69], s[76:77]
    v_pk_add_f32 v[70:71], v[70:71], s[76:77]
    v_pk_mul_f32 v[16:17], v[80:81], s[74:75]
    v_pk_mul_f32 v[18:19], v[82:83], s[74:75]
    v_pk_mul_f32 v[20:21], v[84:85], s[74:75]
    v_pk_mul_f32 v[22:23], v[86:87], s[74:75]
    v_exp_f32_e64 v16, v16 clamp
    v_exp_f32_e64 v17, v17 clamp
    v_exp_f32_e64 v18, v18 clamp
    v_exp_f32_e64 v19, v19 clamp
    v_exp_f32_e64 v20, v20 clamp
    v_exp_f32_e64 v21, v21 clamp
    v_exp_f32_e64 v22, v22 clamp
    v_exp_f32_e64 v23, v23 clamp
    v_pk_add_f32 v[80:81], v[80:81], s[72:73]
    v_pk_add_f32 v[82:83], v[82:83], s[72:73]
    v_pk_add_f32 v[84:85], v[84:85], s[72:73]
    v_pk_add_f32 v[86:87], v[86:87], s[72:73]
    v_max_f32 v80, v80, v16
    v_max_f32 v81, v81, v17
    v_max_f32 v82, v82, v18
    v_max_f32 v83, v83, v19
    v_max_f32 v84, v84, v20
    v_max_f32 v85, v85, v21
    v_max_f32 v86, v86, v22
    v_max_f32 v87, v87, v23
    v_pk_add_f32 v[80:81], v[80:81], s[76:77]
    v_pk_add_f32 v[82:83], v[82:83], s[76:77]
    v_pk_add_f32 v[84:85], v[84:85], s[76:77]
    v_pk_add_f32 v[86:87], v[86:87], s[76:77]
    v_pk_mul_f32 v[16:17], v[96:97], s[74:75]
    v_pk_mul_f32 v[18:19], v[98:99], s[74:75]
    v_pk_mul_f32 v[20:21], v[100:101], s[74:75]
    v_pk_mul_f32 v[22:23], v[102:103], s[74:75]
    v_exp_f32_e64 v16, v16 clamp
    v_exp_f32_e64 v17, v17 clamp
    v_exp_f32_e64 v18, v18 clamp
    v_exp_f32_e64 v19, v19 clamp
    v_exp_f32_e64 v20, v20 clamp
    v_exp_f32_e64 v21, v21 clamp
    v_exp_f32_e64 v22, v22 clamp
    v_exp_f32_e64 v23, v23 clamp
    v_pk_add_f32 v[96:97], v[96:97], s[72:73]
    v_pk_add_f32 v[98:99], v[98:99], s[72:73]
    v_pk_add_f32 v[100:101], v[100:101], s[72:73]
    v_pk_add_f32 v[102:103], v[102:103], s[72:73]
    v_max_f32 v96, v96, v16
    v_max_f32 v97, v97, v17
    v_max_f32 v98, v98, v18
    v_max_f32 v99, v99, v19
    v_max_f32 v100, v100, v20
    v_max_f32 v101, v101, v21
    v_max_f32 v102, v102, v22
    v_max_f32 v103, v103, v23
    v_pk_add_f32 v[96:97], v[96:97], s[76:77]
    v_pk_add_f32 v[98:99], v[98:99], s[76:77]
    v_pk_add_f32 v[100:101], v[100:101], s[76:77]
    v_pk_add_f32 v[102:103], v[102:103], s[76:77]
    v_pk_mul_f32 v[16:17], v[112:113], s[74:75]
    v_pk_mul_f32 v[18:19], v[114:115], s[74:75]
    v_pk_mul_f32 v[20:21], v[116:117], s[74:75]
    v_pk_mul_f32 v[22:23], v[118:119], s[74:75]
    v_exp_f32_e64 v16, v16 clamp
    v_exp_f32_e64 v17, v17 clamp
    v_exp_f32_e64 v18, v18 clamp
    v_exp_f32_e64 v19, v19 clamp
    v_exp_f32_e64 v20, v20 clamp
    v_exp_f32_e64 v21, v21 clamp
    v_exp_f32_e64 v22, v22 clamp
    v_exp_f32_e64 v23, v23 clamp
    v_pk_add_f32 v[112:113], v[112:113], s[72:73]
    v_pk_add_f32 v[114:115], v[114:115], s[72:73]
    v_pk_add_f32 v[116:117], v[116:117], s[72:73]
    v_pk_add_f32 v[118:119], v[118:119], s[72:73]
    v_max_f32 v112, v112, v16
    v_max_f32 v113, v113, v17
    v_max_f32 v114, v114, v18
    v_max_f32 v115, v115, v19
    v_max_f32 v116, v116, v20
    v_max_f32 v117, v117, v21
    v_max_f32 v118, v118, v22
    v_max_f32 v119, v119, v23
    v_pk_add_f32 v[112:113], v[112:113], s[76:77]
    v_pk_add_f32 v[114:115], v[114:115], s[76:77]
    v_pk_add_f32 v[116:117], v[116:117], s[76:77]
    v_pk_add_f32 v[118:119], v[118:119], s[76:77]
    v_pk_mul_f32 v[16:17], v[128:129], s[74:75]
    v_pk_mul_f32 v[18:19], v[130:131], s[74:75]
    v_pk_mul_f32 v[20:21], v[132:133], s[74:75]
    v_pk_mul_f32 v[22:23], v[134:135], s[74:75]
    v_exp_f32_e64 v16, v16 clamp
    v_exp_f32_e64 v17, v17 clamp
    v_exp_f32_e64 v18, v18 clamp
    v_exp_f32_e64 v19, v19 clamp
    v_exp_f32_e64 v20, v20 clamp
    v_exp_f32_e64 v21, v21 clamp
    v_exp_f32_e64 v22, v22 clamp
    v_exp_f32_e64 v23, v23 clamp
    v_pk_add_f32 v[128:129], v[128:129], s[72:73]
    v_pk_add_f32 v[130:131], v[130:131], s[72:73]
    v_pk_add_f32 v[132:133], v[132:133], s[72:73]
    v_pk_add_f32 v[134:135], v[134:135], s[72:73]
    v_max_f32 v128, v128, v16
    v_max_f32 v129, v129, v17
    v_max_f32 v130, v130, v18
    v_max_f32 v131, v131, v19
    v_max_f32 v132, v132, v20
    v_max_f32 v133, v133, v21
    v_max_f32 v134, v134, v22
    v_max_f32 v135, v135, v23
    v_pk_add_f32 v[128:129], v[128:129], s[76:77]
    v_pk_add_f32 v[130:131], v[130:131], s[76:77]
    v_pk_add_f32 v[132:133], v[132:133], s[76:77]
    v_pk_add_f32 v[134:135], v[134:135], s[76:77]
    v_cvt_pk_bf16_f32 v64, v64, v65
    v_cvt_pk_bf16_f32 v65, v66, v67
    v_cvt_pk_bf16_f32 v66, v68, v69
    v_cvt_pk_bf16_f32 v67, v70, v71
    v_cvt_pk_bf16_f32 v160, v160, v161
    v_cvt_pk_bf16_f32 v161, v162, v163
    v_cvt_pk_bf16_f32 v162, v164, v165
    v_cvt_pk_bf16_f32 v163, v166, v167
    v_cvt_pk_bf16_f32 v80, v80, v81
    v_cvt_pk_bf16_f32 v81, v82, v83
    v_cvt_pk_bf16_f32 v82, v84, v85
    v_cvt_pk_bf16_f32 v83, v86, v87
    v_cvt_pk_bf16_f32 v176, v176, v177
    v_cvt_pk_bf16_f32 v177, v178, v179
    v_cvt_pk_bf16_f32 v178, v180, v181
    v_cvt_pk_bf16_f32 v179, v182, v183
    v_cvt_pk_bf16_f32 v96, v96, v97
    v_cvt_pk_bf16_f32 v97, v98, v99
    v_cvt_pk_bf16_f32 v98, v100, v101
    v_cvt_pk_bf16_f32 v99, v102, v103
    v_cvt_pk_bf16_f32 v192, v192, v193
    v_cvt_pk_bf16_f32 v193, v194, v195
    v_cvt_pk_bf16_f32 v194, v196, v197
    v_cvt_pk_bf16_f32 v195, v198, v199
    v_cvt_pk_bf16_f32 v112, v112, v113
    v_cvt_pk_bf16_f32 v113, v114, v115
    v_cvt_pk_bf16_f32 v114, v116, v117
    v_cvt_pk_bf16_f32 v115, v118, v119
    v_cvt_pk_bf16_f32 v208, v208, v209
    v_cvt_pk_bf16_f32 v209, v210, v211
    v_cvt_pk_bf16_f32 v210, v212, v213
    v_cvt_pk_bf16_f32 v211, v214, v215
    v_cvt_pk_bf16_f32 v128, v128, v129
    v_cvt_pk_bf16_f32 v129, v130, v131
    v_cvt_pk_bf16_f32 v130, v132, v133
    v_cvt_pk_bf16_f32 v131, v134, v135
    v_cvt_pk_bf16_f32 v144, v144, v145
    v_cvt_pk_bf16_f32 v145, v146, v147
    v_cvt_pk_bf16_f32 v146, v148, v149
    v_cvt_pk_bf16_f32 v147, v150, v151
    s_nop 1
    v_mfma_f32_16x16x32_bf16 v[68:71], v[160:163], v[64:67], 0
    v_mfma_f32_16x16x32_bf16 v[84:87], v[160:163], v[80:83], 0
    v_mfma_f32_16x16x32_bf16 v[100:103], v[176:179], v[64:67], 0
    v_mfma_f32_16x16x32_bf16 v[116:119], v[176:179], v[80:83], 0
    v_mfma_f32_16x16x32_bf16 v[132:135], v[176:179], v[96:99], 0
    v_mfma_f32_16x16x32_bf16 v[148:151], v[192:195], v[80:83], 0
    v_mfma_f32_16x16x32_bf16 v[164:167], v[192:195], v[96:99], 0
    v_mfma_f32_16x16x32_bf16 v[180:183], v[192:195], v[112:115], 0
    v_mfma_f32_16x16x32_bf16 v[196:199], v[208:211], v[96:99], 0
    v_mfma_f32_16x16x32_bf16 v[212:215], v[208:211], v[112:115], 0
    v_pk_mul_f32 v[16:17], v[72:73], s[74:75]
    v_pk_mul_f32 v[18:19], v[74:75], s[74:75]
    v_pk_mul_f32 v[20:21], v[76:77], s[74:75]
    v_pk_mul_f32 v[22:23], v[78:79], s[74:75]
    v_exp_f32_e64 v16, v16 clamp
    v_exp_f32_e64 v17, v17 clamp
    v_exp_f32_e64 v18, v18 clamp
    v_exp_f32_e64 v19, v19 clamp
    v_exp_f32_e64 v20, v20 clamp
    v_exp_f32_e64 v21, v21 clamp
    v_exp_f32_e64 v22, v22 clamp
    v_exp_f32_e64 v23, v23 clamp
    v_pk_add_f32 v[72:73], v[72:73], s[72:73]
    v_pk_add_f32 v[74:75], v[74:75], s[72:73]
    v_pk_add_f32 v[76:77], v[76:77], s[72:73]
    v_pk_add_f32 v[78:79], v[78:79], s[72:73]
    v_max_f32 v72, v72, v16
    v_max_f32 v73, v73, v17
    v_max_f32 v74, v74, v18
    v_max_f32 v75, v75, v19
    v_max_f32 v76, v76, v20
    v_max_f32 v77, v77, v21
    v_max_f32 v78, v78, v22
    v_max_f32 v79, v79, v23
    v_pk_add_f32 v[72:73], v[72:73], s[76:77]
    v_pk_add_f32 v[74:75], v[74:75], s[76:77]
    v_pk_add_f32 v[76:77], v[76:77], s[76:77]
    v_pk_add_f32 v[78:79], v[78:79], s[76:77]
    v_pk_mul_f32 v[16:17], v[88:89], s[74:75]
    v_pk_mul_f32 v[18:19], v[90:91], s[74:75]
    v_pk_mul_f32 v[20:21], v[92:93], s[74:75]
    v_pk_mul_f32 v[22:23], v[94:95], s[74:75]
    v_exp_f32_e64 v16, v16 clamp
    v_exp_f32_e64 v17, v17 clamp
    v_exp_f32_e64 v18, v18 clamp
    v_exp_f32_e64 v19, v19 clamp
    v_exp_f32_e64 v20, v20 clamp
    v_exp_f32_e64 v21, v21 clamp
    v_exp_f32_e64 v22, v22 clamp
    v_exp_f32_e64 v23, v23 clamp
    v_pk_add_f32 v[88:89], v[88:89], s[72:73]
    v_pk_add_f32 v[90:91], v[90:91], s[72:73]
    v_pk_add_f32 v[92:93], v[92:93], s[72:73]
    v_pk_add_f32 v[94:95], v[94:95], s[72:73]
    v_max_f32 v88, v88, v16
    v_max_f32 v89, v89, v17
    v_max_f32 v90, v90, v18
    v_max_f32 v91, v91, v19
    v_max_f32 v92, v92, v20
    v_max_f32 v93, v93, v21
    v_max_f32 v94, v94, v22
    v_max_f32 v95, v95, v23
    v_pk_add_f32 v[88:89], v[88:89], s[76:77]
    v_pk_add_f32 v[90:91], v[90:91], s[76:77]
    v_pk_add_f32 v[92:93], v[92:93], s[76:77]
    v_pk_add_f32 v[94:95], v[94:95], s[76:77]
    v_pk_mul_f32 v[16:17], v[104:105], s[74:75]
    v_pk_mul_f32 v[18:19], v[106:107], s[74:75]
    v_pk_mul_f32 v[20:21], v[108:109], s[74:75]
    v_pk_mul_f32 v[22:23], v[110:111], s[74:75]
    v_exp_f32_e64 v16, v16 clamp
    v_exp_f32_e64 v17, v17 clamp
    v_exp_f32_e64 v18, v18 clamp
    v_exp_f32_e64 v19, v19 clamp
    v_exp_f32_e64 v20, v20 clamp
    v_exp_f32_e64 v21, v21 clamp
    v_exp_f32_e64 v22, v22 clamp
    v_exp_f32_e64 v23, v23 clamp
    v_pk_add_f32 v[104:105], v[104:105], s[72:73]
    v_pk_add_f32 v[106:107], v[106:107], s[72:73]
    v_pk_add_f32 v[108:109], v[108:109], s[72:73]
    v_pk_add_f32 v[110:111], v[110:111], s[72:73]
    v_max_f32 v104, v104, v16
    v_max_f32 v105, v105, v17
    v_max_f32 v106, v106, v18
    v_max_f32 v107, v107, v19
    v_max_f32 v108, v108, v20
    v_max_f32 v109, v109, v21
    v_max_f32 v110, v110, v22
    v_max_f32 v111, v111, v23
    v_pk_add_f32 v[104:105], v[104:105], s[76:77]
    v_pk_add_f32 v[106:107], v[106:107], s[76:77]
    v_pk_add_f32 v[108:109], v[108:109], s[76:77]
    v_pk_add_f32 v[110:111], v[110:111], s[76:77]
    v_pk_mul_f32 v[16:17], v[120:121], s[74:75]
    v_pk_mul_f32 v[18:19], v[122:123], s[74:75]
    v_pk_mul_f32 v[20:21], v[124:125], s[74:75]
    v_pk_mul_f32 v[22:23], v[126:127], s[74:75]
    v_exp_f32_e64 v16, v16 clamp
    v_exp_f32_e64 v17, v17 clamp
    v_exp_f32_e64 v18, v18 clamp
    v_exp_f32_e64 v19, v19 clamp
    v_exp_f32_e64 v20, v20 clamp
    v_exp_f32_e64 v21, v21 clamp
    v_exp_f32_e64 v22, v22 clamp
    v_exp_f32_e64 v23, v23 clamp
    v_pk_add_f32 v[120:121], v[120:121], s[72:73]
    v_pk_add_f32 v[122:123], v[122:123], s[72:73]
    v_pk_add_f32 v[124:125], v[124:125], s[72:73]
    v_pk_add_f32 v[126:127], v[126:127], s[72:73]
    v_max_f32 v120, v120, v16
    v_max_f32 v121, v121, v17
    v_max_f32 v122, v122, v18
    v_max_f32 v123, v123, v19
    v_max_f32 v124, v124, v20
    v_max_f32 v125, v125, v21
    v_max_f32 v126, v126, v22
    v_max_f32 v127, v127, v23
    v_pk_add_f32 v[120:121], v[120:121], s[76:77]
    v_pk_add_f32 v[122:123], v[122:123], s[76:77]
    v_pk_add_f32 v[124:125], v[124:125], s[76:77]
    v_pk_add_f32 v[126:127], v[126:127], s[76:77]
    v_pk_mul_f32 v[16:17], v[136:137], s[74:75]
    v_pk_mul_f32 v[18:19], v[138:139], s[74:75]
    v_pk_mul_f32 v[20:21], v[140:141], s[74:75]
    v_pk_mul_f32 v[22:23], v[142:143], s[74:75]
    v_exp_f32_e64 v16, v16 clamp
    v_exp_f32_e64 v17, v17 clamp
    v_exp_f32_e64 v18, v18 clamp
    v_exp_f32_e64 v19, v19 clamp
    v_exp_f32_e64 v20, v20 clamp
    v_exp_f32_e64 v21, v21 clamp
    v_exp_f32_e64 v22, v22 clamp
    v_exp_f32_e64 v23, v23 clamp
    v_pk_add_f32 v[136:137], v[136:137], s[72:73]
    v_pk_add_f32 v[138:139], v[138:139], s[72:73]
    v_pk_add_f32 v[140:141], v[140:141], s[72:73]
    v_pk_add_f32 v[142:143], v[142:143], s[72:73]
    v_max_f32 v136, v136, v16
    v_max_f32 v137, v137, v17
    v_max_f32 v138, v138, v18
    v_max_f32 v139, v139, v19
    v_max_f32 v140, v140, v20
    v_max_f32 v141, v141, v21
    v_max_f32 v142, v142, v22
    v_max_f32 v143, v143, v23
    v_pk_add_f32 v[136:137], v[136:137], s[76:77]
    v_pk_add_f32 v[138:139], v[138:139], s[76:77]
    v_pk_add_f32 v[140:141], v[140:141], s[76:77]
    v_pk_add_f32 v[142:143], v[142:143], s[76:77]
    v_cvt_pk_bf16_f32 v72, v72, v73
    v_cvt_pk_bf16_f32 v73, v74, v75
    v_cvt_pk_bf16_f32 v74, v76, v77
    v_cvt_pk_bf16_f32 v75, v78, v79
    v_cvt_pk_bf16_f32 v168, v168, v169
    v_cvt_pk_bf16_f32 v169, v170, v171
    v_cvt_pk_bf16_f32 v170, v172, v173
    v_cvt_pk_bf16_f32 v171, v174, v175
    v_cvt_pk_bf16_f32 v88, v88, v89
    v_cvt_pk_bf16_f32 v89, v90, v91
    v_cvt_pk_bf16_f32 v90, v92, v93
    v_cvt_pk_bf16_f32 v91, v94, v95
    v_cvt_pk_bf16_f32 v184, v184, v185
    v_cvt_pk_bf16_f32 v185, v186, v187
    v_cvt_pk_bf16_f32 v186, v188, v189
    v_cvt_pk_bf16_f32 v187, v190, v191
    v_cvt_pk_bf16_f32 v104, v104, v105
    v_cvt_pk_bf16_f32 v105, v106, v107
    v_cvt_pk_bf16_f32 v106, v108, v109
    v_cvt_pk_bf16_f32 v107, v110, v111
    v_cvt_pk_bf16_f32 v200, v200, v201
    v_cvt_pk_bf16_f32 v201, v202, v203
    v_cvt_pk_bf16_f32 v202, v204, v205
    v_cvt_pk_bf16_f32 v203, v206, v207
    v_cvt_pk_bf16_f32 v120, v120, v121
    v_cvt_pk_bf16_f32 v121, v122, v123
    v_cvt_pk_bf16_f32 v122, v124, v125
    v_cvt_pk_bf16_f32 v123, v126, v127
    v_cvt_pk_bf16_f32 v216, v216, v217
    v_cvt_pk_bf16_f32 v217, v218, v219
    v_cvt_pk_bf16_f32 v218, v220, v221
    v_cvt_pk_bf16_f32 v219, v222, v223
    v_cvt_pk_bf16_f32 v136, v136, v137
    v_cvt_pk_bf16_f32 v137, v138, v139
    v_cvt_pk_bf16_f32 v138, v140, v141
    v_cvt_pk_bf16_f32 v139, v142, v143
    v_cvt_pk_bf16_f32 v152, v152, v153
    v_cvt_pk_bf16_f32 v153, v154, v155
    v_cvt_pk_bf16_f32 v154, v156, v157
    v_cvt_pk_bf16_f32 v155, v158, v159
    s_nop 1
    v_mfma_f32_16x16x32_bf16 v[76:79], v[208:211], v[128:131], 0
    v_mfma_f32_16x16x32_bf16 v[92:95], v[144:147], v[112:115], 0
    v_mfma_f32_16x16x32_bf16 v[108:111], v[144:147], v[128:131], 0
    v_mfma_f32_16x16x32_bf16 v[124:127], v[24:27], v[64:67], 0
    v_mfma_f32_16x16x32_bf16 v[140:143], v[24:27], v[80:83], 0
    v_mfma_f32_16x16x32_bf16 v[156:159], v[24:27], v[96:99], 0
    v_mfma_f32_16x16x32_bf16 v[172:175], v[24:27], v[112:115], 0
    v_mfma_f32_16x16x32_bf16 v[188:191], v[24:27], v[128:131], 0
    v_mfma_f32_16x16x32_bf16 v[68:71], v[168:171], v[72:75], v[68:71]
    v_mfma_f32_16x16x32_bf16 v[84:87], v[168:171], v[88:91], v[84:87]
    v_mfma_f32_16x16x32_bf16 v[100:103], v[184:187], v[72:75], v[100:103]
    v_mfma_f32_16x16x32_bf16 v[116:119], v[184:187], v[88:91], v[116:119]
    v_mfma_f32_16x16x32_bf16 v[132:135], v[184:187], v[104:107], v[132:135]
    v_mfma_f32_16x16x32_bf16 v[148:151], v[200:203], v[88:91], v[148:151]
    v_mfma_f32_16x16x32_bf16 v[164:167], v[200:203], v[104:107], v[164:167]
    v_mfma_f32_16x16x32_bf16 v[180:183], v[200:203], v[120:123], v[180:183]
    v_mfma_f32_16x16x32_bf16 v[196:199], v[216:219], v[104:107], v[196:199]
    v_mfma_f32_16x16x32_bf16 v[212:215], v[216:219], v[120:123], v[212:215]
    v_mfma_f32_16x16x32_bf16 v[76:79], v[216:219], v[136:139], v[76:79]
    v_mfma_f32_16x16x32_bf16 v[92:95], v[152:155], v[120:123], v[92:95]
    v_mfma_f32_16x16x32_bf16 v[108:111], v[152:155], v[136:139], v[108:111]
    v_mfma_f32_16x16x32_bf16 v[124:127], v[24:27], v[72:75], v[124:127]
    v_mfma_f32_16x16x32_bf16 v[140:143], v[24:27], v[88:91], v[140:143]
    v_mfma_f32_16x16x32_bf16 v[156:159], v[24:27], v[104:107], v[156:159]
    v_mfma_f32_16x16x32_bf16 v[172:175], v[24:27], v[120:123], v[172:175]
    v_mfma_f32_16x16x32_bf16 v[188:191], v[24:27], v[136:139], v[188:191]
    s_nop 7
    s_nop 1
    s_mul_i32 s4, s3, 18432
    v_add_u32 v8, s4, v7
    ds_write_b128 v8, v[68:71] offset:0
    ds_write_b128 v8, v[84:87] offset:1024
    ds_write_b128 v8, v[100:103] offset:2048
    ds_write_b128 v8, v[116:119] offset:3072
    ds_write_b128 v8, v[132:135] offset:4096
    ds_write_b128 v8, v[148:151] offset:5120
    ds_write_b128 v8, v[164:167] offset:6144
    ds_write_b128 v8, v[180:183] offset:7168
    ds_write_b128 v8, v[196:199] offset:8192
    ds_write_b128 v8, v[212:215] offset:9216
    ds_write_b128 v8, v[76:79] offset:10240
    ds_write_b128 v8, v[92:95] offset:11264
    ds_write_b128 v8, v[108:111] offset:12288
    ds_write_b128 v8, v[124:127] offset:13312
    ds_write_b128 v8, v[140:143] offset:14336
    ds_write_b128 v8, v[156:159] offset:15360
    ds_write_b128 v8, v[172:175] offset:16384
    ds_write_b128 v8, v[188:191] offset:17408
    s_waitcnt lgkmcnt(0)
    s_barrier
    s_lshl_b32 s4, s3, 10
    v_add_u32 v8, s4, v7
    v_add_u32 v9, 0x9000, v8
    v_lshlrev_b32 v10, 2, v0
    s_mul_i32 s5, s53, 13
    s_add_u32 s5, s5, s3
    s_lshl_b32 s5, s5, 10
    s_mul_i32 s6, s53, 320
    s_add_u32 s6, s6, 106496
    v_add_u32 v11, s4, v7
    v_add_u32 v12, 0x9000, v11
    ds_read_b128 v[64:67], v11 offset:0
    ds_read_b128 v[68:71], v11 offset:18432
    ds_read_b128 v[72:75], v12 offset:0
    ds_read_b128 v[76:79], v12 offset:18432
    ds_read_b128 v[80:83], v11 offset:4096
    ds_read_b128 v[84:87], v11 offset:22528
    ds_read_b128 v[88:91], v12 offset:4096
    ds_read_b128 v[92:95], v12 offset:22528
    ds_read_b128 v[96:99], v11 offset:8192
    ds_read_b128 v[100:103], v11 offset:26624
    ds_read_b128 v[104:107], v12 offset:8192
    ds_read_b128 v[108:111], v12 offset:26624
    s_waitcnt lgkmcnt(8)
    v_pk_add_f32 v[64:65], v[64:65], v[68:69]
    v_pk_add_f32 v[66:67], v[66:67], v[70:71]
    v_pk_add_f32 v[64:65], v[64:65], v[72:73]
    v_pk_add_f32 v[66:67], v[66:67], v[74:75]
    v_pk_add_f32 v[64:65], v[64:65], v[76:77]
    v_pk_add_f32 v[66:67], v[66:67], v[78:79]
    buffer_atomic_add_f32 v64, v10, s[44:47], s5 offen offset:0 sc0
    buffer_atomic_add_f32 v65, v10, s[44:47], s5 offen offset:256 sc0
    buffer_atomic_add_f32 v66, v10, s[44:47], s5 offen offset:512 sc0
    buffer_atomic_add_f32 v67, v10, s[44:47], s5 offen offset:768 sc0
    s_add_u32 s5, s5, 4096
    ds_read_b128 v[112:115], v11 offset:12288
    ds_read_b128 v[116:119], v11 offset:30720
    ds_read_b128 v[120:123], v12 offset:12288
    ds_read_b128 v[124:127], v12 offset:30720
    s_waitcnt lgkmcnt(8)
    v_pk_add_f32 v[80:81], v[80:81], v[84:85]
    v_pk_add_f32 v[82:83], v[82:83], v[86:87]
    v_pk_add_f32 v[80:81], v[80:81], v[88:89]
    v_pk_add_f32 v[82:83], v[82:83], v[90:91]
    v_pk_add_f32 v[80:81], v[80:81], v[92:93]
    v_pk_add_f32 v[82:83], v[82:83], v[94:95]
    buffer_atomic_add_f32 v80, v10, s[44:47], s5 offen offset:0 sc0
    buffer_atomic_add_f32 v81, v10, s[44:47], s5 offen offset:256 sc0
    buffer_atomic_add_f32 v82, v10, s[44:47], s5 offen offset:512 sc0
    buffer_atomic_add_f32 v83, v10, s[44:47], s5 offen offset:768 sc0
    s_add_u32 s5, s5, 4096
    ds_read_b128 v[128:131], v11 offset:16384
    ds_read_b128 v[132:135], v11 offset:34816
    ds_read_b128 v[136:139], v12 offset:16384
    ds_read_b128 v[140:143], v12 offset:34816
    s_waitcnt lgkmcnt(8)
    v_pk_add_f32 v[96:97], v[96:97], v[100:101]
    v_pk_add_f32 v[98:99], v[98:99], v[102:103]
    v_pk_add_f32 v[96:97], v[96:97], v[104:105]
    v_pk_add_f32 v[98:99], v[98:99], v[106:107]
    v_pk_add_f32 v[96:97], v[96:97], v[108:109]
    v_pk_add_f32 v[98:99], v[98:99], v[110:111]
    buffer_atomic_add_f32 v96, v10, s[44:47], s5 offen offset:0 sc0
    buffer_atomic_add_f32 v97, v10, s[44:47], s5 offen offset:256 sc0
    buffer_atomic_add_f32 v98, v10, s[44:47], s5 offen offset:512 sc0
    buffer_atomic_add_f32 v99, v10, s[44:47], s5 offen offset:768 sc0
    s_add_u32 s5, s5, 4096
    s_waitcnt lgkmcnt(0)
    s_cmp_lg_u32 s3, 0
    s_cbranch_scc1 L_kv_z3
    v_pk_add_f32 v[112:113], v[112:113], v[116:117]
    v_pk_add_f32 v[114:115], v[114:115], v[118:119]
    v_pk_add_f32 v[112:113], v[112:113], v[120:121]
    v_pk_add_f32 v[114:115], v[114:115], v[122:123]
    v_pk_add_f32 v[112:113], v[112:113], v[124:125]
    v_pk_add_f32 v[114:115], v[114:115], v[126:127]
    buffer_atomic_add_f32 v112, v10, s[44:47], s5 offen offset:0 sc0
    buffer_atomic_add_f32 v113, v10, s[44:47], s5 offen offset:256 sc0
    buffer_atomic_add_f32 v114, v10, s[44:47], s5 offen offset:512 sc0
    buffer_atomic_add_f32 v115, v10, s[44:47], s5 offen offset:768 sc0
    s_add_u32 s5, s5, 4096
    s_branch L_kv_k4
L_kv_z3:
    s_sub_u32 s8, s3, 1
    s_lshl_b32 s7, s8, 6
    s_add_u32 s7, s7, s6
    v_add_f32 v112, v112, v116
    v_add_f32 v120, v120, v124
    v_add_f32 v112, v112, v120
    s_mov_b64 exec, 0xffff
    buffer_atomic_add_f32 v112, v10, s[44:47], s7 offen sc0
    s_mov_b64 exec, -1
L_kv_k4:
    s_cmp_ge_u32 s3, 2
    s_cbranch_scc1 L_kv_done
    s_add_u32 s8, s3, 3
    s_lshl_b32 s7, s8, 6
    s_add_u32 s7, s7, s6
    v_add_f32 v128, v128, v132
    v_add_f32 v136, v136, v140
    v_add_f32 v128, v128, v136
    s_mov_b64 exec, 0xffff
    buffer_atomic_add_f32 v128, v10, s[44:47], s7 offen sc0
    s_mov_b64 exec, -1
L_kv_done:
    s_mov_b32 s49, 1
    s_lshl_b32 s4, s53, 5
    s_lshl_b32 s5, s52, 2
    s_add_u32 s4, s4, s5
    s_add_u32 s55, s4, 1024
    s_mov_b32 s49, 2
    s_branch L_p2_main_entry
L_spare:
    s_sub_u32 s12, s91, 30
    s_lshl_b32 s13, s90, 1
    s_add_u32 s13, s13, s12
    s_lshl_b32 s60, s13, 3
    s_add_u32 s60, s60, s3
    s_lshl_b32 s55, s13, 2
    s_getpc_b64 s[4:5]
L_cpf:
    s_sub_u32 s4, s4, L_cpf-gated_mix__linear_attn_block__glu_gated_glu__prompt_kernel
    s_subb_u32 s5, s5, 0
    v_lshlrev_b32 v9, 7, v0
    s_lshl_b32 s6, s3, 13
    v_add_u32 v9, s6, v9
    v_min_u32 v9, L_end-gated_mix__linear_attn_block__glu_gated_glu__prompt_kernel, v9
    global_load_dword v12, v9, s[4:5]
    s_mov_b32 s40, s28
    s_mov_b32 s41, s29
    s_mov_b32 s42, 0x21c000
    s_mov_b32 s43, 0x20000
    s_mov_b32 s44, s20
    s_mov_b32 s45, s21
    s_mov_b32 s46, 0xc8000
    s_mov_b32 s47, 0x20000
    s_add_u32 s48, s36, 0xa00400
    s_addc_u32 s49, s37, 0
    s_mov_b32 s50, 0x2e4000
    s_mov_b32 s51, 0x20000
    s_add_u32 s56, s36, 0xe00000
    s_addc_u32 s57, s37, 0
    s_mov_b32 s58, 0x1b000
    s_mov_b32 s59, 0x20000
    v_lshrrev_b32 v4, 2, v0
    v_mul_u32_u24 v4, 0x500, v4
    v_and_b32 v5, 3, v0
    v_lshl_add_u32 v4, v5, 4, v4
    s_mul_i32 s61, s3, 18432
    v_lshrrev_b32 v6, 2, v0
    v_lshlrev_b32 v6, 6, v6
    v_lshl_add_u32 v6, v5, 3, v6
    v_add_u32 v6, s61, v6
    v_lshlrev_b32 v7, 4, v0
    v_and_b32 v8, 31, v0
    v_mul_u32_u24 v8, 0x500, v8
    s_add_u32 s62, s60, 0
    s_mul_hi_u32 s70, s62, 0xccccccd
    s_mul_i32 s71, s70, 20
    s_sub_u32 s71, s62, s71
    s_mul_i32 s65, s70, 40960
    s_lshl_b32 s72, s71, 6
    s_add_u32 s65, s65, s72
    s_lshl_b32 s71, s71, 1
    s_add_u32 s72, s71, 0
    s_mul_hi_u32 s73, s72, 0x33333334
    s_mul_i32 s68, s73, 5
    s_sub_u32 s72, s72, s68
    s_mul_i32 s73, s73, 74
    s_add_u32 s73, s73, s70
    s_mul_i32 s73, s73, 5
    s_add_u32 s73, s73, s72
    s_lshl_b32 s68, s73, 10
    s_add_u32 s72, s71, 1
    s_mul_hi_u32 s73, s72, 0x33333334
    s_mul_i32 s69, s73, 5
    s_sub_u32 s72, s72, s69
    s_mul_i32 s73, s73, 74
    s_add_u32 s73, s73, s70
    s_mul_i32 s73, s73, 5
    s_add_u32 s73, s73, s72
    s_lshl_b32 s69, s73, 10
    v_writelane_b32 v9, s65, 0
    v_writelane_b32 v10, s68, 0
    v_writelane_b32 v11, s69, 0
    s_add_u32 s62, s60, 128
    s_mul_hi_u32 s70, s62, 0xccccccd
    s_mul_i32 s71, s70, 20
    s_sub_u32 s71, s62, s71
    s_mul_i32 s65, s70, 40960
    s_lshl_b32 s72, s71, 6
    s_add_u32 s65, s65, s72
    s_lshl_b32 s71, s71, 1
    s_add_u32 s72, s71, 0
    s_mul_hi_u32 s73, s72, 0x33333334
    s_mul_i32 s68, s73, 5
    s_sub_u32 s72, s72, s68
    s_mul_i32 s73, s73, 74
    s_add_u32 s73, s73, s70
    s_mul_i32 s73, s73, 5
    s_add_u32 s73, s73, s72
    s_lshl_b32 s68, s73, 10
    s_add_u32 s72, s71, 1
    s_mul_hi_u32 s73, s72, 0x33333334
    s_mul_i32 s69, s73, 5
    s_sub_u32 s72, s72, s69
    s_mul_i32 s73, s73, 74
    s_add_u32 s73, s73, s70
    s_mul_i32 s73, s73, 5
    s_add_u32 s73, s73, s72
    s_lshl_b32 s69, s73, 10
    v_writelane_b32 v9, s65, 1
    v_writelane_b32 v10, s68, 1
    v_writelane_b32 v11, s69, 1
    s_add_u32 s62, s60, 256
    s_mul_hi_u32 s70, s62, 0xccccccd
    s_mul_i32 s71, s70, 20
    s_sub_u32 s71, s62, s71
    s_mul_i32 s65, s70, 40960
    s_lshl_b32 s72, s71, 6
    s_add_u32 s65, s65, s72
    s_lshl_b32 s71, s71, 1
    s_add_u32 s72, s71, 0
    s_mul_hi_u32 s73, s72, 0x33333334
    s_mul_i32 s68, s73, 5
    s_sub_u32 s72, s72, s68
    s_mul_i32 s73, s73, 74
    s_add_u32 s73, s73, s70
    s_mul_i32 s73, s73, 5
    s_add_u32 s73, s73, s72
    s_lshl_b32 s68, s73, 10
    s_add_u32 s72, s71, 1
    s_mul_hi_u32 s73, s72, 0x33333334
    s_mul_i32 s69, s73, 5
    s_sub_u32 s72, s72, s69
    s_mul_i32 s73, s73, 74
    s_add_u32 s73, s73, s70
    s_mul_i32 s73, s73, 5
    s_add_u32 s73, s73, s72
    s_lshl_b32 s69, s73, 10
    v_writelane_b32 v9, s65, 2
    v_writelane_b32 v10, s68, 2
    v_writelane_b32 v11, s69, 2
    s_add_u32 s62, s60, 384
    s_mul_hi_u32 s70, s62, 0xccccccd
    s_mul_i32 s71, s70, 20
    s_sub_u32 s71, s62, s71
    s_mul_i32 s65, s70, 40960
    s_lshl_b32 s72, s71, 6
    s_add_u32 s65, s65, s72
    s_lshl_b32 s71, s71, 1
    s_add_u32 s72, s71, 0
    s_mul_hi_u32 s73, s72, 0x33333334
    s_mul_i32 s68, s73, 5
    s_sub_u32 s72, s72, s68
    s_mul_i32 s73, s73, 74
    s_add_u32 s73, s73, s70
    s_mul_i32 s73, s73, 5
    s_add_u32 s73, s73, s72
    s_lshl_b32 s68, s73, 10
    s_add_u32 s72, s71, 1
    s_mul_hi_u32 s73, s72, 0x33333334
    s_mul_i32 s69, s73, 5
    s_sub_u32 s72, s72, s69
    s_mul_i32 s73, s73, 74
    s_add_u32 s73, s73, s70
    s_mul_i32 s73, s73, 5
    s_add_u32 s73, s73, s72
    s_lshl_b32 s69, s73, 10
    v_writelane_b32 v9, s65, 3
    v_writelane_b32 v10, s68, 3
    v_writelane_b32 v11, s69, 3
    s_add_u32 s62, s60, 512
    s_mul_hi_u32 s70, s62, 0xccccccd
    s_mul_i32 s71, s70, 20
    s_sub_u32 s71, s62, s71
    s_mul_i32 s65, s70, 40960
    s_lshl_b32 s72, s71, 6
    s_add_u32 s65, s65, s72
    s_lshl_b32 s71, s71, 1
    s_add_u32 s72, s71, 0
    s_mul_hi_u32 s73, s72, 0x33333334
    s_mul_i32 s68, s73, 5
    s_sub_u32 s72, s72, s68
    s_mul_i32 s73, s73, 74
    s_add_u32 s73, s73, s70
    s_mul_i32 s73, s73, 5
    s_add_u32 s73, s73, s72
    s_lshl_b32 s68, s73, 10
    s_add_u32 s72, s71, 1
    s_mul_hi_u32 s73, s72, 0x33333334
    s_mul_i32 s69, s73, 5
    s_sub_u32 s72, s72, s69
    s_mul_i32 s73, s73, 74
    s_add_u32 s73, s73, s70
    s_mul_i32 s73, s73, 5
    s_add_u32 s73, s73, s72
    s_lshl_b32 s69, s73, 10
    v_writelane_b32 v9, s65, 4
    v_writelane_b32 v10, s68, 4
    v_writelane_b32 v11, s69, 4
    s_add_u32 s62, s60, 640
    s_mul_hi_u32 s70, s62, 0xccccccd
    s_mul_i32 s71, s70, 20
    s_sub_u32 s71, s62, s71
    s_mul_i32 s65, s70, 40960
    s_lshl_b32 s72, s71, 6
    s_add_u32 s65, s65, s72
    s_lshl_b32 s71, s71, 1
    s_add_u32 s72, s71, 0
    s_mul_hi_u32 s73, s72, 0x33333334
    s_mul_i32 s68, s73, 5
    s_sub_u32 s72, s72, s68
    s_mul_i32 s73, s73, 74
    s_add_u32 s73, s73, s70
    s_mul_i32 s73, s73, 5
    s_add_u32 s73, s73, s72
    s_lshl_b32 s68, s73, 10
    s_add_u32 s72, s71, 1
    s_mul_hi_u32 s73, s72, 0x33333334
    s_mul_i32 s69, s73, 5
    s_sub_u32 s72, s72, s69
    s_mul_i32 s73, s73, 74
    s_add_u32 s73, s73, s70
    s_mul_i32 s73, s73, 5
    s_add_u32 s73, s73, s72
    s_lshl_b32 s69, s73, 10
    v_writelane_b32 v9, s65, 5
    v_writelane_b32 v10, s68, 5
    v_writelane_b32 v11, s69, 5
    s_add_u32 s62, s60, 768
    s_mul_hi_u32 s70, s62, 0xccccccd
    s_mul_i32 s71, s70, 20
    s_sub_u32 s71, s62, s71
    s_mul_i32 s65, s70, 40960
    s_lshl_b32 s72, s71, 6
    s_add_u32 s65, s65, s72
    s_lshl_b32 s71, s71, 1
    s_add_u32 s72, s71, 0
    s_mul_hi_u32 s73, s72, 0x33333334
    s_mul_i32 s68, s73, 5
    s_sub_u32 s72, s72, s68
    s_mul_i32 s73, s73, 74
    s_add_u32 s73, s73, s70
    s_mul_i32 s73, s73, 5
    s_add_u32 s73, s73, s72
    s_lshl_b32 s68, s73, 10
    s_add_u32 s72, s71, 1
    s_mul_hi_u32 s73, s72, 0x33333334
    s_mul_i32 s69, s73, 5
    s_sub_u32 s72, s72, s69
    s_mul_i32 s73, s73, 74
    s_add_u32 s73, s73, s70
    s_mul_i32 s73, s73, 5
    s_add_u32 s73, s73, s72
    s_lshl_b32 s69, s73, 10
    v_writelane_b32 v9, s65, 6
    v_writelane_b32 v10, s68, 6
    v_writelane_b32 v11, s69, 6
    s_add_u32 s62, s60, 896
    s_mul_hi_u32 s70, s62, 0xccccccd
    s_mul_i32 s71, s70, 20
    s_sub_u32 s71, s62, s71
    s_mul_i32 s65, s70, 40960
    s_lshl_b32 s72, s71, 6
    s_add_u32 s65, s65, s72
    s_lshl_b32 s71, s71, 1
    s_add_u32 s72, s71, 0
    s_mul_hi_u32 s73, s72, 0x33333334
    s_mul_i32 s68, s73, 5
    s_sub_u32 s72, s72, s68
    s_mul_i32 s73, s73, 74
    s_add_u32 s73, s73, s70
    s_mul_i32 s73, s73, 5
    s_add_u32 s73, s73, s72
    s_lshl_b32 s68, s73, 10
    s_add_u32 s72, s71, 1
    s_mul_hi_u32 s73, s72, 0x33333334
    s_mul_i32 s69, s73, 5
    s_sub_u32 s72, s72, s69
    s_mul_i32 s73, s73, 74
    s_add_u32 s73, s73, s70
    s_mul_i32 s73, s73, 5
    s_add_u32 s73, s73, s72
    s_lshl_b32 s69, s73, 10
    v_writelane_b32 v9, s65, 7
    v_writelane_b32 v10, s68, 7
    v_writelane_b32 v11, s69, 7
    s_add_u32 s62, s60, 1024
    s_mul_hi_u32 s70, s62, 0xccccccd
    s_mul_i32 s71, s70, 20
    s_sub_u32 s71, s62, s71
    s_mul_i32 s65, s70, 40960
    s_lshl_b32 s72, s71, 6
    s_add_u32 s65, s65, s72
    s_lshl_b32 s71, s71, 1
    s_add_u32 s72, s71, 0
    s_mul_hi_u32 s73, s72, 0x33333334
    s_mul_i32 s68, s73, 5
    s_sub_u32 s72, s72, s68
    s_mul_i32 s73, s73, 74
    s_add_u32 s73, s73, s70
    s_mul_i32 s73, s73, 5
    s_add_u32 s73, s73, s72
    s_lshl_b32 s68, s73, 10
    s_add_u32 s72, s71, 1
    s_mul_hi_u32 s73, s72, 0x33333334
    s_mul_i32 s69, s73, 5
    s_sub_u32 s72, s72, s69
    s_mul_i32 s73, s73, 74
    s_add_u32 s73, s73, s70
    s_mul_i32 s73, s73, 5
    s_add_u32 s73, s73, s72
    s_lshl_b32 s69, s73, 10
    s_cmp_ge_u32 s62, 1080
    s_cselect_b32 s65, 0x40000000, s65
    v_writelane_b32 v9, s65, 8
    v_writelane_b32 v10, s68, 8
    v_writelane_b32 v11, s69, 8
    v_readlane_b32 s65, v9, 0
    s_add_u32 m0, s61, 0
    s_add_u32 s66, s65, 20480
    s_nop 2
    buffer_load_dwordx4 v4, s[40:43], s65 offen lds
    s_add_u32 m0, s61, 1024
    s_nop 0
    buffer_load_dwordx4 v4, s[40:43], s66 offen lds
    v_readlane_b32 s65, v9, 1
    s_add_u32 m0, s61, 2048
    s_add_u32 s66, s65, 20480
    s_nop 2
    buffer_load_dwordx4 v4, s[40:43], s65 offen lds
    s_add_u32 m0, s61, 3072
    s_nop 0
    buffer_load_dwordx4 v4, s[40:43], s66 offen lds
    v_readlane_b32 s65, v9, 2
    s_add_u32 m0, s61, 4096
    s_add_u32 s66, s65, 20480
    s_nop 2
    buffer_load_dwordx4 v4, s[40:43], s65 offen lds
    s_add_u32 m0, s61, 5120
    s_nop 0
    buffer_load_dwordx4 v4, s[40:43], s66 offen lds
    v_readlane_b32 s65, v9, 3
    s_add_u32 m0, s61, 6144
    s_add_u32 s66, s65, 20480
    s_nop 2
    buffer_load_dwordx4 v4, s[40:43], s65 offen lds
    s_add_u32 m0, s61, 7168
    s_nop 0
    buffer_load_dwordx4 v4, s[40:43], s66 offen lds
    v_readlane_b32 s65, v9, 4
    s_add_u32 m0, s61, 8192
    s_add_u32 s66, s65, 20480
    s_nop 2
    buffer_load_dwordx4 v4, s[40:43], s65 offen lds
    s_add_u32 m0, s61, 9216
    s_nop 0
    buffer_load_dwordx4 v4, s[40:43], s66 offen lds
    v_readlane_b32 s65, v9, 5
    s_add_u32 m0, s61, 10240
    s_add_u32 s66, s65, 20480
    s_nop 2
    buffer_load_dwordx4 v4, s[40:43], s65 offen lds
    s_add_u32 m0, s61, 11264
    s_nop 0
    buffer_load_dwordx4 v4, s[40:43], s66 offen lds
    v_readlane_b32 s65, v9, 6
    s_add_u32 m0, s61, 12288
    s_add_u32 s66, s65, 20480
    s_nop 2
    buffer_load_dwordx4 v4, s[40:43], s65 offen lds
    s_add_u32 m0, s61, 13312
    s_nop 0
    buffer_load_dwordx4 v4, s[40:43], s66 offen lds
    v_readlane_b32 s65, v9, 7
    s_add_u32 m0, s61, 14336
    s_add_u32 s66, s65, 20480
    s_nop 2
    buffer_load_dwordx4 v4, s[40:43], s65 offen lds
    s_add_u32 m0, s61, 15360
    s_nop 0
    buffer_load_dwordx4 v4, s[40:43], s66 offen lds
    v_readlane_b32 s65, v9, 8
    s_add_u32 m0, s61, 16384
    s_add_u32 s66, s65, 20480
    s_nop 2
    buffer_load_dwordx4 v4, s[40:43], s65 offen lds
    s_add_u32 m0, s61, 17408
    s_nop 0
    buffer_load_dwordx4 v4, s[40:43], s66 offen lds
    v_mov_b32 v16, 0
    v_mov_b32 v17, 0
    v_mov_b32 v18, 0
    v_mov_b32 v19, 0
    s_lshl_b32 s62, s60, 10
    buffer_store_dwordx4 v[16:19], v7, s[56:59], s62 offen sc1
    s_waitcnt vmcnt(17)
    ds_read_b64_tr_b16 v[128:129], v6 offset:0
    ds_read_b64_tr_b16 v[130:131], v6 offset:1024
    ds_read_b64_tr_b16 v[132:133], v6 offset:32
    ds_read_b64_tr_b16 v[134:135], v6 offset:1056
    v_readlane_b32 s68, v10, 0
    v_readlane_b32 s69, v11, 0
    s_waitcnt lgkmcnt(2)
    s_nop 2
    buffer_store_dwordx4 v[128:131], v7, s[48:51], s68 offen sc1
    s_waitcnt lgkmcnt(0)
    buffer_store_dwordx4 v[132:135], v7, s[48:51], s69 offen sc1
    s_waitcnt vmcnt(17)
    ds_read_b64_tr_b16 v[136:137], v6 offset:2048
    ds_read_b64_tr_b16 v[138:139], v6 offset:3072
    ds_read_b64_tr_b16 v[140:141], v6 offset:2080
    ds_read_b64_tr_b16 v[142:143], v6 offset:3104
    v_readlane_b32 s68, v10, 1
    v_readlane_b32 s69, v11, 1
    s_waitcnt lgkmcnt(2)
    s_nop 2
    buffer_store_dwordx4 v[136:139], v7, s[48:51], s68 offen sc1
    s_waitcnt lgkmcnt(0)
    buffer_store_dwordx4 v[140:143], v7, s[48:51], s69 offen sc1
    s_waitcnt vmcnt(17)
    ds_read_b64_tr_b16 v[144:145], v6 offset:4096
    ds_read_b64_tr_b16 v[146:147], v6 offset:5120
    ds_read_b64_tr_b16 v[148:149], v6 offset:4128
    ds_read_b64_tr_b16 v[150:151], v6 offset:5152
    v_readlane_b32 s68, v10, 2
    v_readlane_b32 s69, v11, 2
    s_waitcnt lgkmcnt(2)
    s_nop 2
    buffer_store_dwordx4 v[144:147], v7, s[48:51], s68 offen sc1
    s_waitcnt lgkmcnt(0)
    buffer_store_dwordx4 v[148:151], v7, s[48:51], s69 offen sc1
    s_waitcnt vmcnt(17)
    ds_read_b64_tr_b16 v[152:153], v6 offset:6144
    ds_read_b64_tr_b16 v[154:155], v6 offset:7168
    ds_read_b64_tr_b16 v[156:157], v6 offset:6176
    ds_read_b64_tr_b16 v[158:159], v6 offset:7200
    v_readlane_b32 s68, v10, 3
    v_readlane_b32 s69, v11, 3
    s_waitcnt lgkmcnt(2)
    s_nop 2
    buffer_store_dwordx4 v[152:155], v7, s[48:51], s68 offen sc1
    s_waitcnt lgkmcnt(0)
    buffer_store_dwordx4 v[156:159], v7, s[48:51], s69 offen sc1
    s_waitcnt vmcnt(17)
    ds_read_b64_tr_b16 v[128:129], v6 offset:8192
    ds_read_b64_tr_b16 v[130:131], v6 offset:9216
    ds_read_b64_tr_b16 v[132:133], v6 offset:8224
    ds_read_b64_tr_b16 v[134:135], v6 offset:9248
    v_readlane_b32 s68, v10, 4
    v_readlane_b32 s69, v11, 4
    s_waitcnt lgkmcnt(2)
    s_nop 2
    buffer_store_dwordx4 v[128:131], v7, s[48:51], s68 offen sc1
    s_waitcnt lgkmcnt(0)
    buffer_store_dwordx4 v[132:135], v7, s[48:51], s69 offen sc1
    s_waitcnt vmcnt(17)
    ds_read_b64_tr_b16 v[136:137], v6 offset:10240
    ds_read_b64_tr_b16 v[138:139], v6 offset:11264
    ds_read_b64_tr_b16 v[140:141], v6 offset:10272
    ds_read_b64_tr_b16 v[142:143], v6 offset:11296
    v_readlane_b32 s68, v10, 5
    v_readlane_b32 s69, v11, 5
    s_waitcnt lgkmcnt(2)
    s_nop 2
    buffer_store_dwordx4 v[136:139], v7, s[48:51], s68 offen sc1
    s_waitcnt lgkmcnt(0)
    buffer_store_dwordx4 v[140:143], v7, s[48:51], s69 offen sc1
    s_waitcnt vmcnt(17)
    ds_read_b64_tr_b16 v[144:145], v6 offset:12288
    ds_read_b64_tr_b16 v[146:147], v6 offset:13312
    ds_read_b64_tr_b16 v[148:149], v6 offset:12320
    ds_read_b64_tr_b16 v[150:151], v6 offset:13344
    v_readlane_b32 s68, v10, 6
    v_readlane_b32 s69, v11, 6
    s_waitcnt lgkmcnt(2)
    s_nop 2
    buffer_store_dwordx4 v[144:147], v7, s[48:51], s68 offen sc1
    s_waitcnt lgkmcnt(0)
    buffer_store_dwordx4 v[148:151], v7, s[48:51], s69 offen sc1
    s_waitcnt vmcnt(17)
    ds_read_b64_tr_b16 v[152:153], v6 offset:14336
    ds_read_b64_tr_b16 v[154:155], v6 offset:15360
    ds_read_b64_tr_b16 v[156:157], v6 offset:14368
    ds_read_b64_tr_b16 v[158:159], v6 offset:15392
    v_readlane_b32 s68, v10, 7
    v_readlane_b32 s69, v11, 7
    s_waitcnt lgkmcnt(2)
    s_nop 2
    buffer_store_dwordx4 v[152:155], v7, s[48:51], s68 offen sc1
    s_waitcnt lgkmcnt(0)
    buffer_store_dwordx4 v[156:159], v7, s[48:51], s69 offen sc1
    s_add_u32 s62, s60, 1024
    s_cmp_ge_u32 s62, 1080
    s_cbranch_scc1 L_pk_done
    s_waitcnt vmcnt(17)
    ds_read_b64_tr_b16 v[128:129], v6 offset:16384
    ds_read_b64_tr_b16 v[130:131], v6 offset:17408
    ds_read_b64_tr_b16 v[132:133], v6 offset:16416
    ds_read_b64_tr_b16 v[134:135], v6 offset:17440
    v_readlane_b32 s68, v10, 8
    v_readlane_b32 s69, v11, 8
    s_waitcnt lgkmcnt(2)
    s_nop 2
    buffer_store_dwordx4 v[128:131], v7, s[48:51], s68 offen sc1
    s_waitcnt lgkmcnt(0)
    buffer_store_dwordx4 v[132:135], v7, s[48:51], s69 offen sc1
L_pk_done:
    s_waitcnt vmcnt(0)
    s_barrier
    s_mov_b32 s80, s34
    s_mov_b32 s81, s35
    s_mov_b32 s82, 0x100
    s_mov_b32 s83, 0x20000
    v_mov_b32 v1, 0
L_spT_T:
    buffer_load_dword v2, v1, s[80:83], 0 offen sc1
    s_waitcnt vmcnt(0)
    v_readfirstlane_b32 s92, v2
    s_nop 3
    s_cmp_lg_u32 s92, 0
    s_cbranch_scc1 L_spT_Tok
    s_sleep 8
    s_branch L_spT_T
L_spT_Tok:
    s_cmp_lg_u32 s3, 0
    s_cbranch_scc1 L_sp_noflag
    s_add_u32 s11, s55, 8192
    v_lshlrev_b32 v1, 7, v0
    v_mov_b32 v2, s92
    s_mov_b64 exec, 255
    buffer_store_dword v2, v1, s[84:87], s11 offen sc1
    s_mov_b64 exec, -1
L_sp_noflag:
    s_add_u32 s52, s36, 0xd00000
    s_addc_u32 s53, s37, 0
    s_mov_b32 s54, 0xc8000
    s_mov_b32 s55, 0x20000
    s_add_u32 s62, s60, 0
    s_mul_hi_u32 s70, s62, 0xccccccd
    s_mul_i32 s71, s70, 20
    s_sub_u32 s71, s62, s71
    s_mul_i32 s65, s70, 40960
    s_lshl_b32 s72, s71, 6
    s_add_u32 s65, s65, s72
    s_lshl_b32 s71, s71, 1
    s_add_u32 s72, s71, 0
    s_mul_hi_u32 s73, s72, 0x33333334
    s_mul_i32 s68, s73, 5
    s_sub_u32 s72, s72, s68
    s_mul_i32 s73, s73, 20
    s_add_u32 s73, s73, s70
    s_mul_i32 s73, s73, 5
    s_add_u32 s73, s73, s72
    s_lshl_b32 s68, s73, 10
    s_add_u32 s72, s71, 1
    s_mul_hi_u32 s73, s72, 0x33333334
    s_mul_i32 s69, s73, 5
    s_sub_u32 s72, s72, s69
    s_mul_i32 s73, s73, 20
    s_add_u32 s73, s73, s70
    s_mul_i32 s73, s73, 5
    s_add_u32 s73, s73, s72
    s_lshl_b32 s69, s73, 10
    v_writelane_b32 v10, s68, 0
    v_writelane_b32 v11, s69, 0
    s_add_u32 m0, s61, 0
    s_add_u32 s66, s65, 20480
    buffer_load_dwordx4 v4, s[44:47], s65 offen lds
    s_add_u32 m0, s61, 1024
    s_nop 0
    buffer_load_dwordx4 v4, s[44:47], s66 offen lds
    s_add_u32 s62, s60, 128
    s_mul_hi_u32 s70, s62, 0xccccccd
    s_mul_i32 s71, s70, 20
    s_sub_u32 s71, s62, s71
    s_mul_i32 s65, s70, 40960
    s_lshl_b32 s72, s71, 6
    s_add_u32 s65, s65, s72
    s_lshl_b32 s71, s71, 1
    s_add_u32 s72, s71, 0
    s_mul_hi_u32 s73, s72, 0x33333334
    s_mul_i32 s68, s73, 5
    s_sub_u32 s72, s72, s68
    s_mul_i32 s73, s73, 20
    s_add_u32 s73, s73, s70
    s_mul_i32 s73, s73, 5
    s_add_u32 s73, s73, s72
    s_lshl_b32 s68, s73, 10
    s_add_u32 s72, s71, 1
    s_mul_hi_u32 s73, s72, 0x33333334
    s_mul_i32 s69, s73, 5
    s_sub_u32 s72, s72, s69
    s_mul_i32 s73, s73, 20
    s_add_u32 s73, s73, s70
    s_mul_i32 s73, s73, 5
    s_add_u32 s73, s73, s72
    s_lshl_b32 s69, s73, 10
    v_writelane_b32 v10, s68, 1
    v_writelane_b32 v11, s69, 1
    s_add_u32 m0, s61, 2048
    s_add_u32 s66, s65, 20480
    buffer_load_dwordx4 v4, s[44:47], s65 offen lds
    s_add_u32 m0, s61, 3072
    s_nop 0
    buffer_load_dwordx4 v4, s[44:47], s66 offen lds
    s_add_u32 s62, s60, 256
    s_mul_hi_u32 s70, s62, 0xccccccd
    s_mul_i32 s71, s70, 20
    s_sub_u32 s71, s62, s71
    s_mul_i32 s65, s70, 40960
    s_lshl_b32 s72, s71, 6
    s_add_u32 s65, s65, s72
    s_lshl_b32 s71, s71, 1
    s_add_u32 s72, s71, 0
    s_mul_hi_u32 s73, s72, 0x33333334
    s_mul_i32 s68, s73, 5
    s_sub_u32 s72, s72, s68
    s_mul_i32 s73, s73, 20
    s_add_u32 s73, s73, s70
    s_mul_i32 s73, s73, 5
    s_add_u32 s73, s73, s72
    s_lshl_b32 s68, s73, 10
    s_add_u32 s72, s71, 1
    s_mul_hi_u32 s73, s72, 0x33333334
    s_mul_i32 s69, s73, 5
    s_sub_u32 s72, s72, s69
    s_mul_i32 s73, s73, 20
    s_add_u32 s73, s73, s70
    s_mul_i32 s73, s73, 5
    s_add_u32 s73, s73, s72
    s_lshl_b32 s69, s73, 10
    v_writelane_b32 v10, s68, 2
    v_writelane_b32 v11, s69, 2
    s_add_u32 m0, s61, 4096
    s_add_u32 s66, s65, 20480
    buffer_load_dwordx4 v4, s[44:47], s65 offen lds
    s_add_u32 m0, s61, 5120
    s_nop 0
    buffer_load_dwordx4 v4, s[44:47], s66 offen lds
    s_add_u32 s62, s60, 384
    s_mul_hi_u32 s70, s62, 0xccccccd
    s_mul_i32 s71, s70, 20
    s_sub_u32 s71, s62, s71
    s_mul_i32 s65, s70, 40960
    s_lshl_b32 s72, s71, 6
    s_add_u32 s65, s65, s72
    s_lshl_b32 s71, s71, 1
    s_add_u32 s72, s71, 0
    s_mul_hi_u32 s73, s72, 0x33333334
    s_mul_i32 s68, s73, 5
    s_sub_u32 s72, s72, s68
    s_mul_i32 s73, s73, 20
    s_add_u32 s73, s73, s70
    s_mul_i32 s73, s73, 5
    s_add_u32 s73, s73, s72
    s_lshl_b32 s68, s73, 10
    s_add_u32 s72, s71, 1
    s_mul_hi_u32 s73, s72, 0x33333334
    s_mul_i32 s69, s73, 5
    s_sub_u32 s72, s72, s69
    s_mul_i32 s73, s73, 20
    s_add_u32 s73, s73, s70
    s_mul_i32 s73, s73, 5
    s_add_u32 s73, s73, s72
    s_lshl_b32 s69, s73, 10
    s_cmp_ge_u32 s62, 400
    s_cselect_b32 s65, 0x40000000, s65
    s_cselect_b32 s68, 0x40000000, s68
    s_cselect_b32 s69, 0x40000000, s69
    v_writelane_b32 v10, s68, 3
    v_writelane_b32 v11, s69, 3
    s_add_u32 m0, s61, 6144
    s_add_u32 s66, s65, 20480
    buffer_load_dwordx4 v4, s[44:47], s65 offen lds
    s_add_u32 m0, s61, 7168
    s_nop 0
    buffer_load_dwordx4 v4, s[44:47], s66 offen lds
    s_waitcnt vmcnt(0)
    ds_read_b64_tr_b16 v[128:129], v6 offset:0
    ds_read_b64_tr_b16 v[130:131], v6 offset:1024
    ds_read_b64_tr_b16 v[132:133], v6 offset:32
    ds_read_b64_tr_b16 v[134:135], v6 offset:1056
    v_readlane_b32 s68, v10, 0
    v_readlane_b32 s69, v11, 0
    s_waitcnt lgkmcnt(2)
    s_nop 2
    buffer_store_dwordx4 v[128:131], v7, s[52:55], s68 offen sc1
    s_waitcnt lgkmcnt(0)
    buffer_store_dwordx4 v[132:135], v7, s[52:55], s69 offen sc1
    ds_read_b64_tr_b16 v[136:137], v6 offset:2048
    ds_read_b64_tr_b16 v[138:139], v6 offset:3072
    ds_read_b64_tr_b16 v[140:141], v6 offset:2080
    ds_read_b64_tr_b16 v[142:143], v6 offset:3104
    v_readlane_b32 s68, v10, 1
    v_readlane_b32 s69, v11, 1
    s_waitcnt lgkmcnt(2)
    s_nop 2
    buffer_store_dwordx4 v[136:139], v7, s[52:55], s68 offen sc1
    s_waitcnt lgkmcnt(0)
    buffer_store_dwordx4 v[140:143], v7, s[52:55], s69 offen sc1
    ds_read_b64_tr_b16 v[144:145], v6 offset:4096
    ds_read_b64_tr_b16 v[146:147], v6 offset:5120
    ds_read_b64_tr_b16 v[148:149], v6 offset:4128
    ds_read_b64_tr_b16 v[150:151], v6 offset:5152
    v_readlane_b32 s68, v10, 2
    v_readlane_b32 s69, v11, 2
    s_waitcnt lgkmcnt(2)
    s_nop 2
    buffer_store_dwordx4 v[144:147], v7, s[52:55], s68 offen sc1
    s_waitcnt lgkmcnt(0)
    buffer_store_dwordx4 v[148:151], v7, s[52:55], s69 offen sc1
    ds_read_b64_tr_b16 v[152:153], v6 offset:6144
    ds_read_b64_tr_b16 v[154:155], v6 offset:7168
    ds_read_b64_tr_b16 v[156:157], v6 offset:6176
    ds_read_b64_tr_b16 v[158:159], v6 offset:7200
    v_readlane_b32 s68, v10, 3
    v_readlane_b32 s69, v11, 3
    s_waitcnt lgkmcnt(2)
    s_nop 2
    buffer_store_dwordx4 v[152:155], v7, s[52:55], s68 offen sc1
    s_waitcnt lgkmcnt(0)
    buffer_store_dwordx4 v[156:159], v7, s[52:55], s69 offen sc1
    s_waitcnt vmcnt(0)
    s_barrier
    s_cmp_lg_u32 s3, 0
    s_cbranch_scc1 L_sp_noflag2
    s_lshl_b32 s11, s13, 2
    s_add_u32 s11, s11, 4096
    v_lshlrev_b32 v1, 7, v0
    v_mov_b32 v2, s92
    s_mov_b64 exec, 255
    buffer_store_dword v2, v1, s[84:87], s11 offen sc1
    s_mov_b64 exec, -1
L_sp_noflag2:
    s_cmp_ge_u32 s3, 4
    s_cbranch_scc1 L_p2_helper_spare
    s_lshl_b32 s11, s90, 7
    s_add_u32 s11, s11, 8192
    v_lshlrev_b32 v1, 2, v0
    s_mov_b64 s[94:95], 0xffff
L_sppk_poll:
    buffer_load_dword v3, v1, s[84:87], s11 offen sc1
    s_waitcnt vmcnt(0)
    v_cmp_ne_u32 vcc, s92, v3
    s_nop 1
    s_and_b64 vcc, vcc, s[94:95]
    s_cbranch_scc0 L_sppk_ok
    s_sleep 8
    s_branch L_sppk_poll
L_sppk_ok:
    s_branch L_p2_main_spare
L_p2_main_spare:
    s_barrier
    s_barrier
    v_lshlrev_b32 v1, 4, v0
    s_branch L_p2_m1
L_p2_main_entry:
    s_waitcnt vmcnt(0)
    s_barrier
    s_cmp_lg_u32 s3, 0
    s_cbranch_scc1 L_p2_m0
    s_cmp_eq_u32 s49, 2
    s_cbranch_scc1 L_p2_m1c
    v_lshlrev_b32 v3, 7, v0
    v_mov_b32 v4, s92
    s_mov_b64 exec, 1
    buffer_store_dword v4, v3, s[84:87], s55 offen sc1
    s_mov_b64 exec, -1
    s_branch L_p2_m0
L_p2_m1c:
    v_lshlrev_b32 v3, 8, v0
    v_mov_b32 v4, s92
    s_mov_b64 exec, 255
    buffer_store_dword v4, v3, s[84:87], s55 offen sc1
    s_mov_b64 exec, -1
L_p2_m0:
    v_lshlrev_b32 v1, 4, v0
L_p2_m1:
    s_mul_i32 s9, s3, 20480
    s_add_u32 s10, s9, 81920
    v_add_u32 v12, s10, v1
    s_add_u32 s10, s9, 0
    v_add_u32 v13, s10, v1
    ds_read_b128 v[112:115], v12 offset:0
    ds_read_b128 v[116:119], v12 offset:1024
    ds_read_b128 v[120:123], v12 offset:2048
    ds_read_b128 v[124:127], v12 offset:3072
    ds_read_b128 v[128:131], v12 offset:4096
    ds_read_b128 v[148:151], v12 offset:5120
    ds_read_b128 v[152:155], v12 offset:6144
    ds_read_b128 v[156:159], v12 offset:7168
    ds_read_b128 v[160:163], v12 offset:8192
    ds_read_b128 v[164:167], v12 offset:9216
    ds_read_b128 v[184:187], v12 offset:10240
    ds_read_b128 v[188:191], v12 offset:11264
    ds_read_b128 v[192:195], v12 offset:12288
    ds_read_b128 v[196:199], v12 offset:13312
    ds_read_b128 v[200:203], v12 offset:14336
    s_waitcnt lgkmcnt(5)
    ds_read_b128 v[220:223], v12 offset:15360
    ds_read_b128 v[224:227], v12 offset:16384
    ds_read_b128 v[228:231], v12 offset:17408
    ds_read_b128 v[232:235], v12 offset:18432
    ds_read_b128 v[236:239], v12 offset:19456
    s_mul_i32 s8, s3, 14
    s_cmp_eq_u32 s3, 3
    s_cselect_b32 s9, 1, 0
    s_sub_u32 s8, s8, s9
    s_cmp_ge_u32 s3, 2
    s_cselect_b32 s62, 13, 14
    s_lshl_b32 s60, s88, 2
    s_mul_i32 s60, s60, 75
    s_add_u32 s60, s60, s8
    s_lshl_b32 s60, s60, 10
    s_mul_i32 s61, s89, 74
    s_add_u32 s61, s61, s8
    s_mul_i32 s61, s61, 5120
    s_mul_i32 s63, s89, 7
    s_lshr_b32 s63, s63, 2
    s_and_b32 s9, s88, 3
    s_mul_i32 s9, s9, 7
    s_lshr_b32 s9, s9, 1
    s_add_u32 s63, s63, s9
    s_cmp_ge_u32 s63, 14
    s_cselect_b32 s9, 14, 0
    s_sub_u32 s63, s63, s9
    s_add_u32 s44, s36, 0xa00400
    s_addc_u32 s45, s37, 0
    s_mov_b32 s46, 0x2e4000
    s_mov_b32 s47, 0x20000
    v_add_u32 v2, 0x1000, v1
    s_mov_b32 s40, s36
    s_mov_b32 s41, s37
    s_mov_b32 s42, 0x960000
    s_mov_b32 s43, 0x20000
    s_mov_b32 s56, s32
    s_mov_b32 s57, s33
    s_mov_b32 s58, 0x280000
    s_mov_b32 s59, 0x20000
    s_waitcnt lgkmcnt(0)
    s_barrier
    v_add_u32 v4, 0x0, v1
    v_add_u32 v5, 0x12c00, v1
    v_add_u32 v6, 0x25800, v1
    v_add_u32 v7, 0x38400, v1
    v_mov_b32 v16, 0
    v_mov_b32 v17, 0
    v_mov_b32 v18, 0
    v_mov_b32 v19, 0
    v_mov_b32 v20, 0
    v_mov_b32 v21, 0
    v_mov_b32 v22, 0
    v_mov_b32 v23, 0
    v_mov_b32 v24, 0
    v_mov_b32 v25, 0
    v_mov_b32 v26, 0
    v_mov_b32 v27, 0
    v_mov_b32 v28, 0
    v_mov_b32 v29, 0
    v_mov_b32 v30, 0
    v_mov_b32 v31, 0
    v_mov_b32 v32, 0
    v_mov_b32 v33, 0
    v_mov_b32 v34, 0
    v_mov_b32 v35, 0
    v_mov_b32 v36, 0
    v_mov_b32 v37, 0
    v_mov_b32 v38, 0
    v_mov_b32 v39, 0
    v_mov_b32 v40, 0
    v_mov_b32 v41, 0
    v_mov_b32 v42, 0
    v_mov_b32 v43, 0
    v_mov_b32 v44, 0
    v_mov_b32 v45, 0
    v_mov_b32 v46, 0
    v_mov_b32 v47, 0
    v_mov_b32 v48, 0
    v_mov_b32 v49, 0
    v_mov_b32 v50, 0
    v_mov_b32 v51, 0
    v_mov_b32 v52, 0
    v_mov_b32 v53, 0
    v_mov_b32 v54, 0
    v_mov_b32 v55, 0
    v_mov_b32 v56, 0
    v_mov_b32 v57, 0
    v_mov_b32 v58, 0
    v_mov_b32 v59, 0
    v_mov_b32 v60, 0
    v_mov_b32 v61, 0
    v_mov_b32 v62, 0
    v_mov_b32 v63, 0
    v_mov_b32 v64, 0
    v_mov_b32 v65, 0
    v_mov_b32 v66, 0
    v_mov_b32 v67, 0
    v_mov_b32 v68, 0
    v_mov_b32 v69, 0
    v_mov_b32 v70, 0
    v_mov_b32 v71, 0
    v_mov_b32 v72, 0
    v_mov_b32 v73, 0
    v_mov_b32 v74, 0
    v_mov_b32 v75, 0
    v_mov_b32 v76, 0
    v_mov_b32 v77, 0
    v_mov_b32 v78, 0
    v_mov_b32 v79, 0
    v_mov_b32 v80, 0
    v_mov_b32 v81, 0
    v_mov_b32 v82, 0
    v_mov_b32 v83, 0
    v_mov_b32 v84, 0
    v_mov_b32 v85, 0
    v_mov_b32 v86, 0
    v_mov_b32 v87, 0
    v_mov_b32 v88, 0
    v_mov_b32 v89, 0
    v_mov_b32 v90, 0
    v_mov_b32 v91, 0
    v_mov_b32 v92, 0
    v_mov_b32 v93, 0
    v_mov_b32 v94, 0
    v_mov_b32 v95, 0
    s_mul_i32 s65, s89, 74
    s_add_u32 s65, s65, 54
    s_mul_i32 s9, s3, 5
    s_add_u32 s65, s65, s9
    s_mul_i32 s65, s65, 5120
    s_barrier
    s_add_u32 s64, s63, 0
    s_cmp_ge_u32 s64, 14
    s_cselect_b32 s66, 14, 0
    s_sub_u32 s64, s64, s66
    s_lshl_b32 s66, s64, 10
    s_add_u32 s66, s66, s60
    s_cmp_eq_u32 s64, s62
    s_cselect_b32 s66, 0x40000000, s66
    buffer_load_dwordx4 v[96:99], v4, s[40:43], s66 offen sc1
    buffer_load_dwordx4 v[100:103], v5, s[40:43], s66 offen sc1
    buffer_load_dwordx4 v[104:107], v6, s[40:43], s66 offen sc1
    buffer_load_dwordx4 v[108:111], v7, s[40:43], s66 offen sc1
    s_add_u32 s64, s63, 1
    s_cmp_ge_u32 s64, 14
    s_cselect_b32 s66, 14, 0
    s_sub_u32 s64, s64, s66
    s_lshl_b32 s66, s64, 10
    s_add_u32 s66, s66, s60
    s_cmp_eq_u32 s64, s62
    s_cselect_b32 s66, 0x40000000, s66
    buffer_load_dwordx4 v[132:135], v4, s[40:43], s66 offen sc1
    buffer_load_dwordx4 v[136:139], v5, s[40:43], s66 offen sc1
    buffer_load_dwordx4 v[140:143], v6, s[40:43], s66 offen sc1
    buffer_load_dwordx4 v[144:147], v7, s[40:43], s66 offen sc1
    s_add_u32 s64, s63, 2
    s_cmp_ge_u32 s64, 14
    s_cselect_b32 s66, 14, 0
    s_sub_u32 s64, s64, s66
    s_lshl_b32 s66, s64, 10
    s_add_u32 s66, s66, s60
    s_cmp_eq_u32 s64, s62
    s_cselect_b32 s66, 0x40000000, s66
    buffer_load_dwordx4 v[168:171], v4, s[40:43], s66 offen sc1
    buffer_load_dwordx4 v[172:175], v5, s[40:43], s66 offen sc1
    buffer_load_dwordx4 v[176:179], v6, s[40:43], s66 offen sc1
    buffer_load_dwordx4 v[180:183], v7, s[40:43], s66 offen sc1
    s_add_u32 s64, s63, 3
    s_cmp_ge_u32 s64, 14
    s_cselect_b32 s66, 14, 0
    s_sub_u32 s64, s64, s66
    s_lshl_b32 s66, s64, 10
    s_add_u32 s66, s66, s60
    s_cmp_eq_u32 s64, s62
    s_cselect_b32 s66, 0x40000000, s66
    buffer_load_dwordx4 v[204:207], v4, s[40:43], s66 offen sc1
    buffer_load_dwordx4 v[208:211], v5, s[40:43], s66 offen sc1
    buffer_load_dwordx4 v[212:215], v6, s[40:43], s66 offen sc1
    buffer_load_dwordx4 v[216:219], v7, s[40:43], s66 offen sc1
    s_add_u32 s48, s36, 0xf80000
    s_addc_u32 s49, s37, 0
    s_mov_b32 s50, 0x2000
    s_mov_b32 s51, 0x20000
    v_and_b32 v3, 15, v0
    v_lshlrev_b32 v3, 2, v3
    s_lshl_b32 s6, s88, 8
    buffer_load_dword v244, v3, s[48:51], s6 offen offset:0 sc1
    buffer_load_dword v245, v3, s[48:51], s6 offen offset:64 sc1
    buffer_load_dword v246, v3, s[48:51], s6 offen offset:128 sc1
    buffer_load_dword v247, v3, s[48:51], s6 offen offset:192 sc1
    s_waitcnt vmcnt(16)
    v_mfma_f32_16x16x32_bf16 v[16:19], v[112:115], v[96:99], v[16:19]
    v_mfma_f32_16x16x32_bf16 v[20:23], v[112:115], v[100:103], v[20:23]
    v_mfma_f32_16x16x32_bf16 v[24:27], v[112:115], v[104:107], v[24:27]
    v_mfma_f32_16x16x32_bf16 v[28:31], v[112:115], v[108:111], v[28:31]
    v_mfma_f32_16x16x32_bf16 v[32:35], v[116:119], v[96:99], v[32:35]
    v_mfma_f32_16x16x32_bf16 v[36:39], v[116:119], v[100:103], v[36:39]
    v_mfma_f32_16x16x32_bf16 v[40:43], v[116:119], v[104:107], v[40:43]
    v_mfma_f32_16x16x32_bf16 v[44:47], v[116:119], v[108:111], v[44:47]
    v_mfma_f32_16x16x32_bf16 v[48:51], v[120:123], v[96:99], v[48:51]
    v_mfma_f32_16x16x32_bf16 v[52:55], v[120:123], v[100:103], v[52:55]
    v_mfma_f32_16x16x32_bf16 v[56:59], v[120:123], v[104:107], v[56:59]
    v_mfma_f32_16x16x32_bf16 v[60:63], v[120:123], v[108:111], v[60:63]
    v_mfma_f32_16x16x32_bf16 v[64:67], v[124:127], v[96:99], v[64:67]
    v_mfma_f32_16x16x32_bf16 v[68:71], v[124:127], v[100:103], v[68:71]
    v_mfma_f32_16x16x32_bf16 v[72:75], v[124:127], v[104:107], v[72:75]
    v_mfma_f32_16x16x32_bf16 v[76:79], v[124:127], v[108:111], v[76:79]
    v_mfma_f32_16x16x32_bf16 v[80:83], v[128:131], v[96:99], v[80:83]
    v_mfma_f32_16x16x32_bf16 v[84:87], v[128:131], v[100:103], v[84:87]
    v_mfma_f32_16x16x32_bf16 v[88:91], v[128:131], v[104:107], v[88:91]
    v_mfma_f32_16x16x32_bf16 v[92:95], v[128:131], v[108:111], v[92:95]
    s_add_u32 s64, s63, 4
    s_cmp_ge_u32 s64, 14
    s_cselect_b32 s66, 14, 0
    s_sub_u32 s64, s64, s66
    s_lshl_b32 s66, s64, 10
    s_add_u32 s66, s66, s60
    s_cmp_eq_u32 s64, s62
    s_cselect_b32 s66, 0x40000000, s66
    buffer_load_dwordx4 v[96:99], v4, s[40:43], s66 offen sc1
    buffer_load_dwordx4 v[100:103], v5, s[40:43], s66 offen sc1
    buffer_load_dwordx4 v[104:107], v6, s[40:43], s66 offen sc1
    buffer_load_dwordx4 v[108:111], v7, s[40:43], s66 offen sc1
    ds_read_b128 v[112:115], v13 offset:0
    ds_read_b128 v[116:119], v13 offset:1024
    ds_read_b128 v[120:123], v13 offset:2048
    ds_read_b128 v[124:127], v13 offset:3072
    ds_read_b128 v[128:131], v13 offset:4096
    s_waitcnt vmcnt(16)
    v_mfma_f32_16x16x32_bf16 v[16:19], v[148:151], v[132:135], v[16:19]
    v_mfma_f32_16x16x32_bf16 v[20:23], v[148:151], v[136:139], v[20:23]
    v_mfma_f32_16x16x32_bf16 v[24:27], v[148:151], v[140:143], v[24:27]
    v_mfma_f32_16x16x32_bf16 v[28:31], v[148:151], v[144:147], v[28:31]
    v_mfma_f32_16x16x32_bf16 v[32:35], v[152:155], v[132:135], v[32:35]
    v_mfma_f32_16x16x32_bf16 v[36:39], v[152:155], v[136:139], v[36:39]
    v_mfma_f32_16x16x32_bf16 v[40:43], v[152:155], v[140:143], v[40:43]
    v_mfma_f32_16x16x32_bf16 v[44:47], v[152:155], v[144:147], v[44:47]
    v_mfma_f32_16x16x32_bf16 v[48:51], v[156:159], v[132:135], v[48:51]
    v_mfma_f32_16x16x32_bf16 v[52:55], v[156:159], v[136:139], v[52:55]
    v_mfma_f32_16x16x32_bf16 v[56:59], v[156:159], v[140:143], v[56:59]
    v_mfma_f32_16x16x32_bf16 v[60:63], v[156:159], v[144:147], v[60:63]
    v_mfma_f32_16x16x32_bf16 v[64:67], v[160:163], v[132:135], v[64:67]
    v_mfma_f32_16x16x32_bf16 v[68:71], v[160:163], v[136:139], v[68:71]
    v_mfma_f32_16x16x32_bf16 v[72:75], v[160:163], v[140:143], v[72:75]
    v_mfma_f32_16x16x32_bf16 v[76:79], v[160:163], v[144:147], v[76:79]
    v_mfma_f32_16x16x32_bf16 v[80:83], v[164:167], v[132:135], v[80:83]
    v_mfma_f32_16x16x32_bf16 v[84:87], v[164:167], v[136:139], v[84:87]
    v_mfma_f32_16x16x32_bf16 v[88:91], v[164:167], v[140:143], v[88:91]
    v_mfma_f32_16x16x32_bf16 v[92:95], v[164:167], v[144:147], v[92:95]
    s_add_u32 s64, s63, 5
    s_cmp_ge_u32 s64, 14
    s_cselect_b32 s66, 14, 0
    s_sub_u32 s64, s64, s66
    s_lshl_b32 s66, s64, 10
    s_add_u32 s66, s66, s60
    s_cmp_eq_u32 s64, s62
    s_cselect_b32 s66, 0x40000000, s66
    buffer_load_dwordx4 v[132:135], v4, s[40:43], s66 offen sc1
    buffer_load_dwordx4 v[136:139], v5, s[40:43], s66 offen sc1
    buffer_load_dwordx4 v[140:143], v6, s[40:43], s66 offen sc1
    buffer_load_dwordx4 v[144:147], v7, s[40:43], s66 offen sc1
    ds_read_b128 v[148:151], v13 offset:5120
    ds_read_b128 v[152:155], v13 offset:6144
    ds_read_b128 v[156:159], v13 offset:7168
    ds_read_b128 v[160:163], v13 offset:8192
    ds_read_b128 v[164:167], v13 offset:9216
    s_waitcnt vmcnt(16)
    v_mfma_f32_16x16x32_bf16 v[16:19], v[184:187], v[168:171], v[16:19]
    v_mfma_f32_16x16x32_bf16 v[20:23], v[184:187], v[172:175], v[20:23]
    v_mfma_f32_16x16x32_bf16 v[24:27], v[184:187], v[176:179], v[24:27]
    v_mfma_f32_16x16x32_bf16 v[28:31], v[184:187], v[180:183], v[28:31]
    v_mfma_f32_16x16x32_bf16 v[32:35], v[188:191], v[168:171], v[32:35]
    v_mfma_f32_16x16x32_bf16 v[36:39], v[188:191], v[172:175], v[36:39]
    v_mfma_f32_16x16x32_bf16 v[40:43], v[188:191], v[176:179], v[40:43]
    v_mfma_f32_16x16x32_bf16 v[44:47], v[188:191], v[180:183], v[44:47]
    v_mfma_f32_16x16x32_bf16 v[48:51], v[192:195], v[168:171], v[48:51]
    v_mfma_f32_16x16x32_bf16 v[52:55], v[192:195], v[172:175], v[52:55]
    v_mfma_f32_16x16x32_bf16 v[56:59], v[192:195], v[176:179], v[56:59]
    v_mfma_f32_16x16x32_bf16 v[60:63], v[192:195], v[180:183], v[60:63]
    v_mfma_f32_16x16x32_bf16 v[64:67], v[196:199], v[168:171], v[64:67]
    v_mfma_f32_16x16x32_bf16 v[68:71], v[196:199], v[172:175], v[68:71]
    v_mfma_f32_16x16x32_bf16 v[72:75], v[196:199], v[176:179], v[72:75]
    v_mfma_f32_16x16x32_bf16 v[76:79], v[196:199], v[180:183], v[76:79]
    v_mfma_f32_16x16x32_bf16 v[80:83], v[200:203], v[168:171], v[80:83]
    v_mfma_f32_16x16x32_bf16 v[84:87], v[200:203], v[172:175], v[84:87]
    v_mfma_f32_16x16x32_bf16 v[88:91], v[200:203], v[176:179], v[88:91]
    v_mfma_f32_16x16x32_bf16 v[92:95], v[200:203], v[180:183], v[92:95]
    s_add_u32 s64, s63, 6
    s_cmp_ge_u32 s64, 14
    s_cselect_b32 s66, 14, 0
    s_sub_u32 s64, s64, s66
    s_lshl_b32 s66, s64, 10
    s_add_u32 s66, s66, s60
    s_cmp_eq_u32 s64, s62
    s_cselect_b32 s66, 0x40000000, s66
    buffer_load_dwordx4 v[168:171], v4, s[40:43], s66 offen sc1
    buffer_load_dwordx4 v[172:175], v5, s[40:43], s66 offen sc1
    buffer_load_dwordx4 v[176:179], v6, s[40:43], s66 offen sc1
    buffer_load_dwordx4 v[180:183], v7, s[40:43], s66 offen sc1
    ds_read_b128 v[184:187], v13 offset:10240
    ds_read_b128 v[188:191], v13 offset:11264
    ds_read_b128 v[192:195], v13 offset:12288
    ds_read_b128 v[196:199], v13 offset:13312
    ds_read_b128 v[200:203], v13 offset:14336
    s_waitcnt vmcnt(16)
    v_mfma_f32_16x16x32_bf16 v[16:19], v[220:223], v[204:207], v[16:19]
    v_mfma_f32_16x16x32_bf16 v[20:23], v[220:223], v[208:211], v[20:23]
    v_mfma_f32_16x16x32_bf16 v[24:27], v[220:223], v[212:215], v[24:27]
    v_mfma_f32_16x16x32_bf16 v[28:31], v[220:223], v[216:219], v[28:31]
    v_mfma_f32_16x16x32_bf16 v[32:35], v[224:227], v[204:207], v[32:35]
    v_mfma_f32_16x16x32_bf16 v[36:39], v[224:227], v[208:211], v[36:39]
    v_mfma_f32_16x16x32_bf16 v[40:43], v[224:227], v[212:215], v[40:43]
    v_mfma_f32_16x16x32_bf16 v[44:47], v[224:227], v[216:219], v[44:47]
    v_mfma_f32_16x16x32_bf16 v[48:51], v[228:231], v[204:207], v[48:51]
    v_mfma_f32_16x16x32_bf16 v[52:55], v[228:231], v[208:211], v[52:55]
    v_mfma_f32_16x16x32_bf16 v[56:59], v[228:231], v[212:215], v[56:59]
    v_mfma_f32_16x16x32_bf16 v[60:63], v[228:231], v[216:219], v[60:63]
    v_mfma_f32_16x16x32_bf16 v[64:67], v[232:235], v[204:207], v[64:67]
    v_mfma_f32_16x16x32_bf16 v[68:71], v[232:235], v[208:211], v[68:71]
    v_mfma_f32_16x16x32_bf16 v[72:75], v[232:235], v[212:215], v[72:75]
    v_mfma_f32_16x16x32_bf16 v[76:79], v[232:235], v[216:219], v[76:79]
    v_mfma_f32_16x16x32_bf16 v[80:83], v[236:239], v[204:207], v[80:83]
    v_mfma_f32_16x16x32_bf16 v[84:87], v[236:239], v[208:211], v[84:87]
    v_mfma_f32_16x16x32_bf16 v[88:91], v[236:239], v[212:215], v[88:91]
    v_mfma_f32_16x16x32_bf16 v[92:95], v[236:239], v[216:219], v[92:95]
    s_add_u32 s64, s63, 7
    s_cmp_ge_u32 s64, 14
    s_cselect_b32 s66, 14, 0
    s_sub_u32 s64, s64, s66
    s_lshl_b32 s66, s64, 10
    s_add_u32 s66, s66, s60
    s_cmp_eq_u32 s64, s62
    s_cselect_b32 s66, 0x40000000, s66
    buffer_load_dwordx4 v[204:207], v4, s[40:43], s66 offen sc1
    buffer_load_dwordx4 v[208:211], v5, s[40:43], s66 offen sc1
    buffer_load_dwordx4 v[212:215], v6, s[40:43], s66 offen sc1
    buffer_load_dwordx4 v[216:219], v7, s[40:43], s66 offen sc1
    ds_read_b128 v[220:223], v13 offset:15360
    ds_read_b128 v[224:227], v13 offset:16384
    ds_read_b128 v[228:231], v13 offset:17408
    ds_read_b128 v[232:235], v13 offset:18432
    ds_read_b128 v[236:239], v13 offset:19456
    s_waitcnt vmcnt(12) lgkmcnt(15)
    v_mfma_f32_16x16x32_bf16 v[16:19], v[112:115], v[96:99], v[16:19]
    v_mfma_f32_16x16x32_bf16 v[20:23], v[112:115], v[100:103], v[20:23]
    v_mfma_f32_16x16x32_bf16 v[24:27], v[112:115], v[104:107], v[24:27]
    v_mfma_f32_16x16x32_bf16 v[28:31], v[112:115], v[108:111], v[28:31]
    v_mfma_f32_16x16x32_bf16 v[32:35], v[116:119], v[96:99], v[32:35]
    v_mfma_f32_16x16x32_bf16 v[36:39], v[116:119], v[100:103], v[36:39]
    v_mfma_f32_16x16x32_bf16 v[40:43], v[116:119], v[104:107], v[40:43]
    v_mfma_f32_16x16x32_bf16 v[44:47], v[116:119], v[108:111], v[44:47]
    v_mfma_f32_16x16x32_bf16 v[48:51], v[120:123], v[96:99], v[48:51]
    v_mfma_f32_16x16x32_bf16 v[52:55], v[120:123], v[100:103], v[52:55]
    v_mfma_f32_16x16x32_bf16 v[56:59], v[120:123], v[104:107], v[56:59]
    v_mfma_f32_16x16x32_bf16 v[60:63], v[120:123], v[108:111], v[60:63]
    v_mfma_f32_16x16x32_bf16 v[64:67], v[124:127], v[96:99], v[64:67]
    v_mfma_f32_16x16x32_bf16 v[68:71], v[124:127], v[100:103], v[68:71]
    v_mfma_f32_16x16x32_bf16 v[72:75], v[124:127], v[104:107], v[72:75]
    v_mfma_f32_16x16x32_bf16 v[76:79], v[124:127], v[108:111], v[76:79]
    v_mfma_f32_16x16x32_bf16 v[80:83], v[128:131], v[96:99], v[80:83]
    v_mfma_f32_16x16x32_bf16 v[84:87], v[128:131], v[100:103], v[84:87]
    v_mfma_f32_16x16x32_bf16 v[88:91], v[128:131], v[104:107], v[88:91]
    v_mfma_f32_16x16x32_bf16 v[92:95], v[128:131], v[108:111], v[92:95]
    s_add_u32 s64, s63, 8
    s_cmp_ge_u32 s64, 14
    s_cselect_b32 s66, 14, 0
    s_sub_u32 s64, s64, s66
    s_lshl_b32 s66, s64, 10
    s_add_u32 s66, s66, s60
    s_cmp_eq_u32 s64, s62
    s_cselect_b32 s66, 0x40000000, s66
    buffer_load_dwordx4 v[96:99], v4, s[40:43], s66 offen sc1
    buffer_load_dwordx4 v[100:103], v5, s[40:43], s66 offen sc1
    buffer_load_dwordx4 v[104:107], v6, s[40:43], s66 offen sc1
    buffer_load_dwordx4 v[108:111], v7, s[40:43], s66 offen sc1
    ds_read_b128 v[112:115], v12 offset:0
    ds_read_b128 v[116:119], v12 offset:1024
    ds_read_b128 v[120:123], v12 offset:2048
    ds_read_b128 v[124:127], v12 offset:3072
    ds_read_b128 v[128:131], v12 offset:4096
    s_waitcnt vmcnt(12) lgkmcnt(15)
    v_mfma_f32_16x16x32_bf16 v[16:19], v[148:151], v[132:135], v[16:19]
    v_mfma_f32_16x16x32_bf16 v[20:23], v[148:151], v[136:139], v[20:23]
    v_mfma_f32_16x16x32_bf16 v[24:27], v[148:151], v[140:143], v[24:27]
    v_mfma_f32_16x16x32_bf16 v[28:31], v[148:151], v[144:147], v[28:31]
    v_mfma_f32_16x16x32_bf16 v[32:35], v[152:155], v[132:135], v[32:35]
    v_mfma_f32_16x16x32_bf16 v[36:39], v[152:155], v[136:139], v[36:39]
    v_mfma_f32_16x16x32_bf16 v[40:43], v[152:155], v[140:143], v[40:43]
    v_mfma_f32_16x16x32_bf16 v[44:47], v[152:155], v[144:147], v[44:47]
    v_mfma_f32_16x16x32_bf16 v[48:51], v[156:159], v[132:135], v[48:51]
    v_mfma_f32_16x16x32_bf16 v[52:55], v[156:159], v[136:139], v[52:55]
    v_mfma_f32_16x16x32_bf16 v[56:59], v[156:159], v[140:143], v[56:59]
    v_mfma_f32_16x16x32_bf16 v[60:63], v[156:159], v[144:147], v[60:63]
    v_mfma_f32_16x16x32_bf16 v[64:67], v[160:163], v[132:135], v[64:67]
    v_mfma_f32_16x16x32_bf16 v[68:71], v[160:163], v[136:139], v[68:71]
    v_mfma_f32_16x16x32_bf16 v[72:75], v[160:163], v[140:143], v[72:75]
    v_mfma_f32_16x16x32_bf16 v[76:79], v[160:163], v[144:147], v[76:79]
    v_mfma_f32_16x16x32_bf16 v[80:83], v[164:167], v[132:135], v[80:83]
    v_mfma_f32_16x16x32_bf16 v[84:87], v[164:167], v[136:139], v[84:87]
    v_mfma_f32_16x16x32_bf16 v[88:91], v[164:167], v[140:143], v[88:91]
    v_mfma_f32_16x16x32_bf16 v[92:95], v[164:167], v[144:147], v[92:95]
    s_add_u32 s64, s63, 9
    s_cmp_ge_u32 s64, 14
    s_cselect_b32 s66, 14, 0
    s_sub_u32 s64, s64, s66
    s_lshl_b32 s66, s64, 10
    s_add_u32 s66, s66, s60
    s_cmp_eq_u32 s64, s62
    s_cselect_b32 s66, 0x40000000, s66
    buffer_load_dwordx4 v[132:135], v4, s[40:43], s66 offen sc1
    buffer_load_dwordx4 v[136:139], v5, s[40:43], s66 offen sc1
    buffer_load_dwordx4 v[140:143], v6, s[40:43], s66 offen sc1
    buffer_load_dwordx4 v[144:147], v7, s[40:43], s66 offen sc1
    ds_read_b128 v[148:151], v12 offset:5120
    ds_read_b128 v[152:155], v12 offset:6144
    ds_read_b128 v[156:159], v12 offset:7168
    ds_read_b128 v[160:163], v12 offset:8192
    ds_read_b128 v[164:167], v12 offset:9216
    s_waitcnt vmcnt(12) lgkmcnt(15)
    v_mfma_f32_16x16x32_bf16 v[16:19], v[184:187], v[168:171], v[16:19]
    v_mfma_f32_16x16x32_bf16 v[20:23], v[184:187], v[172:175], v[20:23]
    v_mfma_f32_16x16x32_bf16 v[24:27], v[184:187], v[176:179], v[24:27]
    v_mfma_f32_16x16x32_bf16 v[28:31], v[184:187], v[180:183], v[28:31]
    v_mfma_f32_16x16x32_bf16 v[32:35], v[188:191], v[168:171], v[32:35]
    v_mfma_f32_16x16x32_bf16 v[36:39], v[188:191], v[172:175], v[36:39]
    v_mfma_f32_16x16x32_bf16 v[40:43], v[188:191], v[176:179], v[40:43]
    v_mfma_f32_16x16x32_bf16 v[44:47], v[188:191], v[180:183], v[44:47]
    v_mfma_f32_16x16x32_bf16 v[48:51], v[192:195], v[168:171], v[48:51]
    v_mfma_f32_16x16x32_bf16 v[52:55], v[192:195], v[172:175], v[52:55]
    v_mfma_f32_16x16x32_bf16 v[56:59], v[192:195], v[176:179], v[56:59]
    v_mfma_f32_16x16x32_bf16 v[60:63], v[192:195], v[180:183], v[60:63]
    v_mfma_f32_16x16x32_bf16 v[64:67], v[196:199], v[168:171], v[64:67]
    v_mfma_f32_16x16x32_bf16 v[68:71], v[196:199], v[172:175], v[68:71]
    v_mfma_f32_16x16x32_bf16 v[72:75], v[196:199], v[176:179], v[72:75]
    v_mfma_f32_16x16x32_bf16 v[76:79], v[196:199], v[180:183], v[76:79]
    v_mfma_f32_16x16x32_bf16 v[80:83], v[200:203], v[168:171], v[80:83]
    v_mfma_f32_16x16x32_bf16 v[84:87], v[200:203], v[172:175], v[84:87]
    v_mfma_f32_16x16x32_bf16 v[88:91], v[200:203], v[176:179], v[88:91]
    v_mfma_f32_16x16x32_bf16 v[92:95], v[200:203], v[180:183], v[92:95]
    s_add_u32 s64, s63, 10
    s_cmp_ge_u32 s64, 14
    s_cselect_b32 s66, 14, 0
    s_sub_u32 s64, s64, s66
    s_lshl_b32 s66, s64, 10
    s_add_u32 s66, s66, s60
    s_cmp_eq_u32 s64, s62
    s_cselect_b32 s66, 0x40000000, s66
    buffer_load_dwordx4 v[168:171], v4, s[40:43], s66 offen sc1
    buffer_load_dwordx4 v[172:175], v5, s[40:43], s66 offen sc1
    buffer_load_dwordx4 v[176:179], v6, s[40:43], s66 offen sc1
    buffer_load_dwordx4 v[180:183], v7, s[40:43], s66 offen sc1
    ds_read_b128 v[184:187], v12 offset:10240
    ds_read_b128 v[188:191], v12 offset:11264
    ds_read_b128 v[192:195], v12 offset:12288
    ds_read_b128 v[196:199], v12 offset:13312
    ds_read_b128 v[200:203], v12 offset:14336
    s_waitcnt vmcnt(12) lgkmcnt(15)
    v_mfma_f32_16x16x32_bf16 v[16:19], v[220:223], v[204:207], v[16:19]
    v_mfma_f32_16x16x32_bf16 v[20:23], v[220:223], v[208:211], v[20:23]
    v_mfma_f32_16x16x32_bf16 v[24:27], v[220:223], v[212:215], v[24:27]
    v_mfma_f32_16x16x32_bf16 v[28:31], v[220:223], v[216:219], v[28:31]
    v_mfma_f32_16x16x32_bf16 v[32:35], v[224:227], v[204:207], v[32:35]
    v_mfma_f32_16x16x32_bf16 v[36:39], v[224:227], v[208:211], v[36:39]
    v_mfma_f32_16x16x32_bf16 v[40:43], v[224:227], v[212:215], v[40:43]
    v_mfma_f32_16x16x32_bf16 v[44:47], v[224:227], v[216:219], v[44:47]
    v_mfma_f32_16x16x32_bf16 v[48:51], v[228:231], v[204:207], v[48:51]
    v_mfma_f32_16x16x32_bf16 v[52:55], v[228:231], v[208:211], v[52:55]
    v_mfma_f32_16x16x32_bf16 v[56:59], v[228:231], v[212:215], v[56:59]
    v_mfma_f32_16x16x32_bf16 v[60:63], v[228:231], v[216:219], v[60:63]
    v_mfma_f32_16x16x32_bf16 v[64:67], v[232:235], v[204:207], v[64:67]
    v_mfma_f32_16x16x32_bf16 v[68:71], v[232:235], v[208:211], v[68:71]
    v_mfma_f32_16x16x32_bf16 v[72:75], v[232:235], v[212:215], v[72:75]
    v_mfma_f32_16x16x32_bf16 v[76:79], v[232:235], v[216:219], v[76:79]
    v_mfma_f32_16x16x32_bf16 v[80:83], v[236:239], v[204:207], v[80:83]
    v_mfma_f32_16x16x32_bf16 v[84:87], v[236:239], v[208:211], v[84:87]
    v_mfma_f32_16x16x32_bf16 v[88:91], v[236:239], v[212:215], v[88:91]
    v_mfma_f32_16x16x32_bf16 v[92:95], v[236:239], v[216:219], v[92:95]
    s_add_u32 s64, s63, 11
    s_cmp_ge_u32 s64, 14
    s_cselect_b32 s66, 14, 0
    s_sub_u32 s64, s64, s66
    s_lshl_b32 s66, s64, 10
    s_add_u32 s66, s66, s60
    s_cmp_eq_u32 s64, s62
    s_cselect_b32 s66, 0x40000000, s66
    buffer_load_dwordx4 v[204:207], v4, s[40:43], s66 offen sc1
    buffer_load_dwordx4 v[208:211], v5, s[40:43], s66 offen sc1
    buffer_load_dwordx4 v[212:215], v6, s[40:43], s66 offen sc1
    buffer_load_dwordx4 v[216:219], v7, s[40:43], s66 offen sc1
    ds_read_b128 v[220:223], v12 offset:15360
    ds_read_b128 v[224:227], v12 offset:16384
    ds_read_b128 v[228:231], v12 offset:17408
    ds_read_b128 v[232:235], v12 offset:18432
    ds_read_b128 v[236:239], v12 offset:19456
    s_waitcnt vmcnt(12) lgkmcnt(15)
    v_mfma_f32_16x16x32_bf16 v[16:19], v[112:115], v[96:99], v[16:19]
    v_mfma_f32_16x16x32_bf16 v[20:23], v[112:115], v[100:103], v[20:23]
    v_mfma_f32_16x16x32_bf16 v[24:27], v[112:115], v[104:107], v[24:27]
    v_mfma_f32_16x16x32_bf16 v[28:31], v[112:115], v[108:111], v[28:31]
    v_mfma_f32_16x16x32_bf16 v[32:35], v[116:119], v[96:99], v[32:35]
    v_mfma_f32_16x16x32_bf16 v[36:39], v[116:119], v[100:103], v[36:39]
    v_mfma_f32_16x16x32_bf16 v[40:43], v[116:119], v[104:107], v[40:43]
    v_mfma_f32_16x16x32_bf16 v[44:47], v[116:119], v[108:111], v[44:47]
    v_mfma_f32_16x16x32_bf16 v[48:51], v[120:123], v[96:99], v[48:51]
    v_mfma_f32_16x16x32_bf16 v[52:55], v[120:123], v[100:103], v[52:55]
    v_mfma_f32_16x16x32_bf16 v[56:59], v[120:123], v[104:107], v[56:59]
    v_mfma_f32_16x16x32_bf16 v[60:63], v[120:123], v[108:111], v[60:63]
    v_mfma_f32_16x16x32_bf16 v[64:67], v[124:127], v[96:99], v[64:67]
    v_mfma_f32_16x16x32_bf16 v[68:71], v[124:127], v[100:103], v[68:71]
    v_mfma_f32_16x16x32_bf16 v[72:75], v[124:127], v[104:107], v[72:75]
    v_mfma_f32_16x16x32_bf16 v[76:79], v[124:127], v[108:111], v[76:79]
    v_mfma_f32_16x16x32_bf16 v[80:83], v[128:131], v[96:99], v[80:83]
    v_mfma_f32_16x16x32_bf16 v[84:87], v[128:131], v[100:103], v[84:87]
    v_mfma_f32_16x16x32_bf16 v[88:91], v[128:131], v[104:107], v[88:91]
    v_mfma_f32_16x16x32_bf16 v[92:95], v[128:131], v[108:111], v[92:95]
    s_add_u32 s64, s63, 12
    s_cmp_ge_u32 s64, 14
    s_cselect_b32 s66, 14, 0
    s_sub_u32 s64, s64, s66
    s_lshl_b32 s66, s64, 10
    s_add_u32 s66, s66, s60
    s_cmp_eq_u32 s64, s62
    s_cselect_b32 s66, 0x40000000, s66
    buffer_load_dwordx4 v[96:99], v4, s[40:43], s66 offen sc1
    buffer_load_dwordx4 v[100:103], v5, s[40:43], s66 offen sc1
    buffer_load_dwordx4 v[104:107], v6, s[40:43], s66 offen sc1
    buffer_load_dwordx4 v[108:111], v7, s[40:43], s66 offen sc1
    s_add_u32 s64, s63, 12
    s_cmp_ge_u32 s64, 14
    s_cselect_b32 s66, 14, 0
    s_sub_u32 s64, s64, s66
    s_mul_i32 s66, s64, 5120
    s_add_u32 s66, s66, s61
    s_cmp_eq_u32 s64, s62
    s_cselect_b32 s66, 0x40000000, s66
    buffer_load_dwordx4 v[112:115], v1, s[44:47], s66 offen offset:0 sc1
    buffer_load_dwordx4 v[116:119], v1, s[44:47], s66 offen offset:1024 sc1
    buffer_load_dwordx4 v[120:123], v1, s[44:47], s66 offen offset:2048 sc1
    buffer_load_dwordx4 v[124:127], v1, s[44:47], s66 offen offset:3072 sc1
    buffer_load_dwordx4 v[128:131], v2, s[44:47], s66 offen sc1
    s_waitcnt vmcnt(17) lgkmcnt(10)
    v_mfma_f32_16x16x32_bf16 v[16:19], v[148:151], v[132:135], v[16:19]
    v_mfma_f32_16x16x32_bf16 v[20:23], v[148:151], v[136:139], v[20:23]
    v_mfma_f32_16x16x32_bf16 v[24:27], v[148:151], v[140:143], v[24:27]
    v_mfma_f32_16x16x32_bf16 v[28:31], v[148:151], v[144:147], v[28:31]
    v_mfma_f32_16x16x32_bf16 v[32:35], v[152:155], v[132:135], v[32:35]
    v_mfma_f32_16x16x32_bf16 v[36:39], v[152:155], v[136:139], v[36:39]
    v_mfma_f32_16x16x32_bf16 v[40:43], v[152:155], v[140:143], v[40:43]
    v_mfma_f32_16x16x32_bf16 v[44:47], v[152:155], v[144:147], v[44:47]
    v_mfma_f32_16x16x32_bf16 v[48:51], v[156:159], v[132:135], v[48:51]
    v_mfma_f32_16x16x32_bf16 v[52:55], v[156:159], v[136:139], v[52:55]
    v_mfma_f32_16x16x32_bf16 v[56:59], v[156:159], v[140:143], v[56:59]
    v_mfma_f32_16x16x32_bf16 v[60:63], v[156:159], v[144:147], v[60:63]
    v_mfma_f32_16x16x32_bf16 v[64:67], v[160:163], v[132:135], v[64:67]
    v_mfma_f32_16x16x32_bf16 v[68:71], v[160:163], v[136:139], v[68:71]
    v_mfma_f32_16x16x32_bf16 v[72:75], v[160:163], v[140:143], v[72:75]
    v_mfma_f32_16x16x32_bf16 v[76:79], v[160:163], v[144:147], v[76:79]
    v_mfma_f32_16x16x32_bf16 v[80:83], v[164:167], v[132:135], v[80:83]
    v_mfma_f32_16x16x32_bf16 v[84:87], v[164:167], v[136:139], v[84:87]
    v_mfma_f32_16x16x32_bf16 v[88:91], v[164:167], v[140:143], v[88:91]
    v_mfma_f32_16x16x32_bf16 v[92:95], v[164:167], v[144:147], v[92:95]
    s_add_u32 s64, s63, 13
    s_cmp_ge_u32 s64, 14
    s_cselect_b32 s66, 14, 0
    s_sub_u32 s64, s64, s66
    s_lshl_b32 s66, s64, 10
    s_add_u32 s66, s66, s60
    s_cmp_eq_u32 s64, s62
    s_cselect_b32 s66, 0x40000000, s66
    buffer_load_dwordx4 v[132:135], v4, s[40:43], s66 offen sc1
    buffer_load_dwordx4 v[136:139], v5, s[40:43], s66 offen sc1
    buffer_load_dwordx4 v[140:143], v6, s[40:43], s66 offen sc1
    buffer_load_dwordx4 v[144:147], v7, s[40:43], s66 offen sc1
    s_add_u32 s64, s63, 13
    s_cmp_ge_u32 s64, 14
    s_cselect_b32 s66, 14, 0
    s_sub_u32 s64, s64, s66
    s_mul_i32 s66, s64, 5120
    s_add_u32 s66, s66, s61
    s_cmp_eq_u32 s64, s62
    s_cselect_b32 s66, 0x40000000, s66
    buffer_load_dwordx4 v[148:151], v1, s[44:47], s66 offen offset:0 sc1
    buffer_load_dwordx4 v[152:155], v1, s[44:47], s66 offen offset:1024 sc1
    buffer_load_dwordx4 v[156:159], v1, s[44:47], s66 offen offset:2048 sc1
    buffer_load_dwordx4 v[160:163], v1, s[44:47], s66 offen offset:3072 sc1
    buffer_load_dwordx4 v[164:167], v2, s[44:47], s66 offen sc1
    s_waitcnt vmcnt(22) lgkmcnt(5)
    v_mfma_f32_16x16x32_bf16 v[16:19], v[184:187], v[168:171], v[16:19]
    v_mfma_f32_16x16x32_bf16 v[20:23], v[184:187], v[172:175], v[20:23]
    v_mfma_f32_16x16x32_bf16 v[24:27], v[184:187], v[176:179], v[24:27]
    v_mfma_f32_16x16x32_bf16 v[28:31], v[184:187], v[180:183], v[28:31]
    v_mfma_f32_16x16x32_bf16 v[32:35], v[188:191], v[168:171], v[32:35]
    v_mfma_f32_16x16x32_bf16 v[36:39], v[188:191], v[172:175], v[36:39]
    v_mfma_f32_16x16x32_bf16 v[40:43], v[188:191], v[176:179], v[40:43]
    v_mfma_f32_16x16x32_bf16 v[44:47], v[188:191], v[180:183], v[44:47]
    v_mfma_f32_16x16x32_bf16 v[48:51], v[192:195], v[168:171], v[48:51]
    v_mfma_f32_16x16x32_bf16 v[52:55], v[192:195], v[172:175], v[52:55]
    v_mfma_f32_16x16x32_bf16 v[56:59], v[192:195], v[176:179], v[56:59]
    v_mfma_f32_16x16x32_bf16 v[60:63], v[192:195], v[180:183], v[60:63]
    v_mfma_f32_16x16x32_bf16 v[64:67], v[196:199], v[168:171], v[64:67]
    v_mfma_f32_16x16x32_bf16 v[68:71], v[196:199], v[172:175], v[68:71]
    v_mfma_f32_16x16x32_bf16 v[72:75], v[196:199], v[176:179], v[72:75]
    v_mfma_f32_16x16x32_bf16 v[76:79], v[196:199], v[180:183], v[76:79]
    v_mfma_f32_16x16x32_bf16 v[80:83], v[200:203], v[168:171], v[80:83]
    v_mfma_f32_16x16x32_bf16 v[84:87], v[200:203], v[172:175], v[84:87]
    v_mfma_f32_16x16x32_bf16 v[88:91], v[200:203], v[176:179], v[88:91]
    v_mfma_f32_16x16x32_bf16 v[92:95], v[200:203], v[180:183], v[92:95]
    s_waitcnt lgkmcnt(0)
    s_barrier
    buffer_load_dwordx4 v[184:187], v1, s[44:47], s65 offen offset:0 sc1
    buffer_load_dwordx4 v[188:191], v1, s[44:47], s65 offen offset:1024 sc1
    buffer_load_dwordx4 v[192:195], v1, s[44:47], s65 offen offset:2048 sc1
    buffer_load_dwordx4 v[196:199], v1, s[44:47], s65 offen offset:3072 sc1
    buffer_load_dwordx4 v[200:203], v2, s[44:47], s65 offen sc1
    s_add_u32 s65, s65, 5120
    s_waitcnt vmcnt(23) lgkmcnt(0)
    v_mfma_f32_16x16x32_bf16 v[16:19], v[220:223], v[204:207], v[16:19]
    v_mfma_f32_16x16x32_bf16 v[20:23], v[220:223], v[208:211], v[20:23]
    v_mfma_f32_16x16x32_bf16 v[24:27], v[220:223], v[212:215], v[24:27]
    v_mfma_f32_16x16x32_bf16 v[28:31], v[220:223], v[216:219], v[28:31]
    v_mfma_f32_16x16x32_bf16 v[32:35], v[224:227], v[204:207], v[32:35]
    v_mfma_f32_16x16x32_bf16 v[36:39], v[224:227], v[208:211], v[36:39]
    v_mfma_f32_16x16x32_bf16 v[40:43], v[224:227], v[212:215], v[40:43]
    v_mfma_f32_16x16x32_bf16 v[44:47], v[224:227], v[216:219], v[44:47]
    v_mfma_f32_16x16x32_bf16 v[48:51], v[228:231], v[204:207], v[48:51]
    v_mfma_f32_16x16x32_bf16 v[52:55], v[228:231], v[208:211], v[52:55]
    v_mfma_f32_16x16x32_bf16 v[56:59], v[228:231], v[212:215], v[56:59]
    v_mfma_f32_16x16x32_bf16 v[60:63], v[228:231], v[216:219], v[60:63]
    v_mfma_f32_16x16x32_bf16 v[64:67], v[232:235], v[204:207], v[64:67]
    v_mfma_f32_16x16x32_bf16 v[68:71], v[232:235], v[208:211], v[68:71]
    v_mfma_f32_16x16x32_bf16 v[72:75], v[232:235], v[212:215], v[72:75]
    v_mfma_f32_16x16x32_bf16 v[76:79], v[232:235], v[216:219], v[76:79]
    v_mfma_f32_16x16x32_bf16 v[80:83], v[236:239], v[204:207], v[80:83]
    v_mfma_f32_16x16x32_bf16 v[84:87], v[236:239], v[208:211], v[84:87]
    v_mfma_f32_16x16x32_bf16 v[88:91], v[236:239], v[212:215], v[88:91]
    v_mfma_f32_16x16x32_bf16 v[92:95], v[236:239], v[216:219], v[92:95]
    buffer_load_dwordx4 v[220:223], v1, s[44:47], s65 offen offset:0 sc1
    buffer_load_dwordx4 v[224:227], v1, s[44:47], s65 offen offset:1024 sc1
    buffer_load_dwordx4 v[228:231], v1, s[44:47], s65 offen offset:2048 sc1
    buffer_load_dwordx4 v[232:235], v1, s[44:47], s65 offen offset:3072 sc1
    buffer_load_dwordx4 v[236:239], v2, s[44:47], s65 offen sc1
    s_add_u32 s65, s65, 5120
    s_waitcnt vmcnt(19)
    v_mfma_f32_16x16x32_bf16 v[16:19], v[112:115], v[96:99], v[16:19]
    v_mfma_f32_16x16x32_bf16 v[20:23], v[112:115], v[100:103], v[20:23]
    v_mfma_f32_16x16x32_bf16 v[24:27], v[112:115], v[104:107], v[24:27]
    v_mfma_f32_16x16x32_bf16 v[28:31], v[112:115], v[108:111], v[28:31]
    v_mfma_f32_16x16x32_bf16 v[32:35], v[116:119], v[96:99], v[32:35]
    v_mfma_f32_16x16x32_bf16 v[36:39], v[116:119], v[100:103], v[36:39]
    v_mfma_f32_16x16x32_bf16 v[40:43], v[116:119], v[104:107], v[40:43]
    v_mfma_f32_16x16x32_bf16 v[44:47], v[116:119], v[108:111], v[44:47]
    v_mfma_f32_16x16x32_bf16 v[48:51], v[120:123], v[96:99], v[48:51]
    v_mfma_f32_16x16x32_bf16 v[52:55], v[120:123], v[100:103], v[52:55]
    v_mfma_f32_16x16x32_bf16 v[56:59], v[120:123], v[104:107], v[56:59]
    v_mfma_f32_16x16x32_bf16 v[60:63], v[120:123], v[108:111], v[60:63]
    v_mfma_f32_16x16x32_bf16 v[64:67], v[124:127], v[96:99], v[64:67]
    v_mfma_f32_16x16x32_bf16 v[68:71], v[124:127], v[100:103], v[68:71]
    v_mfma_f32_16x16x32_bf16 v[72:75], v[124:127], v[104:107], v[72:75]
    v_mfma_f32_16x16x32_bf16 v[76:79], v[124:127], v[108:111], v[76:79]
    v_mfma_f32_16x16x32_bf16 v[80:83], v[128:131], v[96:99], v[80:83]
    v_mfma_f32_16x16x32_bf16 v[84:87], v[128:131], v[100:103], v[84:87]
    v_mfma_f32_16x16x32_bf16 v[88:91], v[128:131], v[104:107], v[88:91]
    v_mfma_f32_16x16x32_bf16 v[92:95], v[128:131], v[108:111], v[92:95]
    buffer_load_dwordx4 v[112:115], v1, s[44:47], s65 offen offset:0 sc1
    buffer_load_dwordx4 v[116:119], v1, s[44:47], s65 offen offset:1024 sc1
    buffer_load_dwordx4 v[120:123], v1, s[44:47], s65 offen offset:2048 sc1
    buffer_load_dwordx4 v[124:127], v1, s[44:47], s65 offen offset:3072 sc1
    buffer_load_dwordx4 v[128:131], v2, s[44:47], s65 offen sc1
    s_add_u32 s65, s65, 5120
    s_waitcnt vmcnt(15)
    v_mfma_f32_16x16x32_bf16 v[16:19], v[148:151], v[132:135], v[16:19]
    v_mfma_f32_16x16x32_bf16 v[20:23], v[148:151], v[136:139], v[20:23]
    v_mfma_f32_16x16x32_bf16 v[24:27], v[148:151], v[140:143], v[24:27]
    v_mfma_f32_16x16x32_bf16 v[28:31], v[148:151], v[144:147], v[28:31]
    v_mfma_f32_16x16x32_bf16 v[32:35], v[152:155], v[132:135], v[32:35]
    v_mfma_f32_16x16x32_bf16 v[36:39], v[152:155], v[136:139], v[36:39]
    v_mfma_f32_16x16x32_bf16 v[40:43], v[152:155], v[140:143], v[40:43]
    v_mfma_f32_16x16x32_bf16 v[44:47], v[152:155], v[144:147], v[44:47]
    v_mfma_f32_16x16x32_bf16 v[48:51], v[156:159], v[132:135], v[48:51]
    v_mfma_f32_16x16x32_bf16 v[52:55], v[156:159], v[136:139], v[52:55]
    v_mfma_f32_16x16x32_bf16 v[56:59], v[156:159], v[140:143], v[56:59]
    v_mfma_f32_16x16x32_bf16 v[60:63], v[156:159], v[144:147], v[60:63]
    v_mfma_f32_16x16x32_bf16 v[64:67], v[160:163], v[132:135], v[64:67]
    v_mfma_f32_16x16x32_bf16 v[68:71], v[160:163], v[136:139], v[68:71]
    v_mfma_f32_16x16x32_bf16 v[72:75], v[160:163], v[140:143], v[72:75]
    v_mfma_f32_16x16x32_bf16 v[76:79], v[160:163], v[144:147], v[76:79]
    v_mfma_f32_16x16x32_bf16 v[80:83], v[164:167], v[132:135], v[80:83]
    v_mfma_f32_16x16x32_bf16 v[84:87], v[164:167], v[136:139], v[84:87]
    v_mfma_f32_16x16x32_bf16 v[88:91], v[164:167], v[140:143], v[88:91]
    v_mfma_f32_16x16x32_bf16 v[92:95], v[164:167], v[144:147], v[92:95]
    buffer_load_dwordx4 v[148:151], v1, s[44:47], s65 offen offset:0 sc1
    buffer_load_dwordx4 v[152:155], v1, s[44:47], s65 offen offset:1024 sc1
    buffer_load_dwordx4 v[156:159], v1, s[44:47], s65 offen offset:2048 sc1
    buffer_load_dwordx4 v[160:163], v1, s[44:47], s65 offen offset:3072 sc1
    buffer_load_dwordx4 v[164:167], v2, s[44:47], s65 offen sc1
    s_add_u32 s65, s65, 5120
    s_nop 7
    v_sub_f32 v244, 1.0, v244
    v_sub_f32 v245, 1.0, v245
    v_sub_f32 v246, 1.0, v246
    v_sub_f32 v247, 1.0, v247
    v_mul_f32 v16, v16, v244
    v_mul_f32 v17, v17, v244
    v_mul_f32 v18, v18, v244
    v_mul_f32 v19, v19, v244
    v_mul_f32 v20, v20, v245
    v_mul_f32 v21, v21, v245
    v_mul_f32 v22, v22, v245
    v_mul_f32 v23, v23, v245
    v_mul_f32 v24, v24, v246
    v_mul_f32 v25, v25, v246
    v_mul_f32 v26, v26, v246
    v_mul_f32 v27, v27, v246
    v_mul_f32 v28, v28, v247
    v_mul_f32 v29, v29, v247
    v_mul_f32 v30, v30, v247
    v_mul_f32 v31, v31, v247
    v_mul_f32 v32, v32, v244
    v_mul_f32 v33, v33, v244
    v_mul_f32 v34, v34, v244
    v_mul_f32 v35, v35, v244
    v_mul_f32 v36, v36, v245
    v_mul_f32 v37, v37, v245
    v_mul_f32 v38, v38, v245
    v_mul_f32 v39, v39, v245
    v_mul_f32 v40, v40, v246
    v_mul_f32 v41, v41, v246
    v_mul_f32 v42, v42, v246
    v_mul_f32 v43, v43, v246
    v_mul_f32 v44, v44, v247
    v_mul_f32 v45, v45, v247
    v_mul_f32 v46, v46, v247
    v_mul_f32 v47, v47, v247
    v_mul_f32 v48, v48, v244
    v_mul_f32 v49, v49, v244
    v_mul_f32 v50, v50, v244
    v_mul_f32 v51, v51, v244
    v_mul_f32 v52, v52, v245
    v_mul_f32 v53, v53, v245
    v_mul_f32 v54, v54, v245
    v_mul_f32 v55, v55, v245
    v_mul_f32 v56, v56, v246
    v_mul_f32 v57, v57, v246
    v_mul_f32 v58, v58, v246
    v_mul_f32 v59, v59, v246
    v_mul_f32 v60, v60, v247
    v_mul_f32 v61, v61, v247
    v_mul_f32 v62, v62, v247
    v_mul_f32 v63, v63, v247
    v_mul_f32 v64, v64, v244
    v_mul_f32 v65, v65, v244
    v_mul_f32 v66, v66, v244
    v_mul_f32 v67, v67, v244
    v_mul_f32 v68, v68, v245
    v_mul_f32 v69, v69, v245
    v_mul_f32 v70, v70, v245
    v_mul_f32 v71, v71, v245
    v_mul_f32 v72, v72, v246
    v_mul_f32 v73, v73, v246
    v_mul_f32 v74, v74, v246
    v_mul_f32 v75, v75, v246
    v_mul_f32 v76, v76, v247
    v_mul_f32 v77, v77, v247
    v_mul_f32 v78, v78, v247
    v_mul_f32 v79, v79, v247
    v_mul_f32 v80, v80, v244
    v_mul_f32 v81, v81, v244
    v_mul_f32 v82, v82, v244
    v_mul_f32 v83, v83, v244
    v_mul_f32 v84, v84, v245
    v_mul_f32 v85, v85, v245
    v_mul_f32 v86, v86, v245
    v_mul_f32 v87, v87, v245
    v_mul_f32 v88, v88, v246
    v_mul_f32 v89, v89, v246
    v_mul_f32 v90, v90, v246
    v_mul_f32 v91, v91, v246
    v_mul_f32 v92, v92, v247
    v_mul_f32 v93, v93, v247
    v_mul_f32 v94, v94, v247
    v_mul_f32 v95, v95, v247
    s_barrier
    ds_read_b128 v[168:171], v13 offset:0
    ds_read_b128 v[172:175], v13 offset:5120
    ds_read_b128 v[176:179], v13 offset:10240
    ds_read_b128 v[180:183], v13 offset:15360
    ds_read_b128 v[204:207], v13 offset:1024
    ds_read_b128 v[208:211], v13 offset:6144
    ds_read_b128 v[212:215], v13 offset:11264
    ds_read_b128 v[216:219], v13 offset:16384
    ds_read_b128 v[96:99], v13 offset:2048
    ds_read_b128 v[100:103], v13 offset:7168
    ds_read_b128 v[104:107], v13 offset:12288
    ds_read_b128 v[108:111], v13 offset:17408
    ds_read_b128 v[132:135], v13 offset:3072
    ds_read_b128 v[136:139], v13 offset:8192
    ds_read_b128 v[140:143], v13 offset:13312
    ds_read_b128 v[144:147], v13 offset:18432
    s_waitcnt vmcnt(15) lgkmcnt(12)
    v_mfma_f32_16x16x32_bf16 v[16:19], v[184:187], v[168:171], v[16:19]
    v_mfma_f32_16x16x32_bf16 v[20:23], v[184:187], v[172:175], v[20:23]
    v_mfma_f32_16x16x32_bf16 v[24:27], v[184:187], v[176:179], v[24:27]
    v_mfma_f32_16x16x32_bf16 v[28:31], v[184:187], v[180:183], v[28:31]
    v_mfma_f32_16x16x32_bf16 v[32:35], v[188:191], v[168:171], v[32:35]
    v_mfma_f32_16x16x32_bf16 v[36:39], v[188:191], v[172:175], v[36:39]
    v_mfma_f32_16x16x32_bf16 v[40:43], v[188:191], v[176:179], v[40:43]
    v_mfma_f32_16x16x32_bf16 v[44:47], v[188:191], v[180:183], v[44:47]
    v_mfma_f32_16x16x32_bf16 v[48:51], v[192:195], v[168:171], v[48:51]
    v_mfma_f32_16x16x32_bf16 v[52:55], v[192:195], v[172:175], v[52:55]
    v_mfma_f32_16x16x32_bf16 v[56:59], v[192:195], v[176:179], v[56:59]
    v_mfma_f32_16x16x32_bf16 v[60:63], v[192:195], v[180:183], v[60:63]
    v_mfma_f32_16x16x32_bf16 v[64:67], v[196:199], v[168:171], v[64:67]
    v_mfma_f32_16x16x32_bf16 v[68:71], v[196:199], v[172:175], v[68:71]
    v_mfma_f32_16x16x32_bf16 v[72:75], v[196:199], v[176:179], v[72:75]
    v_mfma_f32_16x16x32_bf16 v[76:79], v[196:199], v[180:183], v[76:79]
    v_mfma_f32_16x16x32_bf16 v[80:83], v[200:203], v[168:171], v[80:83]
    v_mfma_f32_16x16x32_bf16 v[84:87], v[200:203], v[172:175], v[84:87]
    v_mfma_f32_16x16x32_bf16 v[88:91], v[200:203], v[176:179], v[88:91]
    v_mfma_f32_16x16x32_bf16 v[92:95], v[200:203], v[180:183], v[92:95]
    buffer_load_dwordx4 v[184:187], v1, s[44:47], s65 offen offset:0 sc1
    buffer_load_dwordx4 v[188:191], v1, s[44:47], s65 offen offset:1024 sc1
    buffer_load_dwordx4 v[192:195], v1, s[44:47], s65 offen offset:2048 sc1
    buffer_load_dwordx4 v[196:199], v1, s[44:47], s65 offen offset:3072 sc1
    buffer_load_dwordx4 v[200:203], v2, s[44:47], s65 offen sc1
    s_add_u32 s65, s65, 5120
    ds_read_b128 v[168:171], v13 offset:4096
    ds_read_b128 v[172:175], v13 offset:9216
    ds_read_b128 v[176:179], v13 offset:14336
    ds_read_b128 v[180:183], v13 offset:19456
    s_waitcnt vmcnt(15) lgkmcnt(12)
    v_mfma_f32_16x16x32_bf16 v[16:19], v[220:223], v[204:207], v[16:19]
    v_mfma_f32_16x16x32_bf16 v[20:23], v[220:223], v[208:211], v[20:23]
    v_mfma_f32_16x16x32_bf16 v[24:27], v[220:223], v[212:215], v[24:27]
    v_mfma_f32_16x16x32_bf16 v[28:31], v[220:223], v[216:219], v[28:31]
    v_mfma_f32_16x16x32_bf16 v[32:35], v[224:227], v[204:207], v[32:35]
    v_mfma_f32_16x16x32_bf16 v[36:39], v[224:227], v[208:211], v[36:39]
    v_mfma_f32_16x16x32_bf16 v[40:43], v[224:227], v[212:215], v[40:43]
    v_mfma_f32_16x16x32_bf16 v[44:47], v[224:227], v[216:219], v[44:47]
    v_mfma_f32_16x16x32_bf16 v[48:51], v[228:231], v[204:207], v[48:51]
    v_mfma_f32_16x16x32_bf16 v[52:55], v[228:231], v[208:211], v[52:55]
    v_mfma_f32_16x16x32_bf16 v[56:59], v[228:231], v[212:215], v[56:59]
    v_mfma_f32_16x16x32_bf16 v[60:63], v[228:231], v[216:219], v[60:63]
    v_mfma_f32_16x16x32_bf16 v[64:67], v[232:235], v[204:207], v[64:67]
    v_mfma_f32_16x16x32_bf16 v[68:71], v[232:235], v[208:211], v[68:71]
    v_mfma_f32_16x16x32_bf16 v[72:75], v[232:235], v[212:215], v[72:75]
    v_mfma_f32_16x16x32_bf16 v[76:79], v[232:235], v[216:219], v[76:79]
    v_mfma_f32_16x16x32_bf16 v[80:83], v[236:239], v[204:207], v[80:83]
    v_mfma_f32_16x16x32_bf16 v[84:87], v[236:239], v[208:211], v[84:87]
    v_mfma_f32_16x16x32_bf16 v[88:91], v[236:239], v[212:215], v[88:91]
    v_mfma_f32_16x16x32_bf16 v[92:95], v[236:239], v[216:219], v[92:95]
    s_waitcnt vmcnt(10) lgkmcnt(8)
    v_mfma_f32_16x16x32_bf16 v[16:19], v[112:115], v[96:99], v[16:19]
    v_mfma_f32_16x16x32_bf16 v[20:23], v[112:115], v[100:103], v[20:23]
    v_mfma_f32_16x16x32_bf16 v[24:27], v[112:115], v[104:107], v[24:27]
    v_mfma_f32_16x16x32_bf16 v[28:31], v[112:115], v[108:111], v[28:31]
    v_mfma_f32_16x16x32_bf16 v[32:35], v[116:119], v[96:99], v[32:35]
    v_mfma_f32_16x16x32_bf16 v[36:39], v[116:119], v[100:103], v[36:39]
    v_mfma_f32_16x16x32_bf16 v[40:43], v[116:119], v[104:107], v[40:43]
    v_mfma_f32_16x16x32_bf16 v[44:47], v[116:119], v[108:111], v[44:47]
    v_mfma_f32_16x16x32_bf16 v[48:51], v[120:123], v[96:99], v[48:51]
    v_mfma_f32_16x16x32_bf16 v[52:55], v[120:123], v[100:103], v[52:55]
    v_mfma_f32_16x16x32_bf16 v[56:59], v[120:123], v[104:107], v[56:59]
    v_mfma_f32_16x16x32_bf16 v[60:63], v[120:123], v[108:111], v[60:63]
    v_mfma_f32_16x16x32_bf16 v[64:67], v[124:127], v[96:99], v[64:67]
    v_mfma_f32_16x16x32_bf16 v[68:71], v[124:127], v[100:103], v[68:71]
    v_mfma_f32_16x16x32_bf16 v[72:75], v[124:127], v[104:107], v[72:75]
    v_mfma_f32_16x16x32_bf16 v[76:79], v[124:127], v[108:111], v[76:79]
    v_mfma_f32_16x16x32_bf16 v[80:83], v[128:131], v[96:99], v[80:83]
    v_mfma_f32_16x16x32_bf16 v[84:87], v[128:131], v[100:103], v[84:87]
    v_mfma_f32_16x16x32_bf16 v[88:91], v[128:131], v[104:107], v[88:91]
    v_mfma_f32_16x16x32_bf16 v[92:95], v[128:131], v[108:111], v[92:95]
    s_waitcnt vmcnt(5) lgkmcnt(4)
    v_mfma_f32_16x16x32_bf16 v[16:19], v[148:151], v[132:135], v[16:19]
    v_mfma_f32_16x16x32_bf16 v[20:23], v[148:151], v[136:139], v[20:23]
    v_mfma_f32_16x16x32_bf16 v[24:27], v[148:151], v[140:143], v[24:27]
    v_mfma_f32_16x16x32_bf16 v[28:31], v[148:151], v[144:147], v[28:31]
    v_mfma_f32_16x16x32_bf16 v[32:35], v[152:155], v[132:135], v[32:35]
    v_mfma_f32_16x16x32_bf16 v[36:39], v[152:155], v[136:139], v[36:39]
    v_mfma_f32_16x16x32_bf16 v[40:43], v[152:155], v[140:143], v[40:43]
    v_mfma_f32_16x16x32_bf16 v[44:47], v[152:155], v[144:147], v[44:47]
    v_mfma_f32_16x16x32_bf16 v[48:51], v[156:159], v[132:135], v[48:51]
    v_mfma_f32_16x16x32_bf16 v[52:55], v[156:159], v[136:139], v[52:55]
    v_mfma_f32_16x16x32_bf16 v[56:59], v[156:159], v[140:143], v[56:59]
    v_mfma_f32_16x16x32_bf16 v[60:63], v[156:159], v[144:147], v[60:63]
    v_mfma_f32_16x16x32_bf16 v[64:67], v[160:163], v[132:135], v[64:67]
    v_mfma_f32_16x16x32_bf16 v[68:71], v[160:163], v[136:139], v[68:71]
    v_mfma_f32_16x16x32_bf16 v[72:75], v[160:163], v[140:143], v[72:75]
    v_mfma_f32_16x16x32_bf16 v[76:79], v[160:163], v[144:147], v[76:79]
    v_mfma_f32_16x16x32_bf16 v[80:83], v[164:167], v[132:135], v[80:83]
    v_mfma_f32_16x16x32_bf16 v[84:87], v[164:167], v[136:139], v[84:87]
    v_mfma_f32_16x16x32_bf16 v[88:91], v[164:167], v[140:143], v[88:91]
    v_mfma_f32_16x16x32_bf16 v[92:95], v[164:167], v[144:147], v[92:95]
    s_waitcnt vmcnt(0) lgkmcnt(0)
    v_mfma_f32_16x16x32_bf16 v[16:19], v[184:187], v[168:171], v[16:19]
    v_mfma_f32_16x16x32_bf16 v[20:23], v[184:187], v[172:175], v[20:23]
    v_mfma_f32_16x16x32_bf16 v[24:27], v[184:187], v[176:179], v[24:27]
    v_mfma_f32_16x16x32_bf16 v[28:31], v[184:187], v[180:183], v[28:31]
    v_mfma_f32_16x16x32_bf16 v[32:35], v[188:191], v[168:171], v[32:35]
    v_mfma_f32_16x16x32_bf16 v[36:39], v[188:191], v[172:175], v[36:39]
    v_mfma_f32_16x16x32_bf16 v[40:43], v[188:191], v[176:179], v[40:43]
    v_mfma_f32_16x16x32_bf16 v[44:47], v[188:191], v[180:183], v[44:47]
    v_mfma_f32_16x16x32_bf16 v[48:51], v[192:195], v[168:171], v[48:51]
    v_mfma_f32_16x16x32_bf16 v[52:55], v[192:195], v[172:175], v[52:55]
    v_mfma_f32_16x16x32_bf16 v[56:59], v[192:195], v[176:179], v[56:59]
    v_mfma_f32_16x16x32_bf16 v[60:63], v[192:195], v[180:183], v[60:63]
    v_mfma_f32_16x16x32_bf16 v[64:67], v[196:199], v[168:171], v[64:67]
    v_mfma_f32_16x16x32_bf16 v[68:71], v[196:199], v[172:175], v[68:71]
    v_mfma_f32_16x16x32_bf16 v[72:75], v[196:199], v[176:179], v[72:75]
    v_mfma_f32_16x16x32_bf16 v[76:79], v[196:199], v[180:183], v[76:79]
    v_mfma_f32_16x16x32_bf16 v[80:83], v[200:203], v[168:171], v[80:83]
    v_mfma_f32_16x16x32_bf16 v[84:87], v[200:203], v[172:175], v[84:87]
    v_mfma_f32_16x16x32_bf16 v[88:91], v[200:203], v[176:179], v[88:91]
    v_mfma_f32_16x16x32_bf16 v[92:95], v[200:203], v[180:183], v[92:95]
    s_nop 7
    s_mul_i32 s9, s3, 20480
    s_add_u32 s9, s9, 81920
    v_add_u32 v3, s9, v1
    s_cmp_eq_u32 s3, 0
    s_cbranch_scc1 L_red_skip0
    ds_write_b128 v3, v[16:19] offset:0
    ds_write_b128 v3, v[32:35] offset:1024
    ds_write_b128 v3, v[48:51] offset:2048
    ds_write_b128 v3, v[64:67] offset:3072
    ds_write_b128 v3, v[80:83] offset:4096
    s_branch L_red_next0
L_red_skip0:
    v_mov_b32 v220, v16
    v_mov_b32 v221, v17
    v_mov_b32 v222, v18
    v_mov_b32 v223, v19
    v_mov_b32 v224, v32
    v_mov_b32 v225, v33
    v_mov_b32 v226, v34
    v_mov_b32 v227, v35
    v_mov_b32 v228, v48
    v_mov_b32 v229, v49
    v_mov_b32 v230, v50
    v_mov_b32 v231, v51
    v_mov_b32 v232, v64
    v_mov_b32 v233, v65
    v_mov_b32 v234, v66
    v_mov_b32 v235, v67
    v_mov_b32 v236, v80
    v_mov_b32 v237, v81
    v_mov_b32 v238, v82
    v_mov_b32 v239, v83
L_red_next0:
    s_cmp_eq_u32 s3, 1
    s_cbranch_scc1 L_red_skip1
    ds_write_b128 v3, v[20:23] offset:5120
    ds_write_b128 v3, v[36:39] offset:6144
    ds_write_b128 v3, v[52:55] offset:7168
    ds_write_b128 v3, v[68:71] offset:8192
    ds_write_b128 v3, v[84:87] offset:9216
    s_branch L_red_next1
L_red_skip1:
    v_mov_b32 v220, v20
    v_mov_b32 v221, v21
    v_mov_b32 v222, v22
    v_mov_b32 v223, v23
    v_mov_b32 v224, v36
    v_mov_b32 v225, v37
    v_mov_b32 v226, v38
    v_mov_b32 v227, v39
    v_mov_b32 v228, v52
    v_mov_b32 v229, v53
    v_mov_b32 v230, v54
    v_mov_b32 v231, v55
    v_mov_b32 v232, v68
    v_mov_b32 v233, v69
    v_mov_b32 v234, v70
    v_mov_b32 v235, v71
    v_mov_b32 v236, v84
    v_mov_b32 v237, v85
    v_mov_b32 v238, v86
    v_mov_b32 v239, v87
L_red_next1:
    s_cmp_eq_u32 s3, 2
    s_cbranch_scc1 L_red_skip2
    ds_write_b128 v3, v[24:27] offset:10240
    ds_write_b128 v3, v[40:43] offset:11264
    ds_write_b128 v3, v[56:59] offset:12288
    ds_write_b128 v3, v[72:75] offset:13312
    ds_write_b128 v3, v[88:91] offset:14336
    s_branch L_red_next2
L_red_skip2:
    v_mov_b32 v220, v24
    v_mov_b32 v221, v25
    v_mov_b32 v222, v26
    v_mov_b32 v223, v27
    v_mov_b32 v224, v40
    v_mov_b32 v225, v41
    v_mov_b32 v226, v42
    v_mov_b32 v227, v43
    v_mov_b32 v228, v56
    v_mov_b32 v229, v57
    v_mov_b32 v230, v58
    v_mov_b32 v231, v59
    v_mov_b32 v232, v72
    v_mov_b32 v233, v73
    v_mov_b32 v234, v74
    v_mov_b32 v235, v75
    v_mov_b32 v236, v88
    v_mov_b32 v237, v89
    v_mov_b32 v238, v90
    v_mov_b32 v239, v91
L_red_next2:
    s_cmp_eq_u32 s3, 3
    s_cbranch_scc1 L_red_skip3
    ds_write_b128 v3, v[28:31] offset:15360
    ds_write_b128 v3, v[44:47] offset:16384
    ds_write_b128 v3, v[60:63] offset:17408
    ds_write_b128 v3, v[76:79] offset:18432
    ds_write_b128 v3, v[92:95] offset:19456
    s_branch L_red_next3
L_red_skip3:
    v_mov_b32 v220, v28
    v_mov_b32 v221, v29
    v_mov_b32 v222, v30
    v_mov_b32 v223, v31
    v_mov_b32 v224, v44
    v_mov_b32 v225, v45
    v_mov_b32 v226, v46
    v_mov_b32 v227, v47
    v_mov_b32 v228, v60
    v_mov_b32 v229, v61
    v_mov_b32 v230, v62
    v_mov_b32 v231, v63
    v_mov_b32 v232, v76
    v_mov_b32 v233, v77
    v_mov_b32 v234, v78
    v_mov_b32 v235, v79
    v_mov_b32 v236, v92
    v_mov_b32 v237, v93
    v_mov_b32 v238, v94
    v_mov_b32 v239, v95
L_red_next3:
    s_waitcnt lgkmcnt(0)
    s_barrier
    s_add_u32 s9, s3, 1
    s_and_b32 s9, s9, 3
    s_mul_i32 s9, s9, 20480
    s_mul_i32 s10, s3, 5120
    s_add_u32 s9, s9, s10
    s_add_u32 s9, s9, 81920
    v_add_u32 v3, s9, v1
    ds_read_b128 v[116:119], v3 offset:0
    ds_read_b128 v[120:123], v3 offset:1024
    ds_read_b128 v[124:127], v3 offset:2048
    ds_read_b128 v[128:131], v3 offset:3072
    ds_read_b128 v[132:135], v3 offset:4096
    s_add_u32 s9, s3, 2
    s_and_b32 s9, s9, 3
    s_mul_i32 s9, s9, 20480
    s_mul_i32 s10, s3, 5120
    s_add_u32 s9, s9, s10
    s_add_u32 s9, s9, 81920
    v_add_u32 v3, s9, v1
    ds_read_b128 v[136:139], v3 offset:0
    ds_read_b128 v[140:143], v3 offset:1024
    ds_read_b128 v[144:147], v3 offset:2048
    ds_read_b128 v[148:151], v3 offset:3072
    ds_read_b128 v[152:155], v3 offset:4096
    s_add_u32 s9, s3, 3
    s_and_b32 s9, s9, 3
    s_mul_i32 s9, s9, 20480
    s_mul_i32 s10, s3, 5120
    s_add_u32 s9, s9, s10
    s_add_u32 s9, s9, 81920
    v_add_u32 v3, s9, v1
    ds_read_b128 v[156:159], v3 offset:0
    ds_read_b128 v[160:163], v3 offset:1024
    ds_read_b128 v[164:167], v3 offset:2048
    ds_read_b128 v[168:171], v3 offset:3072
    ds_read_b128 v[172:175], v3 offset:4096
    v_and_b32 v5, 15, v0
    v_mul_u32_u24 v5, 0x500, v5
    v_lshrrev_b32 v6, 4, v0
    v_lshl_add_u32 v5, v6, 3, v5
    s_lshl_b32 s9, s88, 2
    s_add_u32 s9, s9, s3
    s_mul_i32 s9, s9, 20480
    s_mul_i32 s10, s89, 160
    s_add_u32 s9, s9, s10
    s_waitcnt lgkmcnt(0)
    v_pk_add_f32 v[220:221], v[220:221], v[116:117]
    v_pk_add_f32 v[222:223], v[222:223], v[118:119]
    v_pk_add_f32 v[220:221], v[220:221], v[136:137]
    v_pk_add_f32 v[222:223], v[222:223], v[138:139]
    v_pk_add_f32 v[220:221], v[220:221], v[156:157]
    v_pk_add_f32 v[222:223], v[222:223], v[158:159]
    v_cvt_pk_bf16_f32 v220, v220, v221
    v_cvt_pk_bf16_f32 v221, v222, v223
    buffer_store_dwordx2 v[220:221], v5, s[56:59], s9 offen offset:0
    v_pk_add_f32 v[224:225], v[224:225], v[120:121]
    v_pk_add_f32 v[226:227], v[226:227], v[122:123]
    v_pk_add_f32 v[224:225], v[224:225], v[140:141]
    v_pk_add_f32 v[226:227], v[226:227], v[142:143]
    v_pk_add_f32 v[224:225], v[224:225], v[160:161]
    v_pk_add_f32 v[226:227], v[226:227], v[162:163]
    v_cvt_pk_bf16_f32 v224, v224, v225
    v_cvt_pk_bf16_f32 v225, v226, v227
    buffer_store_dwordx2 v[224:225], v5, s[56:59], s9 offen offset:32
    v_pk_add_f32 v[228:229], v[228:229], v[124:125]
    v_pk_add_f32 v[230:231], v[230:231], v[126:127]
    v_pk_add_f32 v[228:229], v[228:229], v[144:145]
    v_pk_add_f32 v[230:231], v[230:231], v[146:147]
    v_pk_add_f32 v[228:229], v[228:229], v[164:165]
    v_pk_add_f32 v[230:231], v[230:231], v[166:167]
    v_cvt_pk_bf16_f32 v228, v228, v229
    v_cvt_pk_bf16_f32 v229, v230, v231
    buffer_store_dwordx2 v[228:229], v5, s[56:59], s9 offen offset:64
    v_pk_add_f32 v[232:233], v[232:233], v[128:129]
    v_pk_add_f32 v[234:235], v[234:235], v[130:131]
    v_pk_add_f32 v[232:233], v[232:233], v[148:149]
    v_pk_add_f32 v[234:235], v[234:235], v[150:151]
    v_pk_add_f32 v[232:233], v[232:233], v[168:169]
    v_pk_add_f32 v[234:235], v[234:235], v[170:171]
    v_cvt_pk_bf16_f32 v232, v232, v233
    v_cvt_pk_bf16_f32 v233, v234, v235
    buffer_store_dwordx2 v[232:233], v5, s[56:59], s9 offen offset:96
    v_pk_add_f32 v[236:237], v[236:237], v[132:133]
    v_pk_add_f32 v[238:239], v[238:239], v[134:135]
    v_pk_add_f32 v[236:237], v[236:237], v[152:153]
    v_pk_add_f32 v[238:239], v[238:239], v[154:155]
    v_pk_add_f32 v[236:237], v[236:237], v[172:173]
    v_pk_add_f32 v[238:239], v[238:239], v[174:175]
    v_cvt_pk_bf16_f32 v236, v236, v237
    v_cvt_pk_bf16_f32 v237, v238, v239
    buffer_store_dwordx2 v[236:237], v5, s[56:59], s9 offen offset:128
    s_endpgm
L_p2_loader_entry:
    s_lshl_b32 s5, s52, 3
    s_add_u32 s5, s5, s53
    s_mul_i32 s5, s5, 3
    s_add_u32 s5, s5, s4
    s_sub_u32 s93, s5, 1
    s_cmp_eq_u32 s4, 0
    s_cselect_b32 s93, 999, s93
    s_cmp_lg_u32 s54, 0
    s_cselect_b32 s93, 999, s93
    s_cmp_ge_u32 s93, 160
    s_cbranch_scc1 L_mpre_done
    s_lshr_b32 s5, s93, 3
    s_and_b32 s6, s93, 7
    v_lshrrev_b32 v5, 4, v0
    v_and_b32 v6, 15, v0
    s_lshl_b32 s7, s5, 1
    s_add_u32 s8, s7, 4294967295
    s_add_u32 s9, s7, 0
    s_mul_hi_u32 s10, s8, 0x33333334
    s_mul_hi_u32 s11, s9, 0x33333334
    s_mul_i32 s12, s11, 5
    s_sub_u32 s13, s8, s12
    s_sub_u32 s14, s9, s12
    s_lshl_b32 s15, s13, 1
    s_add_u32 s15, s15, s14
    s_mul_i32 s12, s11, 13
    s_add_u32 s15, s15, s12
    s_lshl_b32 s15, s15, 10
    s_cmp_eq_u32 s10, s11
    s_cselect_b32 s74, s15, 0x40000000
    s_lshl_b32 s13, s13, 2
    v_add_u32 v7, s13, v5
    v_and_b32 v7, 63, v7
    v_mul_u32_u24 v7, 13, v7
    v_lshrrev_b32 v7, 6, v7
    s_lshl_b32 s14, s14, 4
    v_add_u32 v8, s14, v6
    v_mul_u32_u24 v8, 205, v8
    v_lshrrev_b32 v8, 12, v8
    v_cmp_eq_u32 s[16:17], v7, v8
    s_add_u32 s8, s7, 0
    s_add_u32 s9, s7, 0
    s_mul_hi_u32 s10, s8, 0x33333334
    s_mul_hi_u32 s11, s9, 0x33333334
    s_mul_i32 s12, s11, 5
    s_sub_u32 s13, s8, s12
    s_sub_u32 s14, s9, s12
    s_lshl_b32 s15, s13, 1
    s_add_u32 s15, s15, s14
    s_mul_i32 s12, s11, 13
    s_add_u32 s15, s15, s12
    s_lshl_b32 s15, s15, 10
    s_cmp_eq_u32 s10, s11
    s_cselect_b32 s75, s15, 0x40000000
    s_lshl_b32 s13, s13, 2
    v_add_u32 v7, s13, v5
    v_and_b32 v7, 63, v7
    v_mul_u32_u24 v7, 13, v7
    v_lshrrev_b32 v7, 6, v7
    s_lshl_b32 s14, s14, 4
    v_add_u32 v8, s14, v6
    v_mul_u32_u24 v8, 205, v8
    v_lshrrev_b32 v8, 12, v8
    v_cmp_eq_u32 s[18:19], v7, v8
    s_add_u32 s8, s7, 1
    s_add_u32 s9, s7, 0
    s_mul_hi_u32 s10, s8, 0x33333334
    s_mul_hi_u32 s11, s9, 0x33333334
    s_mul_i32 s12, s11, 5
    s_sub_u32 s13, s8, s12
    s_sub_u32 s14, s9, s12
    s_lshl_b32 s15, s13, 1
    s_add_u32 s15, s15, s14
    s_mul_i32 s12, s11, 13
    s_add_u32 s15, s15, s12
    s_lshl_b32 s15, s15, 10
    s_cmp_eq_u32 s10, s11
    s_cselect_b32 s76, s15, 0x40000000
    s_lshl_b32 s13, s13, 2
    v_add_u32 v7, s13, v5
    v_and_b32 v7, 63, v7
    v_mul_u32_u24 v7, 13, v7
    v_lshrrev_b32 v7, 6, v7
    s_lshl_b32 s14, s14, 4
    v_add_u32 v8, s14, v6
    v_mul_u32_u24 v8, 205, v8
    v_lshrrev_b32 v8, 12, v8
    v_cmp_eq_u32 s[20:21], v7, v8
    s_add_u32 s8, s7, 0
    s_add_u32 s9, s7, 1
    s_mul_hi_u32 s10, s8, 0x33333334
    s_mul_hi_u32 s11, s9, 0x33333334
    s_mul_i32 s12, s11, 5
    s_sub_u32 s13, s8, s12
    s_sub_u32 s14, s9, s12
    s_lshl_b32 s15, s13, 1
    s_add_u32 s15, s15, s14
    s_mul_i32 s12, s11, 13
    s_add_u32 s15, s15, s12
    s_lshl_b32 s15, s15, 10
    s_cmp_eq_u32 s10, s11
    s_cselect_b32 s77, s15, 0x40000000
    s_lshl_b32 s13, s13, 2
    v_add_u32 v7, s13, v5
    v_and_b32 v7, 63, v7
    v_mul_u32_u24 v7, 13, v7
    v_lshrrev_b32 v7, 6, v7
    s_lshl_b32 s14, s14, 4
    v_add_u32 v8, s14, v6
    v_mul_u32_u24 v8, 205, v8
    v_lshrrev_b32 v8, 12, v8
    v_cmp_eq_u32 s[22:23], v7, v8
    s_add_u32 s8, s7, 1
    s_add_u32 s9, s7, 1
    s_mul_hi_u32 s10, s8, 0x33333334
    s_mul_hi_u32 s11, s9, 0x33333334
    s_mul_i32 s12, s11, 5
    s_sub_u32 s13, s8, s12
    s_sub_u32 s14, s9, s12
    s_lshl_b32 s15, s13, 1
    s_add_u32 s15, s15, s14
    s_mul_i32 s12, s11, 13
    s_add_u32 s15, s15, s12
    s_lshl_b32 s15, s15, 10
    s_cmp_eq_u32 s10, s11
    s_cselect_b32 s78, s15, 0x40000000
    s_lshl_b32 s13, s13, 2
    v_add_u32 v7, s13, v5
    v_and_b32 v7, 63, v7
    v_mul_u32_u24 v7, 13, v7
    v_lshrrev_b32 v7, 6, v7
    s_lshl_b32 s14, s14, 4
    v_add_u32 v8, s14, v6
    v_mul_u32_u24 v8, 205, v8
    v_lshrrev_b32 v8, 12, v8
    v_cmp_eq_u32 s[24:25], v7, v8
    s_add_u32 s8, s7, 2
    s_add_u32 s9, s7, 1
    s_mul_hi_u32 s10, s8, 0x33333334
    s_mul_hi_u32 s11, s9, 0x33333334
    s_mul_i32 s12, s11, 5
    s_sub_u32 s13, s8, s12
    s_sub_u32 s14, s9, s12
    s_lshl_b32 s15, s13, 1
    s_add_u32 s15, s15, s14
    s_mul_i32 s12, s11, 13
    s_add_u32 s15, s15, s12
    s_lshl_b32 s15, s15, 10
    s_cmp_eq_u32 s10, s11
    s_cselect_b32 s79, s15, 0x40000000
    s_lshl_b32 s13, s13, 2
    v_add_u32 v7, s13, v5
    v_and_b32 v7, 63, v7
    v_mul_u32_u24 v7, 13, v7
    v_lshrrev_b32 v7, 6, v7
    s_lshl_b32 s14, s14, 4
    v_add_u32 v8, s14, v6
    v_mul_u32_u24 v8, 205, v8
    v_lshrrev_b32 v8, 12, v8
    v_cmp_eq_u32 s[26:27], v7, v8
    s_add_u32 s8, s5, 4294967295
    s_mul_i32 s9, s6, 20
    s_add_u32 s9, s9, s8
    s_mul_i32 s9, s9, 5120
    s_cmp_lt_u32 s8, 20
    s_cselect_b32 s70, s9, 0x40000000
    s_add_u32 s8, s5, 0
    s_mul_i32 s9, s6, 20
    s_add_u32 s9, s9, s8
    s_mul_i32 s9, s9, 5120
    s_cmp_lt_u32 s8, 20
    s_cselect_b32 s71, s9, 0x40000000
    s_add_u32 s8, s5, 1
    s_mul_i32 s9, s6, 20
    s_add_u32 s9, s9, s8
    s_mul_i32 s9, s9, 5120
    s_cmp_lt_u32 s8, 20
    s_cselect_b32 s72, s9, 0x40000000
    s_mul_i32 s9, s6, 74
    s_add_u32 s9, s9, s5
    s_add_u32 s9, s9, 54
    s_mul_i32 s73, s9, 5120
L_mpre_done:
    s_lshl_b32 s7, s90, 7
    s_add_u32 s7, s7, 4096
    v_lshlrev_b32 v13, 2, v0
    buffer_load_dword v14, v13, s[84:87], s7 offen sc1
    s_cmp_lg_u32 s54, 0
    s_cbranch_scc1 L_p2_h1
    s_barrier
L_p2_h1:
    s_waitcnt vmcnt(0)
    s_mul_i32 s65, s4, 20480
    s_add_u32 s65, s65, 81920
    v_add_u32 v3, s65, v1
    ds_write_b128 v3, v[16:19] offset:0
    ds_write_b128 v3, v[20:23] offset:1024
    ds_write_b128 v3, v[24:27] offset:2048
    ds_write_b128 v3, v[28:31] offset:3072
    ds_write_b128 v3, v[32:35] offset:4096
    ds_write_b128 v3, v[36:39] offset:5120
    ds_write_b128 v3, v[40:43] offset:6144
    ds_write_b128 v3, v[44:47] offset:7168
    ds_write_b128 v3, v[48:51] offset:8192
    ds_write_b128 v3, v[52:55] offset:9216
    ds_write_b128 v3, v[56:59] offset:10240
    ds_write_b128 v3, v[60:63] offset:11264
    ds_write_b128 v3, v[64:67] offset:12288
    ds_write_b128 v3, v[68:71] offset:13312
    ds_write_b128 v3, v[72:75] offset:14336
    ds_write_b128 v3, v[76:79] offset:15360
    ds_write_b128 v3, v[80:83] offset:16384
    ds_write_b128 v3, v[84:87] offset:17408
    ds_write_b128 v3, v[88:91] offset:18432
    ds_write_b128 v3, v[92:95] offset:19456
    s_waitcnt lgkmcnt(0)
    s_barrier
    s_mul_i32 s65, s4, 20480
    s_add_u32 s65, s65, 0
    v_add_u32 v3, s65, v1
    ds_write_b128 v3, v[96:99] offset:0
    ds_write_b128 v3, v[100:103] offset:1024
    ds_write_b128 v3, v[104:107] offset:2048
    ds_write_b128 v3, v[108:111] offset:3072
    ds_write_b128 v3, v[112:115] offset:4096
    ds_write_b128 v3, v[116:119] offset:5120
    ds_write_b128 v3, v[120:123] offset:6144
    ds_write_b128 v3, v[124:127] offset:7168
    ds_write_b128 v3, v[128:131] offset:8192
    ds_write_b128 v3, v[132:135] offset:9216
    ds_write_b128 v3, v[136:139] offset:10240
    ds_write_b128 v3, v[140:143] offset:11264
    ds_write_b128 v3, v[144:147] offset:12288
    ds_write_b128 v3, v[148:151] offset:13312
    ds_write_b128 v3, v[152:155] offset:14336
    ds_write_b128 v3, v[156:159] offset:15360
    ds_write_b128 v3, v[160:163] offset:16384
    ds_write_b128 v3, v[164:167] offset:17408
    ds_write_b128 v3, v[168:171] offset:18432
    ds_write_b128 v3, v[172:175] offset:19456
    s_waitcnt lgkmcnt(0)
    s_barrier
    s_mul_i32 s65, s4, 20480
    s_add_u32 s65, s65, 81920
    v_add_u32 v3, s65, v1
    ds_write_b128 v3, v[176:179] offset:0
    ds_write_b128 v3, v[180:183] offset:1024
    ds_write_b128 v3, v[184:187] offset:2048
    ds_write_b128 v3, v[188:191] offset:3072
    ds_write_b128 v3, v[192:195] offset:4096
    ds_write_b128 v3, v[196:199] offset:5120
    ds_write_b128 v3, v[200:203] offset:6144
    ds_write_b128 v3, v[204:207] offset:7168
    ds_write_b128 v3, v[208:211] offset:8192
    ds_write_b128 v3, v[212:215] offset:9216
    ds_write_b128 v3, v[216:219] offset:10240
    ds_write_b128 v3, v[220:223] offset:11264
    ds_write_b128 v3, v[224:227] offset:12288
    ds_write_b128 v3, v[228:231] offset:13312
    ds_write_b128 v3, v[232:235] offset:14336
    ds_write_b128 v3, v[236:239] offset:15360
    ds_write_b128 v3, v[240:243] offset:16384
    ds_write_b128 v3, v[244:247] offset:17408
    ds_write_b128 v3, v[248:251] offset:18432
    ds_write_b128 v3, v[252:255] offset:19456
    s_waitcnt lgkmcnt(0)
    s_cmp_ge_u32 s93, 160
    s_cbranch_scc1 L_mld_done
    v_cmp_ne_u32 vcc, s92, v14
    s_nop 1
    s_and_b32 vcc_lo, vcc_lo, 0xffff
    s_cbranch_scc0 L_mld_pk2
    s_lshl_b32 s7, s90, 7
    s_add_u32 s7, s7, 4096
    v_lshlrev_b32 v13, 2, v0
    s_mov_b64 s[94:95], 0xffff
L_mpk2_poll:
    buffer_load_dword v14, v13, s[84:87], s7 offen sc1
    s_waitcnt vmcnt(0)
    v_cmp_ne_u32 vcc, s92, v14
    s_nop 1
    s_and_b64 vcc, vcc, s[94:95]
    s_cbranch_scc0 L_mpk2_ok
    s_sleep 8
    s_branch L_mpk2_poll
L_mpk2_ok:
L_mld_pk2:
    s_add_u32 s56, s36, 0xd00000
    s_addc_u32 s57, s37, 0
    s_mov_b32 s58, 0xc8000
    s_mov_b32 s59, 0x20000
    v_add_u32 v2, 0x1000, v1
    buffer_load_dwordx4 v[16:19], v1, s[56:59], s70 offen offset:0 sc1
    buffer_load_dwordx4 v[20:23], v1, s[56:59], s70 offen offset:1024 sc1
    buffer_load_dwordx4 v[24:27], v1, s[56:59], s70 offen offset:2048 sc1
    buffer_load_dwordx4 v[28:31], v1, s[56:59], s70 offen offset:3072 sc1
    buffer_load_dwordx4 v[32:35], v2, s[56:59], s70 offen sc1
    buffer_load_dwordx4 v[36:39], v1, s[56:59], s71 offen offset:0 sc1
    buffer_load_dwordx4 v[40:43], v1, s[56:59], s71 offen offset:1024 sc1
    buffer_load_dwordx4 v[44:47], v1, s[56:59], s71 offen offset:2048 sc1
    buffer_load_dwordx4 v[48:51], v1, s[56:59], s71 offen offset:3072 sc1
    buffer_load_dwordx4 v[52:55], v2, s[56:59], s71 offen sc1
    buffer_load_dwordx4 v[56:59], v1, s[56:59], s72 offen offset:0 sc1
    buffer_load_dwordx4 v[60:63], v1, s[56:59], s72 offen offset:1024 sc1
    buffer_load_dwordx4 v[64:67], v1, s[56:59], s72 offen offset:2048 sc1
    buffer_load_dwordx4 v[68:71], v1, s[56:59], s72 offen offset:3072 sc1
    buffer_load_dwordx4 v[72:75], v2, s[56:59], s72 offen sc1
    v_mov_b32 v100, 0
    v_mov_b32 v101, 0
    v_mov_b32 v114, 0
    v_mov_b32 v115, 0
    s_add_u32 s56, s36, 0xe00000
    s_addc_u32 s57, s37, 0
    s_mov_b32 s58, 0x1b000
    s_mov_b32 s59, 0x20000
    s_lshl_b32 s7, s90, 8
    s_add_u32 s7, s7, 1024
    v_lshlrev_b32 v13, 2, v0
    s_mov_b64 s[94:95], -1
L_mkv_poll:
    buffer_load_dword v14, v13, s[84:87], s7 offen sc1
    s_waitcnt vmcnt(0)
    v_cmp_ne_u32 vcc, s92, v14
    s_nop 1
    s_and_b64 vcc, vcc, s[94:95]
    s_cbranch_scc0 L_mkv_ok
    s_sleep 4
    s_branch L_mkv_poll
L_mkv_ok:
    v_lshlrev_b32 v13, 2, v0
    buffer_load_dword v76, v13, s[56:59], s74 offen offset:0 sc1
    buffer_load_dword v77, v13, s[56:59], s74 offen offset:256 sc1
    buffer_load_dword v78, v13, s[56:59], s74 offen offset:512 sc1
    buffer_load_dword v79, v13, s[56:59], s74 offen offset:768 sc1
    buffer_load_dword v80, v13, s[56:59], s75 offen offset:0 sc1
    buffer_load_dword v81, v13, s[56:59], s75 offen offset:256 sc1
    buffer_load_dword v82, v13, s[56:59], s75 offen offset:512 sc1
    buffer_load_dword v83, v13, s[56:59], s75 offen offset:768 sc1
    buffer_load_dword v84, v13, s[56:59], s76 offen offset:0 sc1
    buffer_load_dword v85, v13, s[56:59], s76 offen offset:256 sc1
    buffer_load_dword v86, v13, s[56:59], s76 offen offset:512 sc1
    buffer_load_dword v87, v13, s[56:59], s76 offen offset:768 sc1
    buffer_load_dword v88, v13, s[56:59], s77 offen offset:0 sc1
    buffer_load_dword v89, v13, s[56:59], s77 offen offset:256 sc1
    buffer_load_dword v90, v13, s[56:59], s77 offen offset:512 sc1
    buffer_load_dword v91, v13, s[56:59], s77 offen offset:768 sc1
    buffer_load_dword v92, v13, s[56:59], s78 offen offset:0 sc1
    buffer_load_dword v93, v13, s[56:59], s78 offen offset:256 sc1
    buffer_load_dword v94, v13, s[56:59], s78 offen offset:512 sc1
    buffer_load_dword v95, v13, s[56:59], s78 offen offset:768 sc1
    buffer_load_dword v96, v13, s[56:59], s79 offen offset:0 sc1
    buffer_load_dword v97, v13, s[56:59], s79 offen offset:256 sc1
    buffer_load_dword v98, v13, s[56:59], s79 offen offset:512 sc1
    buffer_load_dword v99, v13, s[56:59], s79 offen offset:768 sc1
L_mld_done:
    s_branch L_p2_h2a
L_p2_helper_spare:
    s_sub_u32 s4, s3, 4
    s_mov_b32 s93, 999
    s_mul_i32 s8, s4, 14
    s_cmp_eq_u32 s4, 3
    s_cselect_b32 s9, 1, 0
    s_sub_u32 s8, s8, s9
    s_cmp_ge_u32 s4, 2
    s_cselect_b32 s62, 13, 14
    s_lshl_b32 s60, s88, 2
    s_mul_i32 s60, s60, 75
    s_add_u32 s60, s60, s8
    s_lshl_b32 s60, s60, 10
    s_mul_i32 s61, s89, 74
    s_add_u32 s61, s61, s8
    s_mul_i32 s61, s61, 5120
    s_mul_i32 s63, s89, 7
    s_lshr_b32 s63, s63, 2
    s_and_b32 s9, s88, 3
    s_mul_i32 s9, s9, 7
    s_lshr_b32 s9, s9, 1
    s_add_u32 s63, s63, s9
    s_cmp_ge_u32 s63, 14
    s_cselect_b32 s9, 14, 0
    s_sub_u32 s63, s63, s9
    s_add_u32 s44, s36, 0xa00400
    s_addc_u32 s45, s37, 0
    s_mov_b32 s46, 0x2e4000
    s_mov_b32 s47, 0x20000
    v_lshlrev_b32 v1, 4, v0
    s_barrier
    s_mul_i32 s65, s4, 20480
    s_add_u32 s65, s65, 81920
    s_add_u32 s64, s63, 0
    s_cmp_ge_u32 s64, 14
    s_cselect_b32 s66, 14, 0
    s_sub_u32 s64, s64, s66
    s_mul_i32 s66, s64, 5120
    s_add_u32 s66, s66, s61
    s_cmp_eq_u32 s64, s62
    s_cselect_b32 s66, 0x40000000, s66
    s_add_u32 m0, s65, 0
    s_add_u32 s67, s66, 0
    buffer_load_dwordx4 v1, s[44:47], s67 offen sc1 lds
    s_add_u32 m0, s65, 1024
    s_add_u32 s67, s66, 1024
    buffer_load_dwordx4 v1, s[44:47], s67 offen sc1 lds
    s_add_u32 m0, s65, 2048
    s_add_u32 s67, s66, 2048
    buffer_load_dwordx4 v1, s[44:47], s67 offen sc1 lds
    s_add_u32 m0, s65, 3072
    s_add_u32 s67, s66, 3072
    buffer_load_dwordx4 v1, s[44:47], s67 offen sc1 lds
    s_add_u32 m0, s65, 4096
    s_add_u32 s67, s66, 4096
    buffer_load_dwordx4 v1, s[44:47], s67 offen sc1 lds
    s_add_u32 s64, s63, 1
    s_cmp_ge_u32 s64, 14
    s_cselect_b32 s66, 14, 0
    s_sub_u32 s64, s64, s66
    s_mul_i32 s66, s64, 5120
    s_add_u32 s66, s66, s61
    s_cmp_eq_u32 s64, s62
    s_cselect_b32 s66, 0x40000000, s66
    s_add_u32 m0, s65, 5120
    s_add_u32 s67, s66, 0
    buffer_load_dwordx4 v1, s[44:47], s67 offen sc1 lds
    s_add_u32 m0, s65, 6144
    s_add_u32 s67, s66, 1024
    buffer_load_dwordx4 v1, s[44:47], s67 offen sc1 lds
    s_add_u32 m0, s65, 7168
    s_add_u32 s67, s66, 2048
    buffer_load_dwordx4 v1, s[44:47], s67 offen sc1 lds
    s_add_u32 m0, s65, 8192
    s_add_u32 s67, s66, 3072
    buffer_load_dwordx4 v1, s[44:47], s67 offen sc1 lds
    s_add_u32 m0, s65, 9216
    s_add_u32 s67, s66, 4096
    buffer_load_dwordx4 v1, s[44:47], s67 offen sc1 lds
    s_add_u32 s64, s63, 2
    s_cmp_ge_u32 s64, 14
    s_cselect_b32 s66, 14, 0
    s_sub_u32 s64, s64, s66
    s_mul_i32 s66, s64, 5120
    s_add_u32 s66, s66, s61
    s_cmp_eq_u32 s64, s62
    s_cselect_b32 s66, 0x40000000, s66
    s_add_u32 m0, s65, 10240
    s_add_u32 s67, s66, 0
    buffer_load_dwordx4 v1, s[44:47], s67 offen sc1 lds
    s_add_u32 m0, s65, 11264
    s_add_u32 s67, s66, 1024
    buffer_load_dwordx4 v1, s[44:47], s67 offen sc1 lds
    s_add_u32 m0, s65, 12288
    s_add_u32 s67, s66, 2048
    buffer_load_dwordx4 v1, s[44:47], s67 offen sc1 lds
    s_add_u32 m0, s65, 13312
    s_add_u32 s67, s66, 3072
    buffer_load_dwordx4 v1, s[44:47], s67 offen sc1 lds
    s_add_u32 m0, s65, 14336
    s_add_u32 s67, s66, 4096
    buffer_load_dwordx4 v1, s[44:47], s67 offen sc1 lds
    s_add_u32 s64, s63, 3
    s_cmp_ge_u32 s64, 14
    s_cselect_b32 s66, 14, 0
    s_sub_u32 s64, s64, s66
    s_mul_i32 s66, s64, 5120
    s_add_u32 s66, s66, s61
    s_cmp_eq_u32 s64, s62
    s_cselect_b32 s66, 0x40000000, s66
    s_add_u32 m0, s65, 15360
    s_add_u32 s67, s66, 0
    buffer_load_dwordx4 v1, s[44:47], s67 offen sc1 lds
    s_add_u32 m0, s65, 16384
    s_add_u32 s67, s66, 1024
    buffer_load_dwordx4 v1, s[44:47], s67 offen sc1 lds
    s_add_u32 m0, s65, 17408
    s_add_u32 s67, s66, 2048
    buffer_load_dwordx4 v1, s[44:47], s67 offen sc1 lds
    s_add_u32 m0, s65, 18432
    s_add_u32 s67, s66, 3072
    buffer_load_dwordx4 v1, s[44:47], s67 offen sc1 lds
    s_add_u32 m0, s65, 19456
    s_add_u32 s67, s66, 4096
    buffer_load_dwordx4 v1, s[44:47], s67 offen sc1 lds
    s_mul_i32 s65, s4, 20480
    s_add_u32 s65, s65, 0
    s_add_u32 s64, s63, 4
    s_cmp_ge_u32 s64, 14
    s_cselect_b32 s66, 14, 0
    s_sub_u32 s64, s64, s66
    s_mul_i32 s66, s64, 5120
    s_add_u32 s66, s66, s61
    s_cmp_eq_u32 s64, s62
    s_cselect_b32 s66, 0x40000000, s66
    s_add_u32 m0, s65, 0
    s_add_u32 s67, s66, 0
    buffer_load_dwordx4 v1, s[44:47], s67 offen sc1 lds
    s_add_u32 m0, s65, 1024
    s_add_u32 s67, s66, 1024
    buffer_load_dwordx4 v1, s[44:47], s67 offen sc1 lds
    s_add_u32 m0, s65, 2048
    s_add_u32 s67, s66, 2048
    buffer_load_dwordx4 v1, s[44:47], s67 offen sc1 lds
    s_add_u32 m0, s65, 3072
    s_add_u32 s67, s66, 3072
    buffer_load_dwordx4 v1, s[44:47], s67 offen sc1 lds
    s_add_u32 m0, s65, 4096
    s_add_u32 s67, s66, 4096
    buffer_load_dwordx4 v1, s[44:47], s67 offen sc1 lds
    s_add_u32 s64, s63, 5
    s_cmp_ge_u32 s64, 14
    s_cselect_b32 s66, 14, 0
    s_sub_u32 s64, s64, s66
    s_mul_i32 s66, s64, 5120
    s_add_u32 s66, s66, s61
    s_cmp_eq_u32 s64, s62
    s_cselect_b32 s66, 0x40000000, s66
    s_add_u32 m0, s65, 5120
    s_add_u32 s67, s66, 0
    buffer_load_dwordx4 v1, s[44:47], s67 offen sc1 lds
    s_add_u32 m0, s65, 6144
    s_add_u32 s67, s66, 1024
    buffer_load_dwordx4 v1, s[44:47], s67 offen sc1 lds
    s_add_u32 m0, s65, 7168
    s_add_u32 s67, s66, 2048
    buffer_load_dwordx4 v1, s[44:47], s67 offen sc1 lds
    s_add_u32 m0, s65, 8192
    s_add_u32 s67, s66, 3072
    buffer_load_dwordx4 v1, s[44:47], s67 offen sc1 lds
    s_add_u32 m0, s65, 9216
    s_add_u32 s67, s66, 4096
    buffer_load_dwordx4 v1, s[44:47], s67 offen sc1 lds
    s_add_u32 s64, s63, 6
    s_cmp_ge_u32 s64, 14
    s_cselect_b32 s66, 14, 0
    s_sub_u32 s64, s64, s66
    s_mul_i32 s66, s64, 5120
    s_add_u32 s66, s66, s61
    s_cmp_eq_u32 s64, s62
    s_cselect_b32 s66, 0x40000000, s66
    s_add_u32 m0, s65, 10240
    s_add_u32 s67, s66, 0
    buffer_load_dwordx4 v1, s[44:47], s67 offen sc1 lds
    s_add_u32 m0, s65, 11264
    s_add_u32 s67, s66, 1024
    buffer_load_dwordx4 v1, s[44:47], s67 offen sc1 lds
    s_add_u32 m0, s65, 12288
    s_add_u32 s67, s66, 2048
    buffer_load_dwordx4 v1, s[44:47], s67 offen sc1 lds
    s_add_u32 m0, s65, 13312
    s_add_u32 s67, s66, 3072
    buffer_load_dwordx4 v1, s[44:47], s67 offen sc1 lds
    s_add_u32 m0, s65, 14336
    s_add_u32 s67, s66, 4096
    buffer_load_dwordx4 v1, s[44:47], s67 offen sc1 lds
    s_add_u32 s64, s63, 7
    s_cmp_ge_u32 s64, 14
    s_cselect_b32 s66, 14, 0
    s_sub_u32 s64, s64, s66
    s_mul_i32 s66, s64, 5120
    s_add_u32 s66, s66, s61
    s_cmp_eq_u32 s64, s62
    s_cselect_b32 s66, 0x40000000, s66
    s_add_u32 m0, s65, 15360
    s_add_u32 s67, s66, 0
    buffer_load_dwordx4 v1, s[44:47], s67 offen sc1 lds
    s_add_u32 m0, s65, 16384
    s_add_u32 s67, s66, 1024
    buffer_load_dwordx4 v1, s[44:47], s67 offen sc1 lds
    s_add_u32 m0, s65, 17408
    s_add_u32 s67, s66, 2048
    buffer_load_dwordx4 v1, s[44:47], s67 offen sc1 lds
    s_add_u32 m0, s65, 18432
    s_add_u32 s67, s66, 3072
    buffer_load_dwordx4 v1, s[44:47], s67 offen sc1 lds
    s_add_u32 m0, s65, 19456
    s_add_u32 s67, s66, 4096
    buffer_load_dwordx4 v1, s[44:47], s67 offen sc1 lds
    s_waitcnt vmcnt(0)
    s_barrier
    s_barrier
    s_mul_i32 s65, s4, 20480
    s_add_u32 s65, s65, 81920
    s_add_u32 s64, s63, 8
    s_cmp_ge_u32 s64, 14
    s_cselect_b32 s66, 14, 0
    s_sub_u32 s64, s64, s66
    s_mul_i32 s66, s64, 5120
    s_add_u32 s66, s66, s61
    s_cmp_eq_u32 s64, s62
    s_cselect_b32 s66, 0x40000000, s66
    s_add_u32 m0, s65, 0
    s_add_u32 s67, s66, 0
    buffer_load_dwordx4 v1, s[44:47], s67 offen sc1 lds
    s_add_u32 m0, s65, 1024
    s_add_u32 s67, s66, 1024
    buffer_load_dwordx4 v1, s[44:47], s67 offen sc1 lds
    s_add_u32 m0, s65, 2048
    s_add_u32 s67, s66, 2048
    buffer_load_dwordx4 v1, s[44:47], s67 offen sc1 lds
    s_add_u32 m0, s65, 3072
    s_add_u32 s67, s66, 3072
    buffer_load_dwordx4 v1, s[44:47], s67 offen sc1 lds
    s_add_u32 m0, s65, 4096
    s_add_u32 s67, s66, 4096
    buffer_load_dwordx4 v1, s[44:47], s67 offen sc1 lds
    s_add_u32 s64, s63, 9
    s_cmp_ge_u32 s64, 14
    s_cselect_b32 s66, 14, 0
    s_sub_u32 s64, s64, s66
    s_mul_i32 s66, s64, 5120
    s_add_u32 s66, s66, s61
    s_cmp_eq_u32 s64, s62
    s_cselect_b32 s66, 0x40000000, s66
    s_add_u32 m0, s65, 5120
    s_add_u32 s67, s66, 0
    buffer_load_dwordx4 v1, s[44:47], s67 offen sc1 lds
    s_add_u32 m0, s65, 6144
    s_add_u32 s67, s66, 1024
    buffer_load_dwordx4 v1, s[44:47], s67 offen sc1 lds
    s_add_u32 m0, s65, 7168
    s_add_u32 s67, s66, 2048
    buffer_load_dwordx4 v1, s[44:47], s67 offen sc1 lds
    s_add_u32 m0, s65, 8192
    s_add_u32 s67, s66, 3072
    buffer_load_dwordx4 v1, s[44:47], s67 offen sc1 lds
    s_add_u32 m0, s65, 9216
    s_add_u32 s67, s66, 4096
    buffer_load_dwordx4 v1, s[44:47], s67 offen sc1 lds
    s_add_u32 s64, s63, 10
    s_cmp_ge_u32 s64, 14
    s_cselect_b32 s66, 14, 0
    s_sub_u32 s64, s64, s66
    s_mul_i32 s66, s64, 5120
    s_add_u32 s66, s66, s61
    s_cmp_eq_u32 s64, s62
    s_cselect_b32 s66, 0x40000000, s66
    s_add_u32 m0, s65, 10240
    s_add_u32 s67, s66, 0
    buffer_load_dwordx4 v1, s[44:47], s67 offen sc1 lds
    s_add_u32 m0, s65, 11264
    s_add_u32 s67, s66, 1024
    buffer_load_dwordx4 v1, s[44:47], s67 offen sc1 lds
    s_add_u32 m0, s65, 12288
    s_add_u32 s67, s66, 2048
    buffer_load_dwordx4 v1, s[44:47], s67 offen sc1 lds
    s_add_u32 m0, s65, 13312
    s_add_u32 s67, s66, 3072
    buffer_load_dwordx4 v1, s[44:47], s67 offen sc1 lds
    s_add_u32 m0, s65, 14336
    s_add_u32 s67, s66, 4096
    buffer_load_dwordx4 v1, s[44:47], s67 offen sc1 lds
    s_add_u32 s64, s63, 11
    s_cmp_ge_u32 s64, 14
    s_cselect_b32 s66, 14, 0
    s_sub_u32 s64, s64, s66
    s_mul_i32 s66, s64, 5120
    s_add_u32 s66, s66, s61
    s_cmp_eq_u32 s64, s62
    s_cselect_b32 s66, 0x40000000, s66
    s_add_u32 m0, s65, 15360
    s_add_u32 s67, s66, 0
    buffer_load_dwordx4 v1, s[44:47], s67 offen sc1 lds
    s_add_u32 m0, s65, 16384
    s_add_u32 s67, s66, 1024
    buffer_load_dwordx4 v1, s[44:47], s67 offen sc1 lds
    s_add_u32 m0, s65, 17408
    s_add_u32 s67, s66, 2048
    buffer_load_dwordx4 v1, s[44:47], s67 offen sc1 lds
    s_add_u32 m0, s65, 18432
    s_add_u32 s67, s66, 3072
    buffer_load_dwordx4 v1, s[44:47], s67 offen sc1 lds
    s_add_u32 m0, s65, 19456
    s_add_u32 s67, s66, 4096
    buffer_load_dwordx4 v1, s[44:47], s67 offen sc1 lds
    s_waitcnt vmcnt(0)
L_p2_h2a:
    s_cmp_lg_u32 s3, 4
    s_cbranch_scc1 L_p2_h3
    s_lshl_b32 s7, s90, 7
    s_add_u32 s7, s7, 0
    s_lshl_b32 s8, s90, 8
    s_add_u32 s8, s8, 1024
    v_lshlrev_b32 v7, 2, v0
    s_mov_b64 s[94:95], 0x3fffff
L_sall_poll:
    buffer_load_dword v8, v7, s[84:87], s7 offen sc1
    buffer_load_dword v9, v7, s[84:87], s8 offen sc1
    s_waitcnt vmcnt(0)
    v_cmp_ne_u32 vcc, s92, v8
    v_cmp_ne_u32 s[10:11], s92, v9
    s_nop 1
    s_and_b64 vcc, vcc, s[94:95]
    s_or_b64 vcc, vcc, s[10:11]
    s_cbranch_scc0 L_sall_ok
    s_sleep 2
    s_branch L_sall_poll
L_sall_ok:
L_p2_h3:
    s_barrier
    s_cmp_ge_u32 s93, 160
    s_cbranch_scc1 L_mw_done
    s_waitcnt vmcnt(20)
    v_cndmask_b32_e64 v76, 0, v76, s[16:17]
    v_cndmask_b32_e64 v77, 0, v77, s[16:17]
    v_cndmask_b32_e64 v78, 0, v78, s[16:17]
    v_cndmask_b32_e64 v79, 0, v79, s[16:17]
    v_cvt_pk_bf16_f32 v102, v76, v77
    v_cvt_pk_bf16_f32 v103, v78, v79
    s_waitcnt vmcnt(16)
    v_cndmask_b32_e64 v80, 0, v80, s[18:19]
    v_cndmask_b32_e64 v81, 0, v81, s[18:19]
    v_cndmask_b32_e64 v82, 0, v82, s[18:19]
    v_cndmask_b32_e64 v83, 0, v83, s[18:19]
    v_cvt_pk_bf16_f32 v104, v80, v81
    v_cvt_pk_bf16_f32 v105, v82, v83
    s_waitcnt vmcnt(12)
    v_cndmask_b32_e64 v84, 0, v84, s[20:21]
    v_cndmask_b32_e64 v85, 0, v85, s[20:21]
    v_cndmask_b32_e64 v86, 0, v86, s[20:21]
    v_cndmask_b32_e64 v87, 0, v87, s[20:21]
    v_cvt_pk_bf16_f32 v106, v84, v85
    v_cvt_pk_bf16_f32 v107, v86, v87
    s_waitcnt vmcnt(8)
    v_cndmask_b32_e64 v88, 0, v88, s[22:23]
    v_cndmask_b32_e64 v89, 0, v89, s[22:23]
    v_cndmask_b32_e64 v90, 0, v90, s[22:23]
    v_cndmask_b32_e64 v91, 0, v91, s[22:23]
    v_cvt_pk_bf16_f32 v108, v88, v89
    v_cvt_pk_bf16_f32 v109, v90, v91
    s_waitcnt vmcnt(4)
    v_cndmask_b32_e64 v92, 0, v92, s[24:25]
    v_cndmask_b32_e64 v93, 0, v93, s[24:25]
    v_cndmask_b32_e64 v94, 0, v94, s[24:25]
    v_cndmask_b32_e64 v95, 0, v95, s[24:25]
    v_cvt_pk_bf16_f32 v110, v92, v93
    v_cvt_pk_bf16_f32 v111, v94, v95
    s_waitcnt vmcnt(0)
    v_cndmask_b32_e64 v96, 0, v96, s[26:27]
    v_cndmask_b32_e64 v97, 0, v97, s[26:27]
    v_cndmask_b32_e64 v98, 0, v98, s[26:27]
    v_cndmask_b32_e64 v99, 0, v99, s[26:27]
    v_cvt_pk_bf16_f32 v112, v96, v97
    v_cvt_pk_bf16_f32 v113, v98, v99
    s_nop 1
    v_mfma_f32_16x16x32_bf16 v[116:119], v[100:103], v[16:19], 0
    v_mfma_f32_16x16x32_bf16 v[120:123], v[108:111], v[36:39], 0
    v_mfma_f32_16x16x32_bf16 v[124:127], v[100:103], v[20:23], 0
    v_mfma_f32_16x16x32_bf16 v[128:131], v[108:111], v[40:43], 0
    v_mfma_f32_16x16x32_bf16 v[132:135], v[100:103], v[24:27], 0
    v_mfma_f32_16x16x32_bf16 v[136:139], v[108:111], v[44:47], 0
    v_mfma_f32_16x16x32_bf16 v[140:143], v[100:103], v[28:31], 0
    v_mfma_f32_16x16x32_bf16 v[144:147], v[108:111], v[48:51], 0
    v_mfma_f32_16x16x32_bf16 v[148:151], v[100:103], v[32:35], 0
    v_mfma_f32_16x16x32_bf16 v[152:155], v[108:111], v[52:55], 0
    v_mfma_f32_16x16x32_bf16 v[116:119], v[104:107], v[36:39], v[116:119]
    v_mfma_f32_16x16x32_bf16 v[120:123], v[112:115], v[56:59], v[120:123]
    v_mfma_f32_16x16x32_bf16 v[124:127], v[104:107], v[40:43], v[124:127]
    v_mfma_f32_16x16x32_bf16 v[128:131], v[112:115], v[60:63], v[128:131]
    v_mfma_f32_16x16x32_bf16 v[132:135], v[104:107], v[44:47], v[132:135]
    v_mfma_f32_16x16x32_bf16 v[136:139], v[112:115], v[64:67], v[136:139]
    v_mfma_f32_16x16x32_bf16 v[140:143], v[104:107], v[48:51], v[140:143]
    v_mfma_f32_16x16x32_bf16 v[144:147], v[112:115], v[68:71], v[144:147]
    v_mfma_f32_16x16x32_bf16 v[148:151], v[104:107], v[52:55], v[148:151]
    v_mfma_f32_16x16x32_bf16 v[152:155], v[112:115], v[72:75], v[152:155]
    s_add_u32 s56, s36, 0xa00400
    s_addc_u32 s57, s37, 0
    s_mov_b32 s58, 0x2e4000
    s_mov_b32 s59, 0x20000
    s_nop 3
    v_cvt_pk_bf16_f32 v156, v116, v117
    v_cvt_pk_bf16_f32 v157, v118, v119
    v_cvt_pk_bf16_f32 v158, v120, v121
    v_cvt_pk_bf16_f32 v159, v122, v123
    buffer_store_dwordx4 v[156:159], v1, s[56:59], s73 offen offset:0 sc1
    v_cvt_pk_bf16_f32 v160, v124, v125
    v_cvt_pk_bf16_f32 v161, v126, v127
    v_cvt_pk_bf16_f32 v162, v128, v129
    v_cvt_pk_bf16_f32 v163, v130, v131
    buffer_store_dwordx4 v[160:163], v1, s[56:59], s73 offen offset:1024 sc1
    v_cvt_pk_bf16_f32 v164, v132, v133
    v_cvt_pk_bf16_f32 v165, v134, v135
    v_cvt_pk_bf16_f32 v166, v136, v137
    v_cvt_pk_bf16_f32 v167, v138, v139
    buffer_store_dwordx4 v[164:167], v1, s[56:59], s73 offen offset:2048 sc1
    v_cvt_pk_bf16_f32 v168, v140, v141
    v_cvt_pk_bf16_f32 v169, v142, v143
    v_cvt_pk_bf16_f32 v170, v144, v145
    v_cvt_pk_bf16_f32 v171, v146, v147
    buffer_store_dwordx4 v[168:171], v1, s[56:59], s73 offen offset:3072 sc1
    s_nop 1
    v_cvt_pk_bf16_f32 v172, v148, v149
    v_cvt_pk_bf16_f32 v173, v150, v151
    v_cvt_pk_bf16_f32 v174, v152, v153
    v_cvt_pk_bf16_f32 v175, v154, v155
    buffer_store_dwordx4 v[172:175], v2, s[56:59], s73 offen sc1
    s_waitcnt vmcnt(0)
    s_lshl_b32 s7, s93, 2
    s_add_u32 s7, s7, 16384
    v_lshlrev_b32 v13, 10, v0
    v_mov_b32 v14, s92
    s_mov_b64 exec, 255
    buffer_store_dword v14, v13, s[84:87], s7 offen sc1
    s_mov_b64 exec, -1
L_mw_done:
    s_add_u32 s44, s36, 0xe00000
    s_addc_u32 s45, s37, 0
    s_mov_b32 s46, 0x1b000
    s_mov_b32 s47, 0x20000
    s_mov_b32 s40, s36
    s_mov_b32 s41, s37
    s_mov_b32 s42, 0x960000
    s_mov_b32 s43, 0x20000
    s_add_u32 s48, s36, 0xf80000
    s_addc_u32 s49, s37, 0
    s_mov_b32 s50, 0x2000
    s_mov_b32 s51, 0x20000
    v_lshrrev_b32 v5, 4, v0
    v_lshlrev_b32 v6, 4, v5
    s_mul_i32 s5, s4, 640
    s_add_u32 s5, s5, 106496
    buffer_load_dwordx4 v[160:163], v6, s[44:47], s5 offen offset:0 sc1
    buffer_load_dwordx4 v[164:167], v6, s[44:47], s5 offen offset:64 sc1
    buffer_load_dwordx4 v[168:171], v6, s[44:47], s5 offen offset:128 sc1
    buffer_load_dwordx4 v[172:175], v6, s[44:47], s5 offen offset:192 sc1
    buffer_load_dwordx4 v[176:179], v6, s[44:47], s5 offen offset:256 sc1
    buffer_load_dwordx4 v[180:183], v6, s[44:47], s5 offen offset:320 sc1
    buffer_load_dwordx4 v[184:187], v6, s[44:47], s5 offen offset:384 sc1
    buffer_load_dwordx4 v[188:191], v6, s[44:47], s5 offen offset:448 sc1
    buffer_load_dwordx4 v[192:195], v6, s[44:47], s5 offen offset:512 sc1
    buffer_load_dwordx4 v[196:199], v6, s[44:47], s5 offen offset:576 sc1
    v_add_u32 v2, 0x1000, v1
    s_lshl_b32 s7, s88, 2
    s_mul_i32 s7, s7, 75
    s_mul_i32 s8, s4, 5
    s_add_u32 s7, s7, s8
    s_add_u32 s7, s7, 54
    s_lshl_b32 s7, s7, 10
    buffer_load_dwordx4 v[64:67], v1, s[40:43], s7 offen offset:0 sc1
    buffer_load_dwordx4 v[68:71], v1, s[40:43], s7 offen offset:1024 sc1
    buffer_load_dwordx4 v[72:75], v1, s[40:43], s7 offen offset:2048 sc1
    buffer_load_dwordx4 v[76:79], v1, s[40:43], s7 offen offset:3072 sc1
    buffer_load_dwordx4 v[80:83], v2, s[40:43], s7 offen sc1
    s_add_u32 s7, s7, 76800
    v_and_b32 v3, 15, v0
    v_lshlrev_b32 v3, 2, v3
    s_lshl_b32 s6, s88, 8
    buffer_load_dword v240, v3, s[48:51], s6 offen offset:0 sc1
    buffer_load_dword v241, v3, s[48:51], s6 offen offset:64 sc1
    buffer_load_dword v242, v3, s[48:51], s6 offen offset:128 sc1
    buffer_load_dword v243, v3, s[48:51], s6 offen offset:192 sc1
    buffer_load_dwordx4 v[84:87], v1, s[40:43], s7 offen offset:0 sc1
    buffer_load_dwordx4 v[88:91], v1, s[40:43], s7 offen offset:1024 sc1
    buffer_load_dwordx4 v[92:95], v1, s[40:43], s7 offen offset:2048 sc1
    buffer_load_dwordx4 v[96:99], v1, s[40:43], s7 offen offset:3072 sc1
    buffer_load_dwordx4 v[100:103], v2, s[40:43], s7 offen sc1
    s_add_u32 s7, s7, 76800
    v_and_b32 v7, 15, v0
    v_and_b32 v8, 3, v7
    v_lshlrev_b32 v8, 2, v8
    v_lshrrev_b32 v9, 2, v7
    v_add_u32 v8, v8, v9
    v_add_u32 v9, 0, v8
    v_mul_u32_u24 v9, 13, v9
    v_lshrrev_b32 v208, 6, v9
    v_add_u32 v9, 16, v8
    v_mul_u32_u24 v9, 13, v9
    v_lshrrev_b32 v209, 6, v9
    v_add_u32 v9, 32, v8
    v_mul_u32_u24 v9, 13, v9
    v_lshrrev_b32 v210, 6, v9
    v_add_u32 v9, 0, v5
    v_mul_u32_u24 v9, 13, v9
    v_lshrrev_b32 v212, 6, v9
    v_add_u32 v9, 4, v5
    v_mul_u32_u24 v9, 13, v9
    v_lshrrev_b32 v213, 6, v9
    v_add_u32 v9, 8, v5
    v_mul_u32_u24 v9, 13, v9
    v_lshrrev_b32 v214, 6, v9
    v_add_u32 v9, 12, v5
    v_mul_u32_u24 v9, 13, v9
    v_lshrrev_b32 v215, 6, v9
    v_add_u32 v9, 16, v5
    v_mul_u32_u24 v9, 13, v9
    v_lshrrev_b32 v216, 6, v9
    v_add_u32 v9, 20, v5
    v_mul_u32_u24 v9, 13, v9
    v_lshrrev_b32 v217, 6, v9
    v_add_u32 v9, 24, v5
    v_mul_u32_u24 v9, 13, v9
    v_lshrrev_b32 v218, 6, v9
    v_add_u32 v9, 28, v5
    v_mul_u32_u24 v9, 13, v9
    v_lshrrev_b32 v219, 6, v9
    v_add_u32 v9, 32, v5
    v_mul_u32_u24 v9, 13, v9
    v_lshrrev_b32 v220, 6, v9
    v_add_u32 v9, 36, v5
    v_mul_u32_u24 v9, 13, v9
    v_lshrrev_b32 v221, 6, v9
    s_waitcnt vmcnt(14)
    v_cvt_pk_bf16_f32 v160, v160, v161
    v_cvt_pk_bf16_f32 v161, v162, v163
    v_cvt_pk_bf16_f32 v164, v164, v165
    v_cvt_pk_bf16_f32 v165, v166, v167
    v_cvt_pk_bf16_f32 v168, v168, v169
    v_cvt_pk_bf16_f32 v169, v170, v171
    v_cvt_pk_bf16_f32 v172, v172, v173
    v_cvt_pk_bf16_f32 v173, v174, v175
    v_cvt_pk_bf16_f32 v176, v176, v177
    v_cvt_pk_bf16_f32 v177, v178, v179
    v_cvt_pk_bf16_f32 v180, v180, v181
    v_cvt_pk_bf16_f32 v181, v182, v183
    v_cvt_pk_bf16_f32 v184, v184, v185
    v_cvt_pk_bf16_f32 v185, v186, v187
    v_cvt_pk_bf16_f32 v188, v188, v189
    v_cvt_pk_bf16_f32 v189, v190, v191
    v_cvt_pk_bf16_f32 v192, v192, v193
    v_cvt_pk_bf16_f32 v193, v194, v195
    v_cvt_pk_bf16_f32 v196, v196, v197
    v_cvt_pk_bf16_f32 v197, v198, v199
    v_cmp_eq_u32 s[12:13], v208, v212
    v_cmp_eq_u32 s[14:15], v208, v213
    s_nop 0
    v_cndmask_b32_e64 v16, 0, v160, s[12:13]
    v_cndmask_b32_e64 v17, 0, v161, s[12:13]
    v_cmp_eq_u32 s[12:13], v208, v214
    v_cndmask_b32_e64 v18, 0, v164, s[14:15]
    v_cndmask_b32_e64 v19, 0, v165, s[14:15]
    v_cmp_eq_u32 s[14:15], v208, v215
    v_cndmask_b32_e64 v20, 0, v168, s[12:13]
    v_cndmask_b32_e64 v21, 0, v169, s[12:13]
    v_cmp_eq_u32 s[12:13], v208, v216
    v_cndmask_b32_e64 v22, 0, v172, s[14:15]
    v_cndmask_b32_e64 v23, 0, v173, s[14:15]
    v_cmp_eq_u32 s[14:15], v208, v217
    v_cndmask_b32_e64 v24, 0, v176, s[12:13]
    v_cndmask_b32_e64 v25, 0, v177, s[12:13]
    v_cmp_eq_u32 s[12:13], v209, v214
    v_cndmask_b32_e64 v26, 0, v180, s[14:15]
    v_cndmask_b32_e64 v27, 0, v181, s[14:15]
    v_cmp_eq_u32 s[14:15], v209, v215
    v_cndmask_b32_e64 v28, 0, v168, s[12:13]
    v_cndmask_b32_e64 v29, 0, v169, s[12:13]
    v_cmp_eq_u32 s[12:13], v209, v216
    v_cndmask_b32_e64 v30, 0, v172, s[14:15]
    v_cndmask_b32_e64 v31, 0, v173, s[14:15]
    v_cmp_eq_u32 s[14:15], v209, v217
    v_cndmask_b32_e64 v32, 0, v176, s[12:13]
    v_cndmask_b32_e64 v33, 0, v177, s[12:13]
    v_cmp_eq_u32 s[12:13], v209, v218
    v_cndmask_b32_e64 v34, 0, v180, s[14:15]
    v_cndmask_b32_e64 v35, 0, v181, s[14:15]
    v_cmp_eq_u32 s[14:15], v209, v219
    v_cndmask_b32_e64 v36, 0, v184, s[12:13]
    v_cndmask_b32_e64 v37, 0, v185, s[12:13]
    v_cmp_eq_u32 s[12:13], v209, v220
    v_cndmask_b32_e64 v38, 0, v188, s[14:15]
    v_cndmask_b32_e64 v39, 0, v189, s[14:15]
    v_cmp_eq_u32 s[14:15], v209, v221
    v_cndmask_b32_e64 v40, 0, v192, s[12:13]
    v_cndmask_b32_e64 v41, 0, v193, s[12:13]
    v_cmp_eq_u32 s[12:13], v210, v218
    v_cndmask_b32_e64 v42, 0, v196, s[14:15]
    v_cndmask_b32_e64 v43, 0, v197, s[14:15]
    v_cmp_eq_u32 s[14:15], v210, v219
    v_cndmask_b32_e64 v44, 0, v184, s[12:13]
    v_cndmask_b32_e64 v45, 0, v185, s[12:13]
    v_cmp_eq_u32 s[12:13], v210, v220
    v_cndmask_b32_e64 v46, 0, v188, s[14:15]
    v_cndmask_b32_e64 v47, 0, v189, s[14:15]
    v_cmp_eq_u32 s[14:15], v210, v221
    v_cndmask_b32_e64 v48, 0, v192, s[12:13]
    v_cndmask_b32_e64 v49, 0, v193, s[12:13]
    s_nop 1
    v_cndmask_b32_e64 v50, 0, v196, s[14:15]
    v_cndmask_b32_e64 v51, 0, v197, s[14:15]
    s_mul_i32 s9, s4, 20480
    s_add_u32 s9, s9, 0
    v_add_u32 v4, s9, v1
    s_mov_b32 s10, 0xffff0000
    s_mov_b32 s11, 0x358637bd
    buffer_load_dwordx4 v[104:107], v1, s[40:43], s7 offen offset:0 sc1
    buffer_load_dwordx4 v[108:111], v1, s[40:43], s7 offen offset:1024 sc1
    buffer_load_dwordx4 v[112:115], v1, s[40:43], s7 offen offset:2048 sc1
    buffer_load_dwordx4 v[116:119], v1, s[40:43], s7 offen offset:3072 sc1
    buffer_load_dwordx4 v[120:123], v2, s[40:43], s7 offen sc1
    s_add_u32 s7, s7, 76800
    s_waitcnt vmcnt(10)
    v_mfma_f32_16x16x32_bf16 v[224:227], v[16:19], v[64:67], 0
    v_mfma_f32_16x16x32_bf16 v[224:227], v[20:23], v[68:71], v[224:227]
    v_mfma_f32_16x16x32_bf16 v[224:227], v[24:27], v[72:75], v[224:227]
    v_mfma_f32_16x16x32_bf16 v[228:231], v[28:31], v[68:71], 0
    v_mfma_f32_16x16x32_bf16 v[228:231], v[32:35], v[72:75], v[228:231]
    v_mfma_f32_16x16x32_bf16 v[228:231], v[36:39], v[76:79], v[228:231]
    v_mfma_f32_16x16x32_bf16 v[228:231], v[40:43], v[80:83], v[228:231]
    v_mfma_f32_16x16x32_bf16 v[232:235], v[44:47], v[76:79], 0
    v_mfma_f32_16x16x32_bf16 v[232:235], v[48:51], v[80:83], v[232:235]
    v_lshlrev_b32 v192, 16, v64
    v_and_b32 v193, s10, v64
    v_lshlrev_b32 v194, 16, v65
    v_and_b32 v195, s10, v65
    v_lshlrev_b32 v196, 16, v66
    v_and_b32 v197, s10, v66
    v_lshlrev_b32 v198, 16, v67
    v_and_b32 v199, s10, v67
    v_add_f32 v224, s11, v224
    v_add_f32 v225, s11, v225
    v_add_f32 v226, s11, v226
    v_add_f32 v227, s11, v227
    v_add_f32 v228, s11, v228
    v_add_f32 v229, s11, v229
    v_add_f32 v230, s11, v230
    v_add_f32 v231, s11, v231
    v_add_f32 v232, s11, v232
    v_add_f32 v233, s11, v233
    v_rcp_f32 v224, v224
    v_rcp_f32 v225, v225
    v_rcp_f32 v226, v226
    v_rcp_f32 v227, v227
    v_rcp_f32 v228, v228
    v_rcp_f32 v229, v229
    v_rcp_f32 v230, v230
    v_rcp_f32 v231, v231
    v_rcp_f32 v232, v232
    v_rcp_f32 v233, v233
    s_nop 0
    v_mul_f32 v160, v224, v240
    v_mul_f32 v161, v224, v240
    v_mul_f32 v162, v225, v240
    v_mul_f32 v163, v225, v240
    v_mul_f32 v164, v226, v240
    v_mul_f32 v165, v226, v240
    v_mul_f32 v166, v227, v240
    v_mul_f32 v167, v227, v240
    v_mul_f32 v168, v228, v240
    v_mul_f32 v169, v228, v240
    v_mul_f32 v170, v229, v240
    v_mul_f32 v171, v229, v240
    v_mul_f32 v172, v230, v240
    v_mul_f32 v173, v230, v240
    v_mul_f32 v174, v231, v240
    v_mul_f32 v175, v231, v240
    v_mul_f32 v176, v232, v240
    v_mul_f32 v177, v232, v240
    v_mul_f32 v178, v233, v240
    v_mul_f32 v179, v233, v240
    v_lshlrev_b32 v200, 16, v68
    v_and_b32 v201, s10, v68
    v_lshlrev_b32 v202, 16, v69
    v_and_b32 v203, s10, v69
    v_lshlrev_b32 v204, 16, v70
    v_and_b32 v205, s10, v70
    v_lshlrev_b32 v206, 16, v71
    v_and_b32 v207, s10, v71
    v_pk_mul_f32 v[192:193], v[192:193], v[160:161]
    v_pk_mul_f32 v[194:195], v[194:195], v[160:161]
    v_pk_mul_f32 v[196:197], v[196:197], v[162:163]
    v_pk_mul_f32 v[198:199], v[198:199], v[162:163]
    v_cvt_pk_bf16_f32 v64, v192, v193
    v_cvt_pk_bf16_f32 v65, v194, v195
    v_cvt_pk_bf16_f32 v66, v196, v197
    v_cvt_pk_bf16_f32 v67, v198, v199
    v_lshlrev_b32 v192, 16, v72
    v_and_b32 v193, s10, v72
    v_lshlrev_b32 v194, 16, v73
    v_and_b32 v195, s10, v73
    v_lshlrev_b32 v196, 16, v74
    v_and_b32 v197, s10, v74
    v_lshlrev_b32 v198, 16, v75
    v_and_b32 v199, s10, v75
    v_pk_mul_f32 v[200:201], v[200:201], v[164:165]
    v_pk_mul_f32 v[202:203], v[202:203], v[164:165]
    v_pk_mul_f32 v[204:205], v[204:205], v[166:167]
    v_pk_mul_f32 v[206:207], v[206:207], v[166:167]
    v_cvt_pk_bf16_f32 v68, v200, v201
    v_cvt_pk_bf16_f32 v69, v202, v203
    v_cvt_pk_bf16_f32 v70, v204, v205
    v_cvt_pk_bf16_f32 v71, v206, v207
    v_lshlrev_b32 v200, 16, v76
    v_and_b32 v201, s10, v76
    v_lshlrev_b32 v202, 16, v77
    v_and_b32 v203, s10, v77
    v_lshlrev_b32 v204, 16, v78
    v_and_b32 v205, s10, v78
    v_lshlrev_b32 v206, 16, v79
    v_and_b32 v207, s10, v79
    v_pk_mul_f32 v[192:193], v[192:193], v[168:169]
    v_pk_mul_f32 v[194:195], v[194:195], v[168:169]
    v_pk_mul_f32 v[196:197], v[196:197], v[170:171]
    v_pk_mul_f32 v[198:199], v[198:199], v[170:171]
    v_cvt_pk_bf16_f32 v72, v192, v193
    v_cvt_pk_bf16_f32 v73, v194, v195
    v_cvt_pk_bf16_f32 v74, v196, v197
    v_cvt_pk_bf16_f32 v75, v198, v199
    v_lshlrev_b32 v192, 16, v80
    v_and_b32 v193, s10, v80
    v_lshlrev_b32 v194, 16, v81
    v_and_b32 v195, s10, v81
    v_lshlrev_b32 v196, 16, v82
    v_and_b32 v197, s10, v82
    v_lshlrev_b32 v198, 16, v83
    v_and_b32 v199, s10, v83
    v_pk_mul_f32 v[200:201], v[200:201], v[172:173]
    v_pk_mul_f32 v[202:203], v[202:203], v[172:173]
    v_pk_mul_f32 v[204:205], v[204:205], v[174:175]
    v_pk_mul_f32 v[206:207], v[206:207], v[174:175]
    v_cvt_pk_bf16_f32 v76, v200, v201
    v_cvt_pk_bf16_f32 v77, v202, v203
    v_cvt_pk_bf16_f32 v78, v204, v205
    v_cvt_pk_bf16_f32 v79, v206, v207
    v_pk_mul_f32 v[192:193], v[192:193], v[176:177]
    v_pk_mul_f32 v[194:195], v[194:195], v[176:177]
    v_pk_mul_f32 v[196:197], v[196:197], v[178:179]
    v_pk_mul_f32 v[198:199], v[198:199], v[178:179]
    v_cvt_pk_bf16_f32 v80, v192, v193
    v_cvt_pk_bf16_f32 v81, v194, v195
    v_cvt_pk_bf16_f32 v82, v196, v197
    v_cvt_pk_bf16_f32 v83, v198, v199
    buffer_load_dwordx4 v[124:127], v1, s[40:43], s7 offen offset:0 sc1
    buffer_load_dwordx4 v[128:131], v1, s[40:43], s7 offen offset:1024 sc1
    buffer_load_dwordx4 v[132:135], v1, s[40:43], s7 offen offset:2048 sc1
    buffer_load_dwordx4 v[136:139], v1, s[40:43], s7 offen offset:3072 sc1
    buffer_load_dwordx4 v[140:143], v2, s[40:43], s7 offen sc1
    s_add_u32 s7, s7, 76800
    s_waitcnt vmcnt(10)
    v_mfma_f32_16x16x32_bf16 v[224:227], v[16:19], v[84:87], 0
    v_mfma_f32_16x16x32_bf16 v[224:227], v[20:23], v[88:91], v[224:227]
    v_mfma_f32_16x16x32_bf16 v[224:227], v[24:27], v[92:95], v[224:227]
    v_mfma_f32_16x16x32_bf16 v[228:231], v[28:31], v[88:91], 0
    v_mfma_f32_16x16x32_bf16 v[228:231], v[32:35], v[92:95], v[228:231]
    v_mfma_f32_16x16x32_bf16 v[228:231], v[36:39], v[96:99], v[228:231]
    v_mfma_f32_16x16x32_bf16 v[228:231], v[40:43], v[100:103], v[228:231]
    v_mfma_f32_16x16x32_bf16 v[232:235], v[44:47], v[96:99], 0
    v_mfma_f32_16x16x32_bf16 v[232:235], v[48:51], v[100:103], v[232:235]
    v_lshlrev_b32 v192, 16, v84
    v_and_b32 v193, s10, v84
    v_lshlrev_b32 v194, 16, v85
    v_and_b32 v195, s10, v85
    v_lshlrev_b32 v196, 16, v86
    v_and_b32 v197, s10, v86
    v_lshlrev_b32 v198, 16, v87
    v_and_b32 v199, s10, v87
    v_add_f32 v224, s11, v224
    v_add_f32 v225, s11, v225
    v_add_f32 v226, s11, v226
    v_add_f32 v227, s11, v227
    v_add_f32 v228, s11, v228
    v_add_f32 v229, s11, v229
    v_add_f32 v230, s11, v230
    v_add_f32 v231, s11, v231
    v_add_f32 v232, s11, v232
    v_add_f32 v233, s11, v233
    v_rcp_f32 v224, v224
    v_rcp_f32 v225, v225
    v_rcp_f32 v226, v226
    v_rcp_f32 v227, v227
    v_rcp_f32 v228, v228
    v_rcp_f32 v229, v229
    v_rcp_f32 v230, v230
    v_rcp_f32 v231, v231
    v_rcp_f32 v232, v232
    v_rcp_f32 v233, v233
    s_nop 0
    v_mul_f32 v160, v224, v241
    v_mul_f32 v161, v224, v241
    v_mul_f32 v162, v225, v241
    v_mul_f32 v163, v225, v241
    v_mul_f32 v164, v226, v241
    v_mul_f32 v165, v226, v241
    v_mul_f32 v166, v227, v241
    v_mul_f32 v167, v227, v241
    v_mul_f32 v168, v228, v241
    v_mul_f32 v169, v228, v241
    v_mul_f32 v170, v229, v241
    v_mul_f32 v171, v229, v241
    v_mul_f32 v172, v230, v241
    v_mul_f32 v173, v230, v241
    v_mul_f32 v174, v231, v241
    v_mul_f32 v175, v231, v241
    v_mul_f32 v176, v232, v241
    v_mul_f32 v177, v232, v241
    v_mul_f32 v178, v233, v241
    v_mul_f32 v179, v233, v241
    v_lshlrev_b32 v200, 16, v88
    v_and_b32 v201, s10, v88
    v_lshlrev_b32 v202, 16, v89
    v_and_b32 v203, s10, v89
    v_lshlrev_b32 v204, 16, v90
    v_and_b32 v205, s10, v90
    v_lshlrev_b32 v206, 16, v91
    v_and_b32 v207, s10, v91
    v_pk_mul_f32 v[192:193], v[192:193], v[160:161]
    v_pk_mul_f32 v[194:195], v[194:195], v[160:161]
    v_pk_mul_f32 v[196:197], v[196:197], v[162:163]
    v_pk_mul_f32 v[198:199], v[198:199], v[162:163]
    v_cvt_pk_bf16_f32 v84, v192, v193
    v_cvt_pk_bf16_f32 v85, v194, v195
    v_cvt_pk_bf16_f32 v86, v196, v197
    v_cvt_pk_bf16_f32 v87, v198, v199
    v_lshlrev_b32 v192, 16, v92
    v_and_b32 v193, s10, v92
    v_lshlrev_b32 v194, 16, v93
    v_and_b32 v195, s10, v93
    v_lshlrev_b32 v196, 16, v94
    v_and_b32 v197, s10, v94
    v_lshlrev_b32 v198, 16, v95
    v_and_b32 v199, s10, v95
    v_pk_mul_f32 v[200:201], v[200:201], v[164:165]
    v_pk_mul_f32 v[202:203], v[202:203], v[164:165]
    v_pk_mul_f32 v[204:205], v[204:205], v[166:167]
    v_pk_mul_f32 v[206:207], v[206:207], v[166:167]
    v_cvt_pk_bf16_f32 v88, v200, v201
    v_cvt_pk_bf16_f32 v89, v202, v203
    v_cvt_pk_bf16_f32 v90, v204, v205
    v_cvt_pk_bf16_f32 v91, v206, v207
    v_lshlrev_b32 v200, 16, v96
    v_and_b32 v201, s10, v96
    v_lshlrev_b32 v202, 16, v97
    v_and_b32 v203, s10, v97
    v_lshlrev_b32 v204, 16, v98
    v_and_b32 v205, s10, v98
    v_lshlrev_b32 v206, 16, v99
    v_and_b32 v207, s10, v99
    v_pk_mul_f32 v[192:193], v[192:193], v[168:169]
    v_pk_mul_f32 v[194:195], v[194:195], v[168:169]
    v_pk_mul_f32 v[196:197], v[196:197], v[170:171]
    v_pk_mul_f32 v[198:199], v[198:199], v[170:171]
    v_cvt_pk_bf16_f32 v92, v192, v193
    v_cvt_pk_bf16_f32 v93, v194, v195
    v_cvt_pk_bf16_f32 v94, v196, v197
    v_cvt_pk_bf16_f32 v95, v198, v199
    v_lshlrev_b32 v192, 16, v100
    v_and_b32 v193, s10, v100
    v_lshlrev_b32 v194, 16, v101
    v_and_b32 v195, s10, v101
    v_lshlrev_b32 v196, 16, v102
    v_and_b32 v197, s10, v102
    v_lshlrev_b32 v198, 16, v103
    v_and_b32 v199, s10, v103
    v_pk_mul_f32 v[200:201], v[200:201], v[172:173]
    v_pk_mul_f32 v[202:203], v[202:203], v[172:173]
    v_pk_mul_f32 v[204:205], v[204:205], v[174:175]
    v_pk_mul_f32 v[206:207], v[206:207], v[174:175]
    v_cvt_pk_bf16_f32 v96, v200, v201
    v_cvt_pk_bf16_f32 v97, v202, v203
    v_cvt_pk_bf16_f32 v98, v204, v205
    v_cvt_pk_bf16_f32 v99, v206, v207
    v_pk_mul_f32 v[192:193], v[192:193], v[176:177]
    v_pk_mul_f32 v[194:195], v[194:195], v[176:177]
    v_pk_mul_f32 v[196:197], v[196:197], v[178:179]
    v_pk_mul_f32 v[198:199], v[198:199], v[178:179]
    v_cvt_pk_bf16_f32 v100, v192, v193
    v_cvt_pk_bf16_f32 v101, v194, v195
    v_cvt_pk_bf16_f32 v102, v196, v197
    v_cvt_pk_bf16_f32 v103, v198, v199
    s_waitcnt vmcnt(5)
    v_mfma_f32_16x16x32_bf16 v[224:227], v[16:19], v[104:107], 0
    v_mfma_f32_16x16x32_bf16 v[224:227], v[20:23], v[108:111], v[224:227]
    v_mfma_f32_16x16x32_bf16 v[224:227], v[24:27], v[112:115], v[224:227]
    v_mfma_f32_16x16x32_bf16 v[228:231], v[28:31], v[108:111], 0
    v_mfma_f32_16x16x32_bf16 v[228:231], v[32:35], v[112:115], v[228:231]
    v_mfma_f32_16x16x32_bf16 v[228:231], v[36:39], v[116:119], v[228:231]
    v_mfma_f32_16x16x32_bf16 v[228:231], v[40:43], v[120:123], v[228:231]
    v_mfma_f32_16x16x32_bf16 v[232:235], v[44:47], v[116:119], 0
    v_mfma_f32_16x16x32_bf16 v[232:235], v[48:51], v[120:123], v[232:235]
    v_lshlrev_b32 v192, 16, v104
    v_and_b32 v193, s10, v104
    v_lshlrev_b32 v194, 16, v105
    v_and_b32 v195, s10, v105
    v_lshlrev_b32 v196, 16, v106
    v_and_b32 v197, s10, v106
    v_lshlrev_b32 v198, 16, v107
    v_and_b32 v199, s10, v107
    v_add_f32 v224, s11, v224
    v_add_f32 v225, s11, v225
    v_add_f32 v226, s11, v226
    v_add_f32 v227, s11, v227
    v_add_f32 v228, s11, v228
    v_add_f32 v229, s11, v229
    v_add_f32 v230, s11, v230
    v_add_f32 v231, s11, v231
    v_add_f32 v232, s11, v232
    v_add_f32 v233, s11, v233
    v_rcp_f32 v224, v224
    v_rcp_f32 v225, v225
    v_rcp_f32 v226, v226
    v_rcp_f32 v227, v227
    v_rcp_f32 v228, v228
    v_rcp_f32 v229, v229
    v_rcp_f32 v230, v230
    v_rcp_f32 v231, v231
    v_rcp_f32 v232, v232
    v_rcp_f32 v233, v233
    s_nop 0
    v_mul_f32 v160, v224, v242
    v_mul_f32 v161, v224, v242
    v_mul_f32 v162, v225, v242
    v_mul_f32 v163, v225, v242
    v_mul_f32 v164, v226, v242
    v_mul_f32 v165, v226, v242
    v_mul_f32 v166, v227, v242
    v_mul_f32 v167, v227, v242
    v_mul_f32 v168, v228, v242
    v_mul_f32 v169, v228, v242
    v_mul_f32 v170, v229, v242
    v_mul_f32 v171, v229, v242
    v_mul_f32 v172, v230, v242
    v_mul_f32 v173, v230, v242
    v_mul_f32 v174, v231, v242
    v_mul_f32 v175, v231, v242
    v_mul_f32 v176, v232, v242
    v_mul_f32 v177, v232, v242
    v_mul_f32 v178, v233, v242
    v_mul_f32 v179, v233, v242
    v_lshlrev_b32 v200, 16, v108
    v_and_b32 v201, s10, v108
    v_lshlrev_b32 v202, 16, v109
    v_and_b32 v203, s10, v109
    v_lshlrev_b32 v204, 16, v110
    v_and_b32 v205, s10, v110
    v_lshlrev_b32 v206, 16, v111
    v_and_b32 v207, s10, v111
    v_pk_mul_f32 v[192:193], v[192:193], v[160:161]
    v_pk_mul_f32 v[194:195], v[194:195], v[160:161]
    v_pk_mul_f32 v[196:197], v[196:197], v[162:163]
    v_pk_mul_f32 v[198:199], v[198:199], v[162:163]
    v_cvt_pk_bf16_f32 v104, v192, v193
    v_cvt_pk_bf16_f32 v105, v194, v195
    v_cvt_pk_bf16_f32 v106, v196, v197
    v_cvt_pk_bf16_f32 v107, v198, v199
    v_lshlrev_b32 v192, 16, v112
    v_and_b32 v193, s10, v112
    v_lshlrev_b32 v194, 16, v113
    v_and_b32 v195, s10, v113
    v_lshlrev_b32 v196, 16, v114
    v_and_b32 v197, s10, v114
    v_lshlrev_b32 v198, 16, v115
    v_and_b32 v199, s10, v115
    v_pk_mul_f32 v[200:201], v[200:201], v[164:165]
    v_pk_mul_f32 v[202:203], v[202:203], v[164:165]
    v_pk_mul_f32 v[204:205], v[204:205], v[166:167]
    v_pk_mul_f32 v[206:207], v[206:207], v[166:167]
    v_cvt_pk_bf16_f32 v108, v200, v201
    v_cvt_pk_bf16_f32 v109, v202, v203
    v_cvt_pk_bf16_f32 v110, v204, v205
    v_cvt_pk_bf16_f32 v111, v206, v207
    v_lshlrev_b32 v200, 16, v116
    v_and_b32 v201, s10, v116
    v_lshlrev_b32 v202, 16, v117
    v_and_b32 v203, s10, v117
    v_lshlrev_b32 v204, 16, v118
    v_and_b32 v205, s10, v118
    v_lshlrev_b32 v206, 16, v119
    v_and_b32 v207, s10, v119
    v_pk_mul_f32 v[192:193], v[192:193], v[168:169]
    v_pk_mul_f32 v[194:195], v[194:195], v[168:169]
    v_pk_mul_f32 v[196:197], v[196:197], v[170:171]
    v_pk_mul_f32 v[198:199], v[198:199], v[170:171]
    v_cvt_pk_bf16_f32 v112, v192, v193
    v_cvt_pk_bf16_f32 v113, v194, v195
    v_cvt_pk_bf16_f32 v114, v196, v197
    v_cvt_pk_bf16_f32 v115, v198, v199
    v_lshlrev_b32 v192, 16, v120
    v_and_b32 v193, s10, v120
    v_lshlrev_b32 v194, 16, v121
    v_and_b32 v195, s10, v121
    v_lshlrev_b32 v196, 16, v122
    v_and_b32 v197, s10, v122
    v_lshlrev_b32 v198, 16, v123
    v_and_b32 v199, s10, v123
    v_pk_mul_f32 v[200:201], v[200:201], v[172:173]
    v_pk_mul_f32 v[202:203], v[202:203], v[172:173]
    v_pk_mul_f32 v[204:205], v[204:205], v[174:175]
    v_pk_mul_f32 v[206:207], v[206:207], v[174:175]
    v_cvt_pk_bf16_f32 v116, v200, v201
    v_cvt_pk_bf16_f32 v117, v202, v203
    v_cvt_pk_bf16_f32 v118, v204, v205
    v_cvt_pk_bf16_f32 v119, v206, v207
    v_pk_mul_f32 v[192:193], v[192:193], v[176:177]
    v_pk_mul_f32 v[194:195], v[194:195], v[176:177]
    v_pk_mul_f32 v[196:197], v[196:197], v[178:179]
    v_pk_mul_f32 v[198:199], v[198:199], v[178:179]
    v_cvt_pk_bf16_f32 v120, v192, v193
    v_cvt_pk_bf16_f32 v121, v194, v195
    v_cvt_pk_bf16_f32 v122, v196, v197
    v_cvt_pk_bf16_f32 v123, v198, v199
    s_waitcnt vmcnt(0)
    v_mfma_f32_16x16x32_bf16 v[224:227], v[16:19], v[124:127], 0
    v_mfma_f32_16x16x32_bf16 v[224:227], v[20:23], v[128:131], v[224:227]
    v_mfma_f32_16x16x32_bf16 v[224:227], v[24:27], v[132:135], v[224:227]
    v_mfma_f32_16x16x32_bf16 v[228:231], v[28:31], v[128:131], 0
    v_mfma_f32_16x16x32_bf16 v[228:231], v[32:35], v[132:135], v[228:231]
    v_mfma_f32_16x16x32_bf16 v[228:231], v[36:39], v[136:139], v[228:231]
    v_mfma_f32_16x16x32_bf16 v[228:231], v[40:43], v[140:143], v[228:231]
    v_mfma_f32_16x16x32_bf16 v[232:235], v[44:47], v[136:139], 0
    v_mfma_f32_16x16x32_bf16 v[232:235], v[48:51], v[140:143], v[232:235]
    v_lshlrev_b32 v192, 16, v124
    v_and_b32 v193, s10, v124
    v_lshlrev_b32 v194, 16, v125
    v_and_b32 v195, s10, v125
    v_lshlrev_b32 v196, 16, v126
    v_and_b32 v197, s10, v126
    v_lshlrev_b32 v198, 16, v127
    v_and_b32 v199, s10, v127
    v_add_f32 v224, s11, v224
    v_add_f32 v225, s11, v225
    v_add_f32 v226, s11, v226
    v_add_f32 v227, s11, v227
    v_add_f32 v228, s11, v228
    v_add_f32 v229, s11, v229
    v_add_f32 v230, s11, v230
    v_add_f32 v231, s11, v231
    v_add_f32 v232, s11, v232
    v_add_f32 v233, s11, v233
    v_rcp_f32 v224, v224
    v_rcp_f32 v225, v225
    v_rcp_f32 v226, v226
    v_rcp_f32 v227, v227
    v_rcp_f32 v228, v228
    v_rcp_f32 v229, v229
    v_rcp_f32 v230, v230
    v_rcp_f32 v231, v231
    v_rcp_f32 v232, v232
    v_rcp_f32 v233, v233
    s_nop 0
    v_mul_f32 v160, v224, v243
    v_mul_f32 v161, v224, v243
    v_mul_f32 v162, v225, v243
    v_mul_f32 v163, v225, v243
    v_mul_f32 v164, v226, v243
    v_mul_f32 v165, v226, v243
    v_mul_f32 v166, v227, v243
    v_mul_f32 v167, v227, v243
    v_mul_f32 v168, v228, v243
    v_mul_f32 v169, v228, v243
    v_mul_f32 v170, v229, v243
    v_mul_f32 v171, v229, v243
    v_mul_f32 v172, v230, v243
    v_mul_f32 v173, v230, v243
    v_mul_f32 v174, v231, v243
    v_mul_f32 v175, v231, v243
    v_mul_f32 v176, v232, v243
    v_mul_f32 v177, v232, v243
    v_mul_f32 v178, v233, v243
    v_mul_f32 v179, v233, v243
    v_lshlrev_b32 v200, 16, v128
    v_and_b32 v201, s10, v128
    v_lshlrev_b32 v202, 16, v129
    v_and_b32 v203, s10, v129
    v_lshlrev_b32 v204, 16, v130
    v_and_b32 v205, s10, v130
    v_lshlrev_b32 v206, 16, v131
    v_and_b32 v207, s10, v131
    v_pk_mul_f32 v[192:193], v[192:193], v[160:161]
    v_pk_mul_f32 v[194:195], v[194:195], v[160:161]
    v_pk_mul_f32 v[196:197], v[196:197], v[162:163]
    v_pk_mul_f32 v[198:199], v[198:199], v[162:163]
    v_cvt_pk_bf16_f32 v124, v192, v193
    v_cvt_pk_bf16_f32 v125, v194, v195
    v_cvt_pk_bf16_f32 v126, v196, v197
    v_cvt_pk_bf16_f32 v127, v198, v199
    v_lshlrev_b32 v192, 16, v132
    v_and_b32 v193, s10, v132
    v_lshlrev_b32 v194, 16, v133
    v_and_b32 v195, s10, v133
    v_lshlrev_b32 v196, 16, v134
    v_and_b32 v197, s10, v134
    v_lshlrev_b32 v198, 16, v135
    v_and_b32 v199, s10, v135
    v_pk_mul_f32 v[200:201], v[200:201], v[164:165]
    v_pk_mul_f32 v[202:203], v[202:203], v[164:165]
    v_pk_mul_f32 v[204:205], v[204:205], v[166:167]
    v_pk_mul_f32 v[206:207], v[206:207], v[166:167]
    v_cvt_pk_bf16_f32 v128, v200, v201
    v_cvt_pk_bf16_f32 v129, v202, v203
    v_cvt_pk_bf16_f32 v130, v204, v205
    v_cvt_pk_bf16_f32 v131, v206, v207
    v_lshlrev_b32 v200, 16, v136
    v_and_b32 v201, s10, v136
    v_lshlrev_b32 v202, 16, v137
    v_and_b32 v203, s10, v137
    v_lshlrev_b32 v204, 16, v138
    v_and_b32 v205, s10, v138
    v_lshlrev_b32 v206, 16, v139
    v_and_b32 v207, s10, v139
    v_pk_mul_f32 v[192:193], v[192:193], v[168:169]
    v_pk_mul_f32 v[194:195], v[194:195], v[168:169]
    v_pk_mul_f32 v[196:197], v[196:197], v[170:171]
    v_pk_mul_f32 v[198:199], v[198:199], v[170:171]
    v_cvt_pk_bf16_f32 v132, v192, v193
    v_cvt_pk_bf16_f32 v133, v194, v195
    v_cvt_pk_bf16_f32 v134, v196, v197
    v_cvt_pk_bf16_f32 v135, v198, v199
    v_lshlrev_b32 v192, 16, v140
    v_and_b32 v193, s10, v140
    v_lshlrev_b32 v194, 16, v141
    v_and_b32 v195, s10, v141
    v_lshlrev_b32 v196, 16, v142
    v_and_b32 v197, s10, v142
    v_lshlrev_b32 v198, 16, v143
    v_and_b32 v199, s10, v143
    v_pk_mul_f32 v[200:201], v[200:201], v[172:173]
    v_pk_mul_f32 v[202:203], v[202:203], v[172:173]
    v_pk_mul_f32 v[204:205], v[204:205], v[174:175]
    v_pk_mul_f32 v[206:207], v[206:207], v[174:175]
    v_cvt_pk_bf16_f32 v136, v200, v201
    v_cvt_pk_bf16_f32 v137, v202, v203
    v_cvt_pk_bf16_f32 v138, v204, v205
    v_cvt_pk_bf16_f32 v139, v206, v207
    v_pk_mul_f32 v[192:193], v[192:193], v[176:177]
    v_pk_mul_f32 v[194:195], v[194:195], v[176:177]
    v_pk_mul_f32 v[196:197], v[196:197], v[178:179]
    v_pk_mul_f32 v[198:199], v[198:199], v[178:179]
    v_cvt_pk_bf16_f32 v140, v192, v193
    v_cvt_pk_bf16_f32 v141, v194, v195
    v_cvt_pk_bf16_f32 v142, v196, v197
    v_cvt_pk_bf16_f32 v143, v198, v199
    s_cmp_lg_u32 s3, 4
    s_cbranch_scc1 L_p2_h5
    s_lshl_b32 s7, s90, 10
    s_add_u32 s7, s7, 16384
    v_lshlrev_b32 v7, 4, v0
    s_mov_b32 s94, -1
    s_mov_b32 s95, 0xff
L_s2_poll:
    buffer_load_dwordx4 v[16:19], v7, s[84:87], s7 offen sc1
    s_waitcnt vmcnt(0)
    v_xor_b32 v16, s92, v16
    v_xor_b32 v17, s92, v17
    v_xor_b32 v18, s92, v18
    v_xor_b32 v19, s92, v19
    v_or3_b32 v16, v16, v17, v18
    v_or_b32 v16, v16, v19
    v_cmp_ne_u32 vcc, 0, v16
    s_nop 1
    s_and_b64 vcc, vcc, s[94:95]
    s_cbranch_scc0 L_s2_ok
    s_sleep 4
    s_branch L_s2_poll
L_s2_ok:
L_p2_h5:
    s_barrier
    ds_write_b128 v4, v[64:67] offset:0
    ds_write_b128 v4, v[68:71] offset:1024
    ds_write_b128 v4, v[72:75] offset:2048
    ds_write_b128 v4, v[76:79] offset:3072
    ds_write_b128 v4, v[80:83] offset:4096
    ds_write_b128 v4, v[84:87] offset:5120
    ds_write_b128 v4, v[88:91] offset:6144
    ds_write_b128 v4, v[92:95] offset:7168
    ds_write_b128 v4, v[96:99] offset:8192
    ds_write_b128 v4, v[100:103] offset:9216
    ds_write_b128 v4, v[104:107] offset:10240
    ds_write_b128 v4, v[108:111] offset:11264
    ds_write_b128 v4, v[112:115] offset:12288
    ds_write_b128 v4, v[116:119] offset:13312
    ds_write_b128 v4, v[120:123] offset:14336
    ds_write_b128 v4, v[124:127] offset:15360
    ds_write_b128 v4, v[128:131] offset:16384
    ds_write_b128 v4, v[132:135] offset:17408
    ds_write_b128 v4, v[136:139] offset:18432
    ds_write_b128 v4, v[140:143] offset:19456
    s_waitcnt lgkmcnt(0)
    s_barrier
    s_endpgm
L_end:
    s_endpgm
.section .rodata,"a"
.p2align 6
.amdhsa_kernel gated_mix__linear_attn_block__glu_gated_glu__prompt_kernel
  .amdhsa_next_free_vgpr 256
  .amdhsa_next_free_sgpr 102
  .amdhsa_accum_offset 256
  .amdhsa_group_segment_fixed_size 0
  .amdhsa_kernarg_size 88
  .amdhsa_user_sgpr_count 2
  .amdhsa_user_sgpr_kernarg_segment_ptr 1
  .amdhsa_system_sgpr_workgroup_id_x 1
.end_amdhsa_kernel
.text
```
